```python
import torch

def _softmax(x, axis=-1):
    return torch.softmax(x, dim=axis)
def _gelu(x):
    return torch.nn.functional.gelu(x, approximate="tanh")
def _silu(x):
    return torch.nn.functional.silu(x)
def _sigmoid(x):
    return torch.sigmoid(x)
def _layernorm(x, axis=-1, eps=1e-5):
    m = x.mean(dim=axis, keepdim=True)
    v = x.var(dim=axis, keepdim=True, unbiased=False)
    return (x - m) / torch.sqrt(v + eps)
def _scatter_add(tgt, idx, src, axis=0):
    return tgt.clone().index_add_(axis, idx, src)
def _segment_sum(src, seg, n):
    out = torch.zeros((n,) + src.shape[1:], dtype=src.dtype)
    return out.index_add_(0, seg, src)
def _pad(x, pw):
    flat = tuple(v for pair in reversed(pw) for v in pair)
    return torch.nn.functional.pad(x, flat)

kernel_name = 'concat_heads__ssm_conv_s4__mha_block__prompt'

def setup_inputs():

    _w = (lambda a: (lambda t: t.to(torch.bfloat16) if t.is_floating_point() else t)(torch.as_tensor(a)))
    def _A_setup():
        B, L, D, N = 1, 2048, 576, 128
        A_re = -(lambda _x: torch.exp(torch.as_tensor(_x)))((lambda *s: torch.randn(*s, dtype=torch.bfloat16) * 6.4)(D, N))
        A_im = torch.pi * (lambda *s: torch.randn(*s, dtype=torch.bfloat16) * 0.1)(D, N)
        B_re = (lambda *s: torch.randn(*s, dtype=torch.bfloat16) * 0.2)(D, N)
        B_im = (lambda *s: torch.randn(*s, dtype=torch.bfloat16) * 0.2)(D, N)
        C_re = (lambda *s: torch.randn(*s, dtype=torch.bfloat16) * 0.2)(D, N)
        C_im = (lambda *s: torch.randn(*s, dtype=torch.bfloat16) * 0.2)(D, N)
        log_dt = (lambda *s: torch.randn(*s, dtype=torch.bfloat16) * 0.1)(D) * 0.5 - 4.0
        Dskip = (lambda *s: torch.randn(*s, dtype=torch.bfloat16) * 0.1)(D)
        return {
            "u": _w((lambda *s: torch.randn(*s, dtype=torch.bfloat16) * 0.05)(B, L, D)),
            "A_re": _w(A_re),
            "A_im": _w(A_im),
            "B_re": _w(B_re),
            "B_im": _w(B_im),
            "C_re": _w(C_re),
            "C_im": _w(C_im),
            "log_dt": _w(log_dt),
            "Dskip": _w(Dskip),
        }
    _A_in = _A_setup()

    def _B_setup():
        B, S, D, H = 1, 2048, 576, 32
        return {
            "x": _w((lambda *s: torch.randn(*s, dtype=torch.bfloat16) * 0.2)(B, S, D)),
            "wqkv": _w((lambda *s: torch.randn(*s, dtype=torch.bfloat16) * 0.2)(D, 3 * D)),
            "wo": _w((lambda *s: torch.randn(*s, dtype=torch.bfloat16) * 0.05)(D, D)),
        }
    _B_in = _B_setup()

    return {
        "A_u": _A_in["u"],
        "A_A_re": _A_in["A_re"],
        "A_A_im": _A_in["A_im"],
        "A_B_re": _A_in["B_re"],
        "A_B_im": _A_in["B_im"],
        "A_C_re": _A_in["C_re"],
        "A_C_im": _A_in["C_im"],
        "A_log_dt": _A_in["log_dt"],
        "A_Dskip": _A_in["Dskip"],
        "B_x": _B_in["x"],
        "B_wqkv": _B_in["wqkv"],
        "B_wo": _B_in["wo"],
    }

def reference(A_u, A_A_re, A_A_im, A_B_re, A_B_im, A_C_re, A_C_im, A_log_dt, A_Dskip, B_x, B_wqkv, B_wo):
    def _A_ref(u, A_re, A_im, B_re, B_im, C_re, C_im, log_dt, Dskip):
        Bsz, L, D = u.shape
        dt = torch.exp(log_dt)[:, None]
        A = A_re + 1j * A_im
        Bc = B_re + 1j * B_im
        Cc = C_re + 1j * C_im
        logdA = dt * A
        dB = dt * Bc
        l = (lambda x, dt: x.to(dt))(torch.arange(L), A_re.dtype)
        P = torch.exp(logdA[:, :, None] * l[None, None, :])
        K = torch.einsum("dn,dnl,dn->dl", Cc, P, dB).real
        L2 = 2 * L
        Kp = _pad(K, ((0, 0), (0, L)))
        up = (lambda x, *d: x.permute(*d))(u, 0, 2, 1)
        up = _pad(up, ((0, 0), (0, 0), (0, L)))
        Kf = (lambda x, axes=(-2,-1): torch.fft.rfft2(x.float(), dim=axes))(Kp[:, None, :], axes=(-2, -1))
        Uf = (lambda x, axes=(-2,-1): torch.fft.rfft2(x.float(), dim=axes))(up[:, :, None, :], axes=(-2, -1))
        Yf = Uf * Kf[None, :, :, :]
        y = (lambda x, s, axes=(-2,-1): torch.fft.irfft2(x, s=s, dim=axes).to(torch.bfloat16))(Yf, (1, L2), axes=(-2, -1))[:, :, 0, :L]
        y = (lambda x, *d: x.permute(*d))(y, 0, 2, 1) + u * Dskip[None, None, :]
        return y

    def _B_ref(x, wqkv, wo):
        B, S, D = x.shape
        H = 32
        Dh = D // H
        qkv = (lambda x, *d: x.permute(*d))((x @ wqkv).reshape(B, S, 3, H, Dh), 2, 0, 3, 1, 4)
        q, k, v = qkv[0], qkv[1], qkv[2]
        scores = torch.einsum("bhqd,bhkd->bhqk", q, k) * (Dh ** -0.5)
        p = _softmax(scores, axis=-1)
        o = torch.einsum("bhqk,bhkd->bhqd", p, v)
        return (lambda x, *d: x.permute(*d))(o, 0, 2, 1, 3).reshape(B, S, D) @ wo

    a = _A_ref(A_u, A_A_re, A_A_im, A_B_re, A_B_im, A_C_re, A_C_im, A_log_dt, A_Dskip)
    b = _B_ref(B_x, B_wqkv, B_wo)
    return torch.concatenate([a, b], axis=-1)
```

```asm
; @launch grid=(256,1,1) block=(512,1,1) lds=163840
.amdgcn_target "amdgcn-amd-amdhsa--gfx950"
.text
.globl concat_heads__ssm_conv_s4__mha_block__prompt_kernel
.p2align 8
.type concat_heads__ssm_conv_s4__mha_block__prompt_kernel,@function
concat_heads__ssm_conv_s4__mha_block__prompt_kernel:
L_code_begin:
    s_cmp_ge_u32 s2, 256
    s_cbranch_scc1 L_end
    s_load_dwordx8 s[24:31], s[0:1], 64
    s_load_dwordx4 s[32:35], s[0:1], 96
    s_load_dwordx2 s[36:37], s[0:1], 112
    s_load_dwordx16 s[8:23], s[0:1], 0
    v_lshrrev_b32 v1, 6, v0
    v_and_b32 v0, 63, v0
    v_readfirstlane_b32 s38, v1
    s_getpc_b64 s[60:61]
L_pc:
    s_sub_u32 s60, s60, L_pc-L_code_begin
    s_subb_u32 s61, s61, 0
    v_lshlrev_b32 v94, 13, v1
    v_lshl_add_u32 v94, v0, 7, v94
    v_min_u32 v94, L_code_end-L_code_begin-4, v94
    v_mov_b32 v93, s61
    v_add_co_u32 v92, vcc, s60, v94
    s_nop 1
    v_addc_co_u32 v93, vcc, 0, v93, vcc
    global_load_dword v252, v[92:93], off
    s_and_b32 s39, s2, 7
    s_lshr_b32 s40, s2, 3
    s_and_b32 s3, s38, 3
    s_and_b32 s4, s39, 1
    s_lshl_b32 s4, s4, 3
    s_and_b32 s60, s40, 7
    s_add_u32 s4, s4, s60
    s_lshr_b32 s5, s39, 1
    s_lshl_b32 s5, s5, 2
    s_lshr_b32 s61, s40, 3
    s_add_u32 s5, s5, s61
    s_cmp_ge_u32 s38, 4
    s_cbranch_scc1 L_bwave
    s_setprio 2
    s_and_b32 s60, s40, 7
    s_lshr_b32 s61, s40, 3
    s_lshl_b32 s61, s61, 1
    s_add_u32 s62, s61, s60
    s_cmp_ge_u32 s62, 9
    s_cselect_b32 s61, 9, 0
    s_sub_u32 s62, s62, s61
    s_lshl_b32 s66, s4, 7
    s_lshl_b32 s67, s3, 5
    s_add_u32 s66, s66, s67
    s_mul_i32 s66, s66, 1152
    v_lshrrev_b32 v92, 3, v0
    v_mul_u32_u24 v92, 1152, v92
    v_lshrrev_b32 v93, 4, v0
    v_and_b32 v94, 7, v0
    v_xor_b32 v95, v94, v93
    v_lshlrev_b32 v95, 4, v95
    v_add3_u32 v82, v92, v95, s66
    v_xor_b32 v95, 64, v95
    s_add_u32 s66, s66, 9216
    v_add3_u32 v83, v92, v95, s66
    v_and_b32 v94, 15, v0
    v_lshlrev_b32 v95, 2, v93
    v_xor_b32 v94, v94, v95
    s_mul_i32 s66, s5, 216
    s_and_b32 s67, s66, 31
    s_add_u32 s67, s67, 215
    s_lshr_b32 s67, s67, 4
    v_min_u32 v94, s67, v94
    v_lshlrev_b32 v94, 4, v94
    s_and_b32 s66, s66, 0xffffffe0
    s_mul_i32 s67, s3, 55296
    s_add_u32 s66, s66, s67
    v_mul_u32_u24 v93, 3456, v93
    v_add3_u32 v84, v93, v94, s66
    s_lshl_b32 s65, s3, 12
    s_waitcnt lgkmcnt(0)
    s_mov_b32 s44, s26
    s_and_b32 s45, s27, 0xffff
    s_mov_b32 s46, 2359296
    s_mov_b32 s47, 0x20000
    s_mov_b32 s48, s28
    s_and_b32 s49, s29, 0xffff
    s_mov_b32 s50, 1990656
    s_mov_b32 s51, 0x20000
    s_lshl_b32 s63, s62, 7
    s_mul_i32 s64, s62, 221184
    s_add_u32 m0, s65, 0
    s_nop 0
    buffer_load_dwordx4 v82, s[44:47], s63 offen lds
    s_add_u32 m0, s65, 1024
    s_add_u32 s62, s62, 1
    buffer_load_dwordx4 v83, s[44:47], s63 offen lds
    s_add_u32 s63, s63, 18432
    s_add_u32 m0, s65, 2048
    s_nop 0
    buffer_load_dwordx4 v82, s[44:47], s63 offen lds
    s_add_u32 m0, s65, 3072
    s_cmp_eq_u32 s62, 9
    s_cselect_b32 s62, 0, s62
    buffer_load_dwordx4 v83, s[44:47], s63 offen lds
    s_add_u32 m0, s65, 16384
    s_nop 0
    buffer_load_dwordx4 v84, s[48:51], s64 offen lds
    s_add_u32 m0, s65, 17408
    s_add_u32 s64, s64, 13824
    buffer_load_dwordx4 v84, s[48:51], s64 offen lds
    s_add_u32 m0, s65, 18432
    s_add_u32 s64, s64, 13824
    buffer_load_dwordx4 v84, s[48:51], s64 offen lds
    s_add_u32 m0, s65, 19456
    s_add_u32 s64, s64, 13824
    buffer_load_dwordx4 v84, s[48:51], s64 offen lds
    s_mov_b32 s52, s36
    s_and_b32 s53, s37, 0xffff
    s_mov_b32 s54, 10420224
    s_mov_b32 s55, 0x20000
    s_cmp_lt_u32 s39, 2
    s_cselect_b32 s60, 24, 16
    s_cmp_lt_u32 s40, s60
    s_cselect_b32 s41, 1, 0
    s_lshl_b32 s56, s39, 2
    s_lshr_b32 s60, s40, 3
    s_add_u32 s56, s56, s60
    s_and_b32 s60, s40, 7
    s_lshl_b32 s60, s60, 3
    s_lshl_b32 s61, s3, 1
    s_add_u32 s60, s60, s61
    s_lshr_b32 s61, s38, 2
    s_add_u32 s57, s60, s61
    s_mul_i32 s60, s40, s41
    s_lshl_b32 s61, s39, 6
    s_mul_i32 s58, s39, 32
    s_add_u32 s58, s58, 448
    s_cmp_lt_u32 s60, 16
    s_cmov_b32 s58, s61
    s_lshl_b32 s60, s60, 2
    s_add_u32 s58, s58, s60
    v_mov_b32 v20, 0
    v_lshlrev_b32 v16, 2, v0
    v_add_u32 v16, 163712, v16
    s_mov_b32 exec_hi, 0
    ds_write_b32 v16, v20
    s_mov_b64 exec, -1
    s_and_b32 s66, s3, 1
    s_lshr_b32 s67, s3, 1
    s_lshl_b32 s69, s67, 13
    s_mul_i32 s68, s5, 216
    s_and_b32 s68, s68, 31
    v_and_b32 v16, 31, v0
    v_lshlrev_b32 v17, 7, v16
    v_add_u32 v17, s69, v17
    v_bfe_u32 v18, v0, 1, 3
    v_lshrrev_b32 v19, 5, v0
    v_xor_b32 v18, v18, v19
    v_lshlrev_b32 v18, 4, v18
    v_xor_b32 v20, 0, v18
    v_add_u32 v216, v17, v20
    v_add_u32 v220, 0x10000, v216
    v_xor_b32 v20, 32, v18
    v_add_u32 v217, v17, v20
    v_add_u32 v221, 0x10000, v217
    v_xor_b32 v20, 64, v18
    v_add_u32 v218, v17, v20
    v_add_u32 v222, 0x10000, v218
    v_xor_b32 v20, 96, v18
    v_add_u32 v219, v17, v20
    v_add_u32 v223, 0x10000, v219
    v_and_b32 v16, 3, v0
    v_bfe_u32 v18, v0, 4, 1
    v_lshl_add_u32 v20, v18, 2, v16
    v_mul_u32_u24 v21, 9, v16
    v_add_u32 v21, 4, v21
    v_cmp_eq_u32 vcc, 1, v18
    v_bfe_u32 v16, v0, 2, 2
    v_lshl_add_u32 v17, v19, 3, v16
    v_lshlrev_b32 v17, 8, v17
    v_add_u32 v17, 16384, v17
    v_lshlrev_b32 v16, 6, v16
    v_cndmask_b32 v21, v20, v21, vcc
    v_add_u32 v22, 5, v20
    s_cmp_eq_u32 s66, 1
    s_cselect_b64 vcc, -1, 0
    s_cselect_b32 s69, 23, 14
    v_cndmask_b32 v21, v22, v21, vcc
    v_add_u32 v22, s69, v20
    v_mov_b32 v23, 262144
    v_cmp_lt_u32 vcc, 26, v21
    v_lshl_add_u32 v21, v21, 3, s68
    v_xor_b32 v21, v21, v16
    v_add_u32 v21, v21, v17
    v_cndmask_b32 v224, v21, v23, vcc
    v_add_u32 v226, 0x10000, v224
    v_cmp_lt_u32 vcc, 26, v22
    v_lshl_add_u32 v22, v22, 3, s68
    v_xor_b32 v22, v22, v16
    v_add_u32 v22, v22, v17
    v_cndmask_b32 v225, v22, v23, vcc
    v_add_u32 v227, 0x10000, v225
    s_mul_i32 s82, s56, 155648
    s_add_u32 s82, s82, 3080192
    s_lshl_b32 s83, s38, 10
    s_mul_i32 s92, s38, 384
    v_lshlrev_b32 v1, 4, v0
    v_add_u32 v6, s83, v1
    s_lshl_b32 s60, s38, 6
    v_add_u32 v234, s60, v0
    v_mul_u32_u24 v230, 3277, v234
    v_lshrrev_b32 v230, 16, v230
    v_mul_u32_u24 v231, 20, v230
    v_sub_u32 v231, v234, v231
    v_lshrrev_b32 v232, 2, v230
    v_lshlrev_b32 v232, 10, v232
    v_and_b32 v233, 3, v230
    v_lshl_add_u32 v232, v233, 7, v232
    v_lshl_add_u32 v232, v231, 4, v232
    v_add_u32 v233, 8512, v232
    v_add_u32 v232, 8192, v232
    v_cmp_lt_u32 vcc, 11, v231
    v_lshlrev_b32 v230, 6, v230
    v_lshl_add_u32 v230, v231, 4, v230
    v_cndmask_b32 v232, v232, v233, vcc
    v_subrev_u32 v231, 8, v231
    v_cmp_gt_u32 vcc, 4, v231
    v_add_u32 v230, 16256, v230
    s_nop 0
    v_cndmask_b32 v7, v232, v230, vcc
    v_add_u32 v234, 256, v234
    v_mul_u32_u24 v230, 3277, v234
    v_lshrrev_b32 v230, 16, v230
    v_mul_u32_u24 v231, 20, v230
    v_sub_u32 v231, v234, v231
    v_lshrrev_b32 v232, 2, v230
    v_lshlrev_b32 v232, 10, v232
    v_and_b32 v233, 3, v230
    v_lshl_add_u32 v232, v233, 7, v232
    v_lshl_add_u32 v232, v231, 4, v232
    v_add_u32 v233, 8512, v232
    v_add_u32 v232, 8192, v232
    v_cmp_lt_u32 vcc, 11, v231
    v_lshlrev_b32 v230, 6, v230
    v_lshl_add_u32 v230, v231, 4, v230
    v_cndmask_b32 v232, v232, v233, vcc
    v_subrev_u32 v231, 8, v231
    v_cmp_gt_u32 vcc, 4, v231
    v_add_u32 v230, 16256, v230
    s_nop 0
    v_cndmask_b32 v228, v232, v230, vcc
    s_mul_i32 s60, s38, 24
    s_add_u32 s60, s60, 512
    v_add_u32 v234, s60, v0
    v_mul_u32_u24 v230, 3277, v234
    v_lshrrev_b32 v230, 16, v230
    v_mul_u32_u24 v231, 20, v230
    v_sub_u32 v231, v234, v231
    v_lshrrev_b32 v232, 2, v230
    v_lshlrev_b32 v232, 10, v232
    v_and_b32 v233, 3, v230
    v_lshl_add_u32 v232, v233, 7, v232
    v_lshl_add_u32 v232, v231, 4, v232
    v_add_u32 v233, 8512, v232
    v_add_u32 v232, 8192, v232
    v_cmp_lt_u32 vcc, 11, v231
    v_lshlrev_b32 v230, 6, v230
    v_lshl_add_u32 v230, v231, 4, v230
    v_cndmask_b32 v232, v232, v233, vcc
    v_subrev_u32 v231, 8, v231
    v_cmp_gt_u32 vcc, 4, v231
    v_add_u32 v230, 16256, v230
    s_nop 0
    v_cndmask_b32 v14, v232, v230, vcc
    v_cmp_lt_u32 vcc, 639, v234
    v_lshlrev_b32 v230, 4, v234
    v_add_u32 v230, 8192, v230
    v_cndmask_b32 v14, v14, v230, vcc
    v_add_u32 v234, 96, v234
    v_mul_u32_u24 v230, 3277, v234
    v_lshrrev_b32 v230, 16, v230
    v_mul_u32_u24 v231, 20, v230
    v_sub_u32 v231, v234, v231
    v_lshrrev_b32 v232, 2, v230
    v_lshlrev_b32 v232, 10, v232
    v_and_b32 v233, 3, v230
    v_lshl_add_u32 v232, v233, 7, v232
    v_lshl_add_u32 v232, v231, 4, v232
    v_add_u32 v233, 8512, v232
    v_add_u32 v232, 8192, v232
    v_cmp_lt_u32 vcc, 11, v231
    v_lshlrev_b32 v230, 6, v230
    v_lshl_add_u32 v230, v231, 4, v230
    v_cndmask_b32 v232, v232, v233, vcc
    v_subrev_u32 v231, 8, v231
    v_cmp_gt_u32 vcc, 4, v231
    v_add_u32 v230, 16256, v230
    s_nop 0
    v_cndmask_b32 v229, v232, v230, vcc
    v_cmp_lt_u32 vcc, 639, v234
    v_lshlrev_b32 v230, 4, v234
    v_add_u32 v230, 8192, v230
    v_cndmask_b32 v229, v229, v230, vcc
    v_and_b32 v2, 31, v0
    v_lshlrev_b32 v2, 2, v2
    v_lshrrev_b32 v230, 5, v0
    v_mul_u32_u24 v234, 320, v230
    v_bfe_u32 v230, v0, 2, 2
    v_and_b32 v231, 1, v0
    v_lshlrev_b32 v232, 4, v230
    v_lshl_add_u32 v232, v231, 3, v232
    v_and_b32 v231, 2, v0
    v_mul_u32_u24 v231, 96, v231
    v_add_u32 v232, v232, v231
    v_lshlrev_b32 v233, 3, v230
    v_add_u32 v233, 128, v233
    v_and_b32 v231, 3, v0
    v_cmp_ne_u32 vcc, 0, v231
    v_mov_b32 v230, 262144
    v_and_b32 v231, 16, v0
    v_cndmask_b32 v233, v233, v230, vcc
    v_cmp_ne_u32 vcc, 0, v231
    v_mov_b32 v5, 0xdddddddd
    s_nop 0
    v_cndmask_b32 v232, v232, v233, vcc
    v_cndmask_b32 v233, 64, 32, vcc
    v_add_u32 v3, v234, v232
    v_add_u32 v4, v3, v233
    s_cmp_ge_u32 s40, 28
    s_cselect_b32 s59, 1, 0
    s_cbranch_scc1 L_t_dbl_p
    s_lshr_b32 s42, s40, 2
    s_add_u32 s42, s42, 2
    s_and_b32 s43, s40, 3
    s_branch L_t_map_p
L_t_dbl_p:
    s_bfe_u32 s42, s40, 0x10001
    s_and_b32 s43, s40, 1
    s_lshl_b32 s43, s43, 1
    s_lshr_b32 s60, s38, 2
    s_add_u32 s43, s43, s60
L_t_map_p:
    v_lshrrev_b32 v230, 3, v0
    v_and_b32 v231, 7, v0
    v_and_b32 v232, 16, v0
    v_lshrrev_b32 v232, 2, v232
    v_xor_b32 v231, v231, v232
    v_lshlrev_b32 v231, 4, v231
    s_lshl_b32 s60, s42, 7
    s_mul_i32 s61, s38, 82944
    s_add_u32 s60, s60, s61
    v_mul_u32_u24 v233, 1152, v230
    v_add3_u32 v240, v233, v231, s60
    v_lshrrev_b32 v233, 4, v0
    v_mul_u32_u24 v233, 18, v233
    v_and_b32 v230, 1, v230
    v_add_u32 v233, v233, v230
    v_and_b32 v232, 16, v0
    v_xor_b32 v232, 16, v232
    v_add_u32 v233, v233, v232
    v_mul_u32_u24 v233, 1152, v233
    v_add3_u32 v241, v233, v231, s60
    s_lshl_b32 s70, s4, 2
    s_lshl_b32 s60, s67, 1
    s_add_u32 s70, s70, s60
    s_mul_i32 s69, s5, 6
    s_cmp_eq_u32 s66, 1
    s_cbranch_scc1 L_job1
    s_add_u32 s60, s69, 1
    s_lshr_b32 s13, s60, 5
    s_and_b32 s71, s60, 31
    s_lshr_b32 s72, s70, 3
    s_mov_b32 s12, 155648
    s_mov_b32 s73, 19456
    s_mov_b32 s61, 1024
    s_mov_b32 s11, 3080192
    s_cmp_eq_u32 s13, 0
    s_cmov_b32 s12, 73728
    s_cselect_b32 s10, 0x3eae1a93, 1.0
    s_cmov_b32 s73, 8192
    s_cmov_b32 s11, 720896
    s_cmp_eq_u32 s13, 2
    s_cmov_b32 s61, 1024
    s_cmov_b32 s11, 3088384
    s_mul_i32 s71, s71, s12
    s_mul_i32 s72, s72, s73
    s_add_u32 s11, s11, s71
    s_add_u32 s11, s11, s72
    s_and_b32 s72, s70, 7
    s_mul_i32 s72, s72, s61
    s_add_u32 s11, s11, s72
    s_add_u32 s12, s12, s11
    s_add_u32 s60, s69, 2
    s_lshr_b32 s17, s60, 5
    s_and_b32 s71, s60, 31
    s_lshr_b32 s72, s70, 3
    s_mov_b32 s16, 155648
    s_mov_b32 s73, 19456
    s_mov_b32 s61, 1024
    s_mov_b32 s15, 3080192
    s_cmp_eq_u32 s17, 0
    s_cmov_b32 s16, 73728
    s_cselect_b32 s14, 0x3eae1a93, 1.0
    s_cmov_b32 s73, 8192
    s_cmov_b32 s15, 720896
    s_cmp_eq_u32 s17, 2
    s_cmov_b32 s61, 1024
    s_cmov_b32 s15, 3088384
    s_mul_i32 s71, s71, s16
    s_mul_i32 s72, s72, s73
    s_add_u32 s15, s15, s71
    s_add_u32 s15, s15, s72
    s_and_b32 s72, s70, 7
    s_mul_i32 s72, s72, s61
    s_add_u32 s15, s15, s72
    s_add_u32 s16, s16, s15
    s_add_u32 s60, s69, 3
    s_lshr_b32 s21, s60, 5
    s_and_b32 s71, s60, 31
    s_lshr_b32 s72, s70, 3
    s_mov_b32 s20, 155648
    s_mov_b32 s73, 19456
    s_mov_b32 s61, 1024
    s_mov_b32 s19, 3080192
    s_cmp_eq_u32 s21, 0
    s_cmov_b32 s20, 73728
    s_cselect_b32 s18, 0x3eae1a93, 1.0
    s_cmov_b32 s73, 8192
    s_cmov_b32 s19, 720896
    s_cmp_eq_u32 s21, 2
    s_cmov_b32 s61, 1024
    s_cmov_b32 s19, 3088384
    s_mul_i32 s71, s71, s20
    s_mul_i32 s72, s72, s73
    s_add_u32 s19, s19, s71
    s_add_u32 s19, s19, s72
    s_and_b32 s72, s70, 7
    s_mul_i32 s72, s72, s61
    s_add_u32 s19, s19, s72
    s_add_u32 s20, s20, s19
    s_add_u32 s60, s69, 4
    s_lshr_b32 s25, s60, 5
    s_and_b32 s71, s60, 31
    s_lshr_b32 s72, s70, 3
    s_mov_b32 s24, 155648
    s_mov_b32 s73, 19456
    s_mov_b32 s61, 1024
    s_mov_b32 s23, 3080192
    s_cmp_eq_u32 s25, 0
    s_cmov_b32 s24, 73728
    s_cselect_b32 s22, 0x3eae1a93, 1.0
    s_cmov_b32 s73, 8192
    s_cmov_b32 s23, 720896
    s_cmp_eq_u32 s25, 2
    s_cmov_b32 s61, 1024
    s_cmov_b32 s23, 3088384
    s_mul_i32 s71, s71, s24
    s_mul_i32 s72, s72, s73
    s_add_u32 s23, s23, s71
    s_add_u32 s23, s23, s72
    s_and_b32 s72, s70, 7
    s_mul_i32 s72, s72, s61
    s_add_u32 s23, s23, s72
    s_add_u32 s24, s24, s23
    s_branch L_jobe
L_job1:
    s_add_u32 s60, s69, 0
    s_lshr_b32 s13, s60, 5
    s_and_b32 s71, s60, 31
    s_lshr_b32 s72, s70, 3
    s_mov_b32 s12, 155648
    s_mov_b32 s73, 19456
    s_mov_b32 s61, 1024
    s_mov_b32 s11, 3080192
    s_cmp_eq_u32 s13, 0
    s_cmov_b32 s12, 73728
    s_cselect_b32 s10, 0x3eae1a93, 1.0
    s_cmov_b32 s73, 8192
    s_cmov_b32 s11, 720896
    s_cmp_eq_u32 s13, 2
    s_cmov_b32 s61, 1024
    s_cmov_b32 s11, 3088384
    s_mul_i32 s71, s71, s12
    s_mul_i32 s72, s72, s73
    s_add_u32 s11, s11, s71
    s_add_u32 s11, s11, s72
    s_and_b32 s72, s70, 7
    s_mul_i32 s72, s72, s61
    s_add_u32 s11, s11, s72
    s_add_u32 s12, s12, s11
    s_add_u32 s60, s69, 5
    s_lshr_b32 s17, s60, 5
    s_and_b32 s71, s60, 31
    s_lshr_b32 s72, s70, 3
    s_mov_b32 s16, 155648
    s_mov_b32 s73, 19456
    s_mov_b32 s61, 1024
    s_mov_b32 s15, 3080192
    s_cmp_eq_u32 s17, 0
    s_cmov_b32 s16, 73728
    s_cselect_b32 s14, 0x3eae1a93, 1.0
    s_cmov_b32 s73, 8192
    s_cmov_b32 s15, 720896
    s_cmp_eq_u32 s17, 2
    s_cmov_b32 s61, 1024
    s_cmov_b32 s15, 3088384
    s_mul_i32 s71, s71, s16
    s_mul_i32 s72, s72, s73
    s_add_u32 s15, s15, s71
    s_add_u32 s15, s15, s72
    s_and_b32 s72, s70, 7
    s_mul_i32 s72, s72, s61
    s_add_u32 s15, s15, s72
    s_add_u32 s16, s16, s15
    s_add_u32 s60, s69, 0
    s_lshr_b32 s21, s60, 5
    s_and_b32 s71, s60, 31
    s_lshr_b32 s72, s70, 3
    s_mov_b32 s20, 155648
    s_mov_b32 s73, 19456
    s_mov_b32 s61, 128
    s_mov_b32 s19, 3098624
    s_cmp_eq_u32 s21, 0
    s_cmov_b32 s20, 73728
    s_cselect_b32 s18, 0x3eae1a93, 1.0
    s_cmov_b32 s73, 1024
    s_cmov_b32 s19, 786432
    s_cmp_eq_u32 s21, 2
    s_cmov_b32 s61, 256
    s_cmov_b32 s19, 3096576
    s_mul_i32 s71, s71, s20
    s_mul_i32 s72, s72, s73
    s_add_u32 s19, s19, s71
    s_add_u32 s19, s19, s72
    s_and_b32 s72, s70, 7
    s_mul_i32 s72, s72, s61
    s_add_u32 s19, s19, s72
    s_add_u32 s20, s20, s19
    s_add_u32 s60, s69, 2
    s_lshr_b32 s25, s60, 5
    s_and_b32 s71, s60, 31
    s_lshr_b32 s72, s70, 3
    s_mov_b32 s24, 155648
    s_mov_b32 s73, 19456
    s_mov_b32 s61, 128
    s_mov_b32 s23, 3098624
    s_cmp_eq_u32 s25, 0
    s_cmov_b32 s24, 73728
    s_cselect_b32 s22, 0x3eae1a93, 1.0
    s_cmov_b32 s73, 1024
    s_cmov_b32 s23, 786432
    s_cmp_eq_u32 s25, 2
    s_cmov_b32 s61, 256
    s_cmov_b32 s23, 3096576
    s_mul_i32 s71, s71, s24
    s_mul_i32 s72, s72, s73
    s_add_u32 s23, s23, s71
    s_add_u32 s23, s23, s72
    s_and_b32 s72, s70, 7
    s_mul_i32 s72, s72, s61
    s_add_u32 s23, s23, s72
    s_add_u32 s24, s24, s23
    s_add_u32 s60, s69, 4
    s_lshr_b32 s29, s60, 5
    s_and_b32 s71, s60, 31
    s_lshr_b32 s72, s70, 3
    s_mov_b32 s28, 155648
    s_mov_b32 s73, 19456
    s_mov_b32 s61, 128
    s_mov_b32 s27, 3098624
    s_cmp_eq_u32 s29, 0
    s_cmov_b32 s28, 73728
    s_cselect_b32 s26, 0x3eae1a93, 1.0
    s_cmov_b32 s73, 1024
    s_cmov_b32 s27, 786432
    s_cmp_eq_u32 s29, 2
    s_cmov_b32 s61, 256
    s_cmov_b32 s27, 3096576
    s_mul_i32 s71, s71, s28
    s_mul_i32 s72, s72, s73
    s_add_u32 s27, s27, s71
    s_add_u32 s27, s27, s72
    s_and_b32 s72, s70, 7
    s_mul_i32 s72, s72, s61
    s_add_u32 s27, s27, s72
    s_add_u32 s28, s28, s27
L_jobe:
    s_lshl_b32 s63, s62, 7
    s_mul_i32 s64, s62, 221184
    s_add_u32 m0, s65, 32768
    s_nop 0
    buffer_load_dwordx4 v82, s[44:47], s63 offen lds
    s_add_u32 m0, s65, 33792
    s_add_u32 s62, s62, 1
    buffer_load_dwordx4 v83, s[44:47], s63 offen lds
    s_add_u32 s63, s63, 18432
    s_add_u32 m0, s65, 34816
    s_nop 0
    buffer_load_dwordx4 v82, s[44:47], s63 offen lds
    s_add_u32 m0, s65, 35840
    s_cmp_eq_u32 s62, 9
    s_cselect_b32 s62, 0, s62
    buffer_load_dwordx4 v83, s[44:47], s63 offen lds
    s_add_u32 m0, s65, 49152
    s_nop 0
    buffer_load_dwordx4 v84, s[48:51], s64 offen lds
    s_add_u32 m0, s65, 50176
    s_add_u32 s64, s64, 13824
    buffer_load_dwordx4 v84, s[48:51], s64 offen lds
    s_add_u32 m0, s65, 51200
    s_add_u32 s64, s64, 13824
    buffer_load_dwordx4 v84, s[48:51], s64 offen lds
    s_add_u32 m0, s65, 52224
    s_add_u32 s64, s64, 13824
    buffer_load_dwordx4 v84, s[48:51], s64 offen lds
    s_waitcnt vmcnt(8) lgkmcnt(0)
    s_barrier
    ds_read_b64_tr_b16 v[112:113], v224 offset:0
    ds_read_b64_tr_b16 v[114:115], v224 offset:1024
    ds_read_b128 v[80:83], v216 offset:0
    ds_read_b64_tr_b16 v[116:117], v225 offset:0
    ds_read_b64_tr_b16 v[118:119], v225 offset:1024
    ds_read_b128 v[84:87], v216 offset:4096
    ds_read_b64_tr_b16 v[120:121], v224 offset:4096
    ds_read_b64_tr_b16 v[122:123], v224 offset:5120
    ds_read_b128 v[88:91], v217 offset:0
    ds_read_b64_tr_b16 v[124:125], v225 offset:4096
    ds_read_b64_tr_b16 v[126:127], v225 offset:5120
    ds_read_b128 v[92:95], v217 offset:4096
    ds_read_b64_tr_b16 v[128:129], v224 offset:8192
    ds_read_b64_tr_b16 v[130:131], v224 offset:9216
    ds_read_b128 v[96:99], v218 offset:0
    ds_read_b64_tr_b16 v[132:133], v225 offset:8192
    ds_read_b64_tr_b16 v[134:135], v225 offset:9216
    ds_read_b128 v[100:103], v218 offset:4096
    ds_read_b64_tr_b16 v[136:137], v224 offset:12288
    ds_read_b64_tr_b16 v[138:139], v224 offset:13312
    ds_read_b128 v[104:107], v219 offset:0
    ds_read_b64_tr_b16 v[140:141], v225 offset:12288
    ds_read_b64_tr_b16 v[142:143], v225 offset:13312
    ds_read_b128 v[108:111], v219 offset:4096
    s_waitcnt lgkmcnt(0) vmcnt(0)
    s_barrier
    v_mfma_f32_32x32x16_bf16 v[16:31], v[112:115], v[80:83], 0
    ds_read_b64_tr_b16 v[176:177], v224 offset:32768
    ds_read_b64_tr_b16 v[178:179], v224 offset:33792
    v_mfma_f32_32x32x16_bf16 v[32:47], v[112:115], v[84:87], 0
    ds_read_b128 v[144:147], v216 offset:32768
    ds_read_b64_tr_b16 v[180:181], v225 offset:32768
    v_mfma_f32_32x32x16_bf16 v[48:63], v[116:119], v[80:83], 0
    ds_read_b64_tr_b16 v[182:183], v225 offset:33792
    ds_read_b128 v[148:151], v216 offset:36864
    v_mfma_f32_32x32x16_bf16 v[64:79], v[116:119], v[84:87], 0
    ds_read_b64_tr_b16 v[184:185], v224 offset:36864
    ds_read_b64_tr_b16 v[186:187], v224 offset:37888
    v_mfma_f32_32x32x16_bf16 v[16:31], v[120:123], v[88:91], v[16:31]
    ds_read_b128 v[152:155], v217 offset:32768
    ds_read_b64_tr_b16 v[188:189], v225 offset:36864
    v_mfma_f32_32x32x16_bf16 v[32:47], v[120:123], v[92:95], v[32:47]
    ds_read_b64_tr_b16 v[190:191], v225 offset:37888
    ds_read_b128 v[156:159], v217 offset:36864
    v_mfma_f32_32x32x16_bf16 v[48:63], v[124:127], v[88:91], v[48:63]
    ds_read_b64_tr_b16 v[192:193], v224 offset:40960
    ds_read_b64_tr_b16 v[194:195], v224 offset:41984
    v_mfma_f32_32x32x16_bf16 v[64:79], v[124:127], v[92:95], v[64:79]
    ds_read_b128 v[160:163], v218 offset:32768
    ds_read_b64_tr_b16 v[196:197], v225 offset:40960
    v_mfma_f32_32x32x16_bf16 v[16:31], v[128:131], v[96:99], v[16:31]
    ds_read_b64_tr_b16 v[198:199], v225 offset:41984
    ds_read_b128 v[164:167], v218 offset:36864
    v_mfma_f32_32x32x16_bf16 v[32:47], v[128:131], v[100:103], v[32:47]
    ds_read_b64_tr_b16 v[200:201], v224 offset:45056
    ds_read_b64_tr_b16 v[202:203], v224 offset:46080
    v_mfma_f32_32x32x16_bf16 v[48:63], v[132:135], v[96:99], v[48:63]
    ds_read_b128 v[168:171], v219 offset:32768
    ds_read_b64_tr_b16 v[204:205], v225 offset:45056
    v_mfma_f32_32x32x16_bf16 v[64:79], v[132:135], v[100:103], v[64:79]
    ds_read_b64_tr_b16 v[206:207], v225 offset:46080
    ds_read_b128 v[172:175], v219 offset:36864
    v_mfma_f32_32x32x16_bf16 v[16:31], v[136:139], v[104:107], v[16:31]
    v_mfma_f32_32x32x16_bf16 v[32:47], v[136:139], v[108:111], v[32:47]
    v_mfma_f32_32x32x16_bf16 v[48:63], v[140:143], v[104:107], v[48:63]
    v_mfma_f32_32x32x16_bf16 v[64:79], v[140:143], v[108:111], v[64:79]
    s_waitcnt lgkmcnt(0)
    s_barrier
    v_mfma_f32_32x32x16_bf16 v[16:31], v[176:179], v[144:147], v[16:31]
    ds_read_b64_tr_b16 v[112:113], v226 offset:0
    ds_read_b64_tr_b16 v[114:115], v226 offset:1024
    v_mfma_f32_32x32x16_bf16 v[32:47], v[176:179], v[148:151], v[32:47]
    ds_read_b128 v[80:83], v220 offset:0
    ds_read_b64_tr_b16 v[116:117], v227 offset:0
    v_mfma_f32_32x32x16_bf16 v[48:63], v[180:183], v[144:147], v[48:63]
    ds_read_b64_tr_b16 v[118:119], v227 offset:1024
    ds_read_b128 v[84:87], v220 offset:4096
    v_mfma_f32_32x32x16_bf16 v[64:79], v[180:183], v[148:151], v[64:79]
    ds_read_b64_tr_b16 v[120:121], v226 offset:4096
    ds_read_b64_tr_b16 v[122:123], v226 offset:5120
    v_mfma_f32_32x32x16_bf16 v[16:31], v[184:187], v[152:155], v[16:31]
    ds_read_b128 v[88:91], v221 offset:0
    ds_read_b64_tr_b16 v[124:125], v227 offset:4096
    v_mfma_f32_32x32x16_bf16 v[32:47], v[184:187], v[156:159], v[32:47]
    ds_read_b64_tr_b16 v[126:127], v227 offset:5120
    ds_read_b128 v[92:95], v221 offset:4096
    v_mfma_f32_32x32x16_bf16 v[48:63], v[188:191], v[152:155], v[48:63]
    ds_read_b64_tr_b16 v[128:129], v226 offset:8192
    ds_read_b64_tr_b16 v[130:131], v226 offset:9216
    v_mfma_f32_32x32x16_bf16 v[64:79], v[188:191], v[156:159], v[64:79]
    ds_read_b128 v[96:99], v222 offset:0
    ds_read_b64_tr_b16 v[132:133], v227 offset:8192
    v_mfma_f32_32x32x16_bf16 v[16:31], v[192:195], v[160:163], v[16:31]
    ds_read_b64_tr_b16 v[134:135], v227 offset:9216
    ds_read_b128 v[100:103], v222 offset:4096
    v_mfma_f32_32x32x16_bf16 v[32:47], v[192:195], v[164:167], v[32:47]
    ds_read_b64_tr_b16 v[136:137], v226 offset:12288
    ds_read_b64_tr_b16 v[138:139], v226 offset:13312
    v_mfma_f32_32x32x16_bf16 v[48:63], v[196:199], v[160:163], v[48:63]
    ds_read_b128 v[104:107], v223 offset:0
    ds_read_b64_tr_b16 v[140:141], v227 offset:12288
    v_mfma_f32_32x32x16_bf16 v[64:79], v[196:199], v[164:167], v[64:79]
    ds_read_b64_tr_b16 v[142:143], v227 offset:13312
    ds_read_b128 v[108:111], v223 offset:4096
    v_mfma_f32_32x32x16_bf16 v[16:31], v[200:203], v[168:171], v[16:31]
    v_mfma_f32_32x32x16_bf16 v[32:47], v[200:203], v[172:175], v[32:47]
    v_mfma_f32_32x32x16_bf16 v[48:63], v[204:207], v[168:171], v[48:63]
    v_mfma_f32_32x32x16_bf16 v[64:79], v[204:207], v[172:175], v[64:79]
    s_waitcnt lgkmcnt(0)
    s_barrier
    v_mfma_f32_32x32x16_bf16 v[16:31], v[112:115], v[80:83], v[16:31]
    ds_read_b64_tr_b16 v[176:177], v226 offset:32768
    ds_read_b64_tr_b16 v[178:179], v226 offset:33792
    v_mfma_f32_32x32x16_bf16 v[32:47], v[112:115], v[84:87], v[32:47]
    ds_read_b128 v[144:147], v220 offset:32768
    ds_read_b64_tr_b16 v[180:181], v227 offset:32768
    v_mfma_f32_32x32x16_bf16 v[48:63], v[116:119], v[80:83], v[48:63]
    ds_read_b64_tr_b16 v[182:183], v227 offset:33792
    ds_read_b128 v[148:151], v220 offset:36864
    v_mfma_f32_32x32x16_bf16 v[64:79], v[116:119], v[84:87], v[64:79]
    ds_read_b64_tr_b16 v[184:185], v226 offset:36864
    ds_read_b64_tr_b16 v[186:187], v226 offset:37888
    v_mfma_f32_32x32x16_bf16 v[16:31], v[120:123], v[88:91], v[16:31]
    ds_read_b128 v[152:155], v221 offset:32768
    ds_read_b64_tr_b16 v[188:189], v227 offset:36864
    v_mfma_f32_32x32x16_bf16 v[32:47], v[120:123], v[92:95], v[32:47]
    ds_read_b64_tr_b16 v[190:191], v227 offset:37888
    ds_read_b128 v[156:159], v221 offset:36864
    v_mfma_f32_32x32x16_bf16 v[48:63], v[124:127], v[88:91], v[48:63]
    ds_read_b64_tr_b16 v[192:193], v226 offset:40960
    ds_read_b64_tr_b16 v[194:195], v226 offset:41984
    v_mfma_f32_32x32x16_bf16 v[64:79], v[124:127], v[92:95], v[64:79]
    ds_read_b128 v[160:163], v222 offset:32768
    ds_read_b64_tr_b16 v[196:197], v227 offset:40960
    v_mfma_f32_32x32x16_bf16 v[16:31], v[128:131], v[96:99], v[16:31]
    ds_read_b64_tr_b16 v[198:199], v227 offset:41984
    ds_read_b128 v[164:167], v222 offset:36864
    v_mfma_f32_32x32x16_bf16 v[32:47], v[128:131], v[100:103], v[32:47]
    ds_read_b64_tr_b16 v[200:201], v226 offset:45056
    ds_read_b64_tr_b16 v[202:203], v226 offset:46080
    v_mfma_f32_32x32x16_bf16 v[48:63], v[132:135], v[96:99], v[48:63]
    ds_read_b128 v[168:171], v223 offset:32768
    ds_read_b64_tr_b16 v[204:205], v227 offset:45056
    v_mfma_f32_32x32x16_bf16 v[64:79], v[132:135], v[100:103], v[64:79]
    ds_read_b64_tr_b16 v[206:207], v227 offset:46080
    ds_read_b128 v[172:175], v223 offset:36864
    v_mfma_f32_32x32x16_bf16 v[16:31], v[136:139], v[104:107], v[16:31]
    v_mfma_f32_32x32x16_bf16 v[32:47], v[136:139], v[108:111], v[32:47]
    v_mfma_f32_32x32x16_bf16 v[48:63], v[140:143], v[104:107], v[48:63]
    v_mfma_f32_32x32x16_bf16 v[64:79], v[140:143], v[108:111], v[64:79]
    s_waitcnt lgkmcnt(0)
    s_barrier
    v_mfma_f32_32x32x16_bf16 v[16:31], v[176:179], v[144:147], v[16:31]
    ds_read_b64_tr_b16 v[112:113], v224 offset:0
    ds_read_b64_tr_b16 v[114:115], v224 offset:1024
    v_mfma_f32_32x32x16_bf16 v[32:47], v[176:179], v[148:151], v[32:47]
    ds_read_b128 v[80:83], v216 offset:0
    ds_read_b64_tr_b16 v[116:117], v225 offset:0
    v_mfma_f32_32x32x16_bf16 v[48:63], v[180:183], v[144:147], v[48:63]
    ds_read_b64_tr_b16 v[118:119], v225 offset:1024
    ds_read_b128 v[84:87], v216 offset:4096
    v_mfma_f32_32x32x16_bf16 v[64:79], v[180:183], v[148:151], v[64:79]
    ds_read_b64_tr_b16 v[120:121], v224 offset:4096
    ds_read_b64_tr_b16 v[122:123], v224 offset:5120
    v_mfma_f32_32x32x16_bf16 v[16:31], v[184:187], v[152:155], v[16:31]
    ds_read_b128 v[88:91], v217 offset:0
    ds_read_b64_tr_b16 v[124:125], v225 offset:4096
    v_mfma_f32_32x32x16_bf16 v[32:47], v[184:187], v[156:159], v[32:47]
    ds_read_b64_tr_b16 v[126:127], v225 offset:5120
    ds_read_b128 v[92:95], v217 offset:4096
    v_mfma_f32_32x32x16_bf16 v[48:63], v[188:191], v[152:155], v[48:63]
    ds_read_b64_tr_b16 v[128:129], v224 offset:8192
    ds_read_b64_tr_b16 v[130:131], v224 offset:9216
    v_mfma_f32_32x32x16_bf16 v[64:79], v[188:191], v[156:159], v[64:79]
    ds_read_b128 v[96:99], v218 offset:0
    ds_read_b64_tr_b16 v[132:133], v225 offset:8192
    v_mfma_f32_32x32x16_bf16 v[16:31], v[192:195], v[160:163], v[16:31]
    ds_read_b64_tr_b16 v[134:135], v225 offset:9216
    ds_read_b128 v[100:103], v218 offset:4096
    v_mfma_f32_32x32x16_bf16 v[32:47], v[192:195], v[164:167], v[32:47]
    ds_read_b64_tr_b16 v[136:137], v224 offset:12288
    ds_read_b64_tr_b16 v[138:139], v224 offset:13312
    v_mfma_f32_32x32x16_bf16 v[48:63], v[196:199], v[160:163], v[48:63]
    ds_read_b128 v[104:107], v219 offset:0
    ds_read_b64_tr_b16 v[140:141], v225 offset:12288
    v_mfma_f32_32x32x16_bf16 v[64:79], v[196:199], v[164:167], v[64:79]
    ds_read_b64_tr_b16 v[142:143], v225 offset:13312
    ds_read_b128 v[108:111], v219 offset:4096
    v_mfma_f32_32x32x16_bf16 v[16:31], v[200:203], v[168:171], v[16:31]
    v_mfma_f32_32x32x16_bf16 v[32:47], v[200:203], v[172:175], v[32:47]
    v_mfma_f32_32x32x16_bf16 v[48:63], v[204:207], v[168:171], v[48:63]
    v_mfma_f32_32x32x16_bf16 v[64:79], v[204:207], v[172:175], v[64:79]
    s_waitcnt lgkmcnt(0)
    s_barrier
    v_mfma_f32_32x32x16_bf16 v[16:31], v[112:115], v[80:83], v[16:31]
    ds_read_b64_tr_b16 v[176:177], v224 offset:32768
    ds_read_b64_tr_b16 v[178:179], v224 offset:33792
    v_mfma_f32_32x32x16_bf16 v[32:47], v[112:115], v[84:87], v[32:47]
    ds_read_b128 v[144:147], v216 offset:32768
    ds_read_b64_tr_b16 v[180:181], v225 offset:32768
    v_mfma_f32_32x32x16_bf16 v[48:63], v[116:119], v[80:83], v[48:63]
    ds_read_b64_tr_b16 v[182:183], v225 offset:33792
    ds_read_b128 v[148:151], v216 offset:36864
    v_mfma_f32_32x32x16_bf16 v[64:79], v[116:119], v[84:87], v[64:79]
    ds_read_b64_tr_b16 v[184:185], v224 offset:36864
    ds_read_b64_tr_b16 v[186:187], v224 offset:37888
    v_mfma_f32_32x32x16_bf16 v[16:31], v[120:123], v[88:91], v[16:31]
    ds_read_b128 v[152:155], v217 offset:32768
    ds_read_b64_tr_b16 v[188:189], v225 offset:36864
    v_mfma_f32_32x32x16_bf16 v[32:47], v[120:123], v[92:95], v[32:47]
    ds_read_b64_tr_b16 v[190:191], v225 offset:37888
    ds_read_b128 v[156:159], v217 offset:36864
    v_mfma_f32_32x32x16_bf16 v[48:63], v[124:127], v[88:91], v[48:63]
    ds_read_b64_tr_b16 v[192:193], v224 offset:40960
    ds_read_b64_tr_b16 v[194:195], v224 offset:41984
    v_mfma_f32_32x32x16_bf16 v[64:79], v[124:127], v[92:95], v[64:79]
    ds_read_b128 v[160:163], v218 offset:32768
    ds_read_b64_tr_b16 v[196:197], v225 offset:40960
    v_mfma_f32_32x32x16_bf16 v[16:31], v[128:131], v[96:99], v[16:31]
    ds_read_b64_tr_b16 v[198:199], v225 offset:41984
    ds_read_b128 v[164:167], v218 offset:36864
    v_mfma_f32_32x32x16_bf16 v[32:47], v[128:131], v[100:103], v[32:47]
    ds_read_b64_tr_b16 v[200:201], v224 offset:45056
    ds_read_b64_tr_b16 v[202:203], v224 offset:46080
    v_mfma_f32_32x32x16_bf16 v[48:63], v[132:135], v[96:99], v[48:63]
    ds_read_b128 v[168:171], v219 offset:32768
    ds_read_b64_tr_b16 v[204:205], v225 offset:45056
    v_mfma_f32_32x32x16_bf16 v[64:79], v[132:135], v[100:103], v[64:79]
    ds_read_b64_tr_b16 v[206:207], v225 offset:46080
    ds_read_b128 v[172:175], v219 offset:36864
    v_mfma_f32_32x32x16_bf16 v[16:31], v[136:139], v[104:107], v[16:31]
    v_mfma_f32_32x32x16_bf16 v[32:47], v[136:139], v[108:111], v[32:47]
    v_mfma_f32_32x32x16_bf16 v[48:63], v[140:143], v[104:107], v[48:63]
    v_mfma_f32_32x32x16_bf16 v[64:79], v[140:143], v[108:111], v[64:79]
    s_waitcnt lgkmcnt(0)
    s_barrier
    v_mfma_f32_32x32x16_bf16 v[16:31], v[176:179], v[144:147], v[16:31]
    ds_read_b64_tr_b16 v[112:113], v226 offset:0
    ds_read_b64_tr_b16 v[114:115], v226 offset:1024
    v_mfma_f32_32x32x16_bf16 v[32:47], v[176:179], v[148:151], v[32:47]
    ds_read_b128 v[80:83], v220 offset:0
    ds_read_b64_tr_b16 v[116:117], v227 offset:0
    v_mfma_f32_32x32x16_bf16 v[48:63], v[180:183], v[144:147], v[48:63]
    ds_read_b64_tr_b16 v[118:119], v227 offset:1024
    ds_read_b128 v[84:87], v220 offset:4096
    v_mfma_f32_32x32x16_bf16 v[64:79], v[180:183], v[148:151], v[64:79]
    ds_read_b64_tr_b16 v[120:121], v226 offset:4096
    ds_read_b64_tr_b16 v[122:123], v226 offset:5120
    v_mfma_f32_32x32x16_bf16 v[16:31], v[184:187], v[152:155], v[16:31]
    ds_read_b128 v[88:91], v221 offset:0
    ds_read_b64_tr_b16 v[124:125], v227 offset:4096
    v_mfma_f32_32x32x16_bf16 v[32:47], v[184:187], v[156:159], v[32:47]
    ds_read_b64_tr_b16 v[126:127], v227 offset:5120
    ds_read_b128 v[92:95], v221 offset:4096
    v_mfma_f32_32x32x16_bf16 v[48:63], v[188:191], v[152:155], v[48:63]
    ds_read_b64_tr_b16 v[128:129], v226 offset:8192
    ds_read_b64_tr_b16 v[130:131], v226 offset:9216
    v_mfma_f32_32x32x16_bf16 v[64:79], v[188:191], v[156:159], v[64:79]
    ds_read_b128 v[96:99], v222 offset:0
    ds_read_b64_tr_b16 v[132:133], v227 offset:8192
    v_mfma_f32_32x32x16_bf16 v[16:31], v[192:195], v[160:163], v[16:31]
    ds_read_b64_tr_b16 v[134:135], v227 offset:9216
    ds_read_b128 v[100:103], v222 offset:4096
    v_mfma_f32_32x32x16_bf16 v[32:47], v[192:195], v[164:167], v[32:47]
    ds_read_b64_tr_b16 v[136:137], v226 offset:12288
    ds_read_b64_tr_b16 v[138:139], v226 offset:13312
    v_mfma_f32_32x32x16_bf16 v[48:63], v[196:199], v[160:163], v[48:63]
    ds_read_b128 v[104:107], v223 offset:0
    ds_read_b64_tr_b16 v[140:141], v227 offset:12288
    v_mfma_f32_32x32x16_bf16 v[64:79], v[196:199], v[164:167], v[64:79]
    ds_read_b64_tr_b16 v[142:143], v227 offset:13312
    ds_read_b128 v[108:111], v223 offset:4096
    v_mfma_f32_32x32x16_bf16 v[16:31], v[200:203], v[168:171], v[16:31]
    v_mfma_f32_32x32x16_bf16 v[32:47], v[200:203], v[172:175], v[32:47]
    v_mfma_f32_32x32x16_bf16 v[48:63], v[204:207], v[168:171], v[48:63]
    v_mfma_f32_32x32x16_bf16 v[64:79], v[204:207], v[172:175], v[64:79]
    s_waitcnt lgkmcnt(0)
    s_barrier
    v_mfma_f32_32x32x16_bf16 v[16:31], v[112:115], v[80:83], v[16:31]
    ds_read_b64_tr_b16 v[176:177], v226 offset:32768
    ds_read_b64_tr_b16 v[178:179], v226 offset:33792
    v_mfma_f32_32x32x16_bf16 v[32:47], v[112:115], v[84:87], v[32:47]
    ds_read_b128 v[144:147], v220 offset:32768
    ds_read_b64_tr_b16 v[180:181], v227 offset:32768
    v_mfma_f32_32x32x16_bf16 v[48:63], v[116:119], v[80:83], v[48:63]
    ds_read_b64_tr_b16 v[182:183], v227 offset:33792
    ds_read_b128 v[148:151], v220 offset:36864
    v_mfma_f32_32x32x16_bf16 v[64:79], v[116:119], v[84:87], v[64:79]
    ds_read_b64_tr_b16 v[184:185], v226 offset:36864
    ds_read_b64_tr_b16 v[186:187], v226 offset:37888
    v_mfma_f32_32x32x16_bf16 v[16:31], v[120:123], v[88:91], v[16:31]
    ds_read_b128 v[152:155], v221 offset:32768
    ds_read_b64_tr_b16 v[188:189], v227 offset:36864
    v_mfma_f32_32x32x16_bf16 v[32:47], v[120:123], v[92:95], v[32:47]
    ds_read_b64_tr_b16 v[190:191], v227 offset:37888
    ds_read_b128 v[156:159], v221 offset:36864
    v_mfma_f32_32x32x16_bf16 v[48:63], v[124:127], v[88:91], v[48:63]
    ds_read_b64_tr_b16 v[192:193], v226 offset:40960
    ds_read_b64_tr_b16 v[194:195], v226 offset:41984
    v_mfma_f32_32x32x16_bf16 v[64:79], v[124:127], v[92:95], v[64:79]
    ds_read_b128 v[160:163], v222 offset:32768
    ds_read_b64_tr_b16 v[196:197], v227 offset:40960
    v_mfma_f32_32x32x16_bf16 v[16:31], v[128:131], v[96:99], v[16:31]
    ds_read_b64_tr_b16 v[198:199], v227 offset:41984
    ds_read_b128 v[164:167], v222 offset:36864
    v_mfma_f32_32x32x16_bf16 v[32:47], v[128:131], v[100:103], v[32:47]
    ds_read_b64_tr_b16 v[200:201], v226 offset:45056
    ds_read_b64_tr_b16 v[202:203], v226 offset:46080
    v_mfma_f32_32x32x16_bf16 v[48:63], v[132:135], v[96:99], v[48:63]
    ds_read_b128 v[168:171], v223 offset:32768
    ds_read_b64_tr_b16 v[204:205], v227 offset:45056
    v_mfma_f32_32x32x16_bf16 v[64:79], v[132:135], v[100:103], v[64:79]
    ds_read_b64_tr_b16 v[206:207], v227 offset:46080
    ds_read_b128 v[172:175], v223 offset:36864
    v_mfma_f32_32x32x16_bf16 v[16:31], v[136:139], v[104:107], v[16:31]
    v_mfma_f32_32x32x16_bf16 v[32:47], v[136:139], v[108:111], v[32:47]
    v_mfma_f32_32x32x16_bf16 v[48:63], v[140:143], v[104:107], v[48:63]
    v_mfma_f32_32x32x16_bf16 v[64:79], v[140:143], v[108:111], v[64:79]
    s_waitcnt lgkmcnt(0)
    s_barrier
    v_mfma_f32_32x32x16_bf16 v[16:31], v[176:179], v[144:147], v[16:31]
    ds_read_b64_tr_b16 v[112:113], v224 offset:0
    ds_read_b64_tr_b16 v[114:115], v224 offset:1024
    v_mov_b32 v250, 0
    global_load_dword v251, v250, s[34:35] sc1
    v_mfma_f32_32x32x16_bf16 v[32:47], v[176:179], v[148:151], v[32:47]
    ds_read_b128 v[80:83], v216 offset:0
    ds_read_b64_tr_b16 v[116:117], v225 offset:0
    v_mfma_f32_32x32x16_bf16 v[48:63], v[180:183], v[144:147], v[48:63]
    ds_read_b64_tr_b16 v[118:119], v225 offset:1024
    ds_read_b128 v[84:87], v216 offset:4096
    v_mfma_f32_32x32x16_bf16 v[64:79], v[180:183], v[148:151], v[64:79]
    ds_read_b64_tr_b16 v[120:121], v224 offset:4096
    ds_read_b64_tr_b16 v[122:123], v224 offset:5120
    v_mfma_f32_32x32x16_bf16 v[16:31], v[184:187], v[152:155], v[16:31]
    ds_read_b128 v[88:91], v217 offset:0
    ds_read_b64_tr_b16 v[124:125], v225 offset:4096
    v_mfma_f32_32x32x16_bf16 v[32:47], v[184:187], v[156:159], v[32:47]
    ds_read_b64_tr_b16 v[126:127], v225 offset:5120
    ds_read_b128 v[92:95], v217 offset:4096
    v_mfma_f32_32x32x16_bf16 v[48:63], v[188:191], v[152:155], v[48:63]
    ds_read_b64_tr_b16 v[128:129], v224 offset:8192
    ds_read_b64_tr_b16 v[130:131], v224 offset:9216
    v_mfma_f32_32x32x16_bf16 v[64:79], v[188:191], v[156:159], v[64:79]
    ds_read_b128 v[96:99], v218 offset:0
    ds_read_b64_tr_b16 v[132:133], v225 offset:8192
    v_mfma_f32_32x32x16_bf16 v[16:31], v[192:195], v[160:163], v[16:31]
    ds_read_b64_tr_b16 v[134:135], v225 offset:9216
    ds_read_b128 v[100:103], v218 offset:4096
    v_mfma_f32_32x32x16_bf16 v[32:47], v[192:195], v[164:167], v[32:47]
    ds_read_b64_tr_b16 v[136:137], v224 offset:12288
    ds_read_b64_tr_b16 v[138:139], v224 offset:13312
    v_mfma_f32_32x32x16_bf16 v[48:63], v[196:199], v[160:163], v[48:63]
    ds_read_b128 v[104:107], v219 offset:0
    ds_read_b64_tr_b16 v[140:141], v225 offset:12288
    v_mfma_f32_32x32x16_bf16 v[64:79], v[196:199], v[164:167], v[64:79]
    ds_read_b64_tr_b16 v[142:143], v225 offset:13312
    ds_read_b128 v[108:111], v219 offset:4096
    v_mfma_f32_32x32x16_bf16 v[16:31], v[200:203], v[168:171], v[16:31]
    v_mfma_f32_32x32x16_bf16 v[32:47], v[200:203], v[172:175], v[32:47]
    v_mfma_f32_32x32x16_bf16 v[48:63], v[204:207], v[168:171], v[48:63]
    v_mfma_f32_32x32x16_bf16 v[64:79], v[204:207], v[172:175], v[64:79]
    s_waitcnt lgkmcnt(0)
    v_mov_b32 v8, 163756
    v_mov_b32 v9, 1
    s_mov_b64 exec, 1
    ds_add_u32 v8, v9
    s_mov_b64 exec, -1
    s_cmp_eq_u32 s66, 1
    s_cbranch_scc1 L_p1_extra
    v_mfma_f32_32x32x16_bf16 v[16:31], v[112:115], v[80:83], v[16:31]
    v_mfma_f32_32x32x16_bf16 v[16:31], v[120:123], v[88:91], v[16:31]
    v_mfma_f32_32x32x16_bf16 v[16:31], v[128:131], v[96:99], v[16:31]
    v_mfma_f32_32x32x16_bf16 v[16:31], v[136:139], v[104:107], v[16:31]
    v_mfma_f32_32x32x16_bf16 v[32:47], v[112:115], v[84:87], v[32:47]
    v_mfma_f32_32x32x16_bf16 v[32:47], v[120:123], v[92:95], v[32:47]
    v_mfma_f32_32x32x16_bf16 v[32:47], v[128:131], v[100:103], v[32:47]
    v_mfma_f32_32x32x16_bf16 v[32:47], v[136:139], v[108:111], v[32:47]
    v_mfma_f32_32x32x16_bf16 v[48:63], v[116:119], v[80:83], v[48:63]
    s_nop 6
    v_pk_mul_f32 v[16:17], v[16:17], s[10:11] op_sel_hi:[1,0]
    v_pk_mul_f32 v[18:19], v[18:19], s[10:11] op_sel_hi:[1,0]
    v_pk_mul_f32 v[20:21], v[20:21], s[10:11] op_sel_hi:[1,0]
    v_pk_mul_f32 v[22:23], v[22:23], s[10:11] op_sel_hi:[1,0]
    v_cvt_pk_bf16_f32 v144, v16, v17
    v_mfma_f32_32x32x16_bf16 v[48:63], v[124:127], v[88:91], v[48:63]
    v_cvt_pk_bf16_f32 v145, v18, v19
    v_cvt_pk_bf16_f32 v146, v20, v21
    v_cvt_pk_bf16_f32 v147, v22, v23
    buffer_store_dwordx4 v[144:147], v1, s[52:55], s11 offen offset:0 sc1
    v_pk_mul_f32 v[24:25], v[24:25], s[14:15] op_sel_hi:[1,0]
    v_mfma_f32_32x32x16_bf16 v[48:63], v[132:135], v[96:99], v[48:63]
    v_pk_mul_f32 v[26:27], v[26:27], s[14:15] op_sel_hi:[1,0]
    v_pk_mul_f32 v[28:29], v[28:29], s[14:15] op_sel_hi:[1,0]
    v_pk_mul_f32 v[30:31], v[30:31], s[14:15] op_sel_hi:[1,0]
    v_cvt_pk_bf16_f32 v148, v24, v25
    v_cvt_pk_bf16_f32 v149, v26, v27
    v_mfma_f32_32x32x16_bf16 v[48:63], v[140:143], v[104:107], v[48:63]
    v_cvt_pk_bf16_f32 v150, v28, v29
    v_cvt_pk_bf16_f32 v151, v30, v31
    buffer_store_dwordx4 v[148:151], v1, s[52:55], s15 offen offset:0 sc1
    v_mfma_f32_32x32x16_bf16 v[64:79], v[116:119], v[84:87], v[64:79]
    v_pk_mul_f32 v[32:33], v[32:33], s[10:11] op_sel_hi:[1,0]
    v_pk_mul_f32 v[34:35], v[34:35], s[10:11] op_sel_hi:[1,0]
    v_pk_mul_f32 v[36:37], v[36:37], s[10:11] op_sel_hi:[1,0]
    v_pk_mul_f32 v[38:39], v[38:39], s[10:11] op_sel_hi:[1,0]
    v_cvt_pk_bf16_f32 v152, v32, v33
    v_mfma_f32_32x32x16_bf16 v[64:79], v[124:127], v[92:95], v[64:79]
    v_cvt_pk_bf16_f32 v153, v34, v35
    v_cvt_pk_bf16_f32 v154, v36, v37
    v_cvt_pk_bf16_f32 v155, v38, v39
    buffer_store_dwordx4 v[152:155], v1, s[52:55], s11 offen offset:1024 sc1
    v_pk_mul_f32 v[40:41], v[40:41], s[14:15] op_sel_hi:[1,0]
    v_mfma_f32_32x32x16_bf16 v[64:79], v[132:135], v[100:103], v[64:79]
    v_pk_mul_f32 v[42:43], v[42:43], s[14:15] op_sel_hi:[1,0]
    v_pk_mul_f32 v[44:45], v[44:45], s[14:15] op_sel_hi:[1,0]
    v_pk_mul_f32 v[46:47], v[46:47], s[14:15] op_sel_hi:[1,0]
    v_cvt_pk_bf16_f32 v156, v40, v41
    v_cvt_pk_bf16_f32 v157, v42, v43
    v_mfma_f32_32x32x16_bf16 v[64:79], v[140:143], v[108:111], v[64:79]
    v_cvt_pk_bf16_f32 v158, v44, v45
    v_cvt_pk_bf16_f32 v159, v46, v47
    buffer_store_dwordx4 v[156:159], v1, s[52:55], s15 offen offset:1024 sc1
    v_pk_mul_f32 v[48:49], v[48:49], s[18:19] op_sel_hi:[1,0]
    v_pk_mul_f32 v[50:51], v[50:51], s[18:19] op_sel_hi:[1,0]
    v_pk_mul_f32 v[52:53], v[52:53], s[18:19] op_sel_hi:[1,0]
    v_pk_mul_f32 v[54:55], v[54:55], s[18:19] op_sel_hi:[1,0]
    v_cvt_pk_bf16_f32 v160, v48, v49
    v_cvt_pk_bf16_f32 v161, v50, v51
    v_cvt_pk_bf16_f32 v162, v52, v53
    v_cvt_pk_bf16_f32 v163, v54, v55
    buffer_store_dwordx4 v[160:163], v1, s[52:55], s19 offen offset:0 sc1
    v_pk_mul_f32 v[56:57], v[56:57], s[22:23] op_sel_hi:[1,0]
    v_pk_mul_f32 v[58:59], v[58:59], s[22:23] op_sel_hi:[1,0]
    v_pk_mul_f32 v[60:61], v[60:61], s[22:23] op_sel_hi:[1,0]
    v_pk_mul_f32 v[62:63], v[62:63], s[22:23] op_sel_hi:[1,0]
    v_cvt_pk_bf16_f32 v164, v56, v57
    v_cvt_pk_bf16_f32 v165, v58, v59
    v_cvt_pk_bf16_f32 v166, v60, v61
    v_cvt_pk_bf16_f32 v167, v62, v63
    buffer_store_dwordx4 v[164:167], v1, s[52:55], s23 offen offset:0 sc1
    v_pk_mul_f32 v[64:65], v[64:65], s[18:19] op_sel_hi:[1,0]
    v_pk_mul_f32 v[66:67], v[66:67], s[18:19] op_sel_hi:[1,0]
    v_pk_mul_f32 v[68:69], v[68:69], s[18:19] op_sel_hi:[1,0]
    v_pk_mul_f32 v[70:71], v[70:71], s[18:19] op_sel_hi:[1,0]
    v_cvt_pk_bf16_f32 v168, v64, v65
    v_cvt_pk_bf16_f32 v169, v66, v67
    v_cvt_pk_bf16_f32 v170, v68, v69
    v_cvt_pk_bf16_f32 v171, v70, v71
    buffer_store_dwordx4 v[168:171], v1, s[52:55], s19 offen offset:1024 sc1
    v_pk_mul_f32 v[72:73], v[72:73], s[22:23] op_sel_hi:[1,0]
    v_pk_mul_f32 v[74:75], v[74:75], s[22:23] op_sel_hi:[1,0]
    v_pk_mul_f32 v[76:77], v[76:77], s[22:23] op_sel_hi:[1,0]
    v_pk_mul_f32 v[78:79], v[78:79], s[22:23] op_sel_hi:[1,0]
    v_cvt_pk_bf16_f32 v172, v72, v73
    v_cvt_pk_bf16_f32 v173, v74, v75
    v_cvt_pk_bf16_f32 v174, v76, v77
    v_cvt_pk_bf16_f32 v175, v78, v79
    buffer_store_dwordx4 v[172:175], v1, s[52:55], s23 offen offset:1024 sc1
    s_branch L_p1_done
L_p1_extra:
    v_mfma_f32_32x32x16_bf16 v[16:31], v[112:115], v[80:83], v[16:31]
    v_lshlrev_b32 v178, 2, v0
    v_mfma_f32_32x32x16_bf16 v[16:31], v[120:123], v[88:91], v[16:31]
    v_lshlrev_b32 v179, 3, v0
    v_mfma_f32_32x32x16_bf16 v[16:31], v[128:131], v[96:99], v[16:31]
    v_mfma_f32_32x32x16_bf16 v[16:31], v[136:139], v[104:107], v[16:31]
    v_mfma_f32_32x32x16_bf16 v[32:47], v[112:115], v[84:87], v[32:47]
    v_mfma_f32_32x32x16_bf16 v[32:47], v[120:123], v[92:95], v[32:47]
    v_mfma_f32_32x32x16_bf16 v[32:47], v[128:131], v[100:103], v[32:47]
    v_mfma_f32_32x32x16_bf16 v[32:47], v[136:139], v[108:111], v[32:47]
    v_mfma_f32_32x32x16_bf16 v[48:63], v[116:119], v[80:83], v[48:63]
    s_nop 6
    v_pk_mul_f32 v[16:17], v[16:17], s[10:11] op_sel_hi:[1,0]
    v_pk_mul_f32 v[18:19], v[18:19], s[10:11] op_sel_hi:[1,0]
    v_pk_mul_f32 v[20:21], v[20:21], s[10:11] op_sel_hi:[1,0]
    v_mfma_f32_32x32x16_bf16 v[48:63], v[124:127], v[88:91], v[48:63]
    v_pk_mul_f32 v[22:23], v[22:23], s[10:11] op_sel_hi:[1,0]
    v_cvt_pk_bf16_f32 v144, v16, v17
    v_cvt_pk_bf16_f32 v145, v18, v19
    v_mfma_f32_32x32x16_bf16 v[48:63], v[132:135], v[96:99], v[48:63]
    v_cvt_pk_bf16_f32 v146, v20, v21
    v_cvt_pk_bf16_f32 v147, v22, v23
    buffer_store_dwordx4 v[144:147], v1, s[52:55], s11 offen offset:0 sc1
    v_mfma_f32_32x32x16_bf16 v[48:63], v[140:143], v[104:107], v[48:63]
    v_mfma_f32_32x32x16_bf16 v[64:79], v[116:119], v[84:87], v[64:79]
    v_pk_mul_f32 v[32:33], v[32:33], s[10:11] op_sel_hi:[1,0]
    v_pk_mul_f32 v[34:35], v[34:35], s[10:11] op_sel_hi:[1,0]
    v_pk_mul_f32 v[36:37], v[36:37], s[10:11] op_sel_hi:[1,0]
    v_pk_mul_f32 v[38:39], v[38:39], s[10:11] op_sel_hi:[1,0]
    v_cvt_pk_bf16_f32 v152, v32, v33
    v_mfma_f32_32x32x16_bf16 v[64:79], v[124:127], v[92:95], v[64:79]
    v_cvt_pk_bf16_f32 v153, v34, v35
    v_cvt_pk_bf16_f32 v154, v36, v37
    v_cvt_pk_bf16_f32 v155, v38, v39
    buffer_store_dwordx4 v[152:155], v1, s[52:55], s11 offen offset:1024 sc1
    v_permlane32_swap_b32 v24, v40
    v_mfma_f32_32x32x16_bf16 v[64:79], v[132:135], v[100:103], v[64:79]
    v_permlane32_swap_b32 v25, v41
    v_permlane32_swap_b32 v26, v42
    v_permlane32_swap_b32 v27, v43
    v_permlane32_swap_b32 v28, v44
    v_permlane32_swap_b32 v29, v45
    v_mfma_f32_32x32x16_bf16 v[64:79], v[140:143], v[108:111], v[64:79]
    v_permlane32_swap_b32 v30, v46
    v_permlane32_swap_b32 v31, v47
    v_pk_mul_f32 v[48:49], v[48:49], s[14:15] op_sel_hi:[1,0]
    v_pk_mul_f32 v[50:51], v[50:51], s[14:15] op_sel_hi:[1,0]
    v_pk_mul_f32 v[52:53], v[52:53], s[14:15] op_sel_hi:[1,0]
    v_pk_mul_f32 v[54:55], v[54:55], s[14:15] op_sel_hi:[1,0]
    v_cvt_pk_bf16_f32 v160, v48, v49
    v_cvt_pk_bf16_f32 v161, v50, v51
    v_cvt_pk_bf16_f32 v162, v52, v53
    v_cvt_pk_bf16_f32 v163, v54, v55
    buffer_store_dwordx4 v[160:163], v1, s[52:55], s15 offen offset:0 sc1
    v_pk_mul_f32 v[24:25], v[24:25], s[18:19] op_sel_hi:[1,0]
    v_pk_mul_f32 v[26:27], v[26:27], s[18:19] op_sel_hi:[1,0]
    v_mov_b32 v181, 0x3f80
    v_mov_b32 v183, 0x3f80
    v_cvt_pk_bf16_f32 v180, v24, v25
    v_cvt_pk_bf16_f32 v182, v26, v27
    s_cmp_eq_u32 s21, 2
    s_cbranch_scc1 L_p1_xv0
    buffer_store_dword v180, v178, s[52:55], s19 offen sc1
    buffer_store_dword v182, v178, s[52:55], s20 offen sc1
    s_branch L_p1_xe0
L_p1_xv0:
    buffer_store_dwordx2 v[180:181], v179, s[52:55], s19 offen sc1
    buffer_store_dwordx2 v[182:183], v179, s[52:55], s20 offen sc1
L_p1_xe0:
    v_pk_mul_f32 v[40:41], v[40:41], s[22:23] op_sel_hi:[1,0]
    v_pk_mul_f32 v[42:43], v[42:43], s[22:23] op_sel_hi:[1,0]
    v_mov_b32 v185, 0x3f80
    v_mov_b32 v187, 0x3f80
    v_cvt_pk_bf16_f32 v184, v40, v41
    v_cvt_pk_bf16_f32 v186, v42, v43
    s_cmp_eq_u32 s25, 2
    s_cbranch_scc1 L_p1_xv1
    buffer_store_dword v184, v178, s[52:55], s23 offen sc1
    buffer_store_dword v186, v178, s[52:55], s24 offen sc1
    s_branch L_p1_xe1
L_p1_xv1:
    buffer_store_dwordx2 v[184:185], v179, s[52:55], s23 offen sc1
    buffer_store_dwordx2 v[186:187], v179, s[52:55], s24 offen sc1
L_p1_xe1:
    v_pk_mul_f32 v[64:65], v[64:65], s[14:15] op_sel_hi:[1,0]
    v_pk_mul_f32 v[66:67], v[66:67], s[14:15] op_sel_hi:[1,0]
    v_pk_mul_f32 v[68:69], v[68:69], s[14:15] op_sel_hi:[1,0]
    v_pk_mul_f32 v[70:71], v[70:71], s[14:15] op_sel_hi:[1,0]
    v_cvt_pk_bf16_f32 v168, v64, v65
    v_cvt_pk_bf16_f32 v169, v66, v67
    v_cvt_pk_bf16_f32 v170, v68, v69
    v_cvt_pk_bf16_f32 v171, v70, v71
    buffer_store_dwordx4 v[168:171], v1, s[52:55], s15 offen offset:1024 sc1
    v_pk_mul_f32 v[28:29], v[28:29], s[26:27] op_sel_hi:[1,0]
    v_pk_mul_f32 v[30:31], v[30:31], s[26:27] op_sel_hi:[1,0]
    v_mov_b32 v189, 0x3f80
    v_mov_b32 v191, 0x3f80
    v_cvt_pk_bf16_f32 v188, v28, v29
    v_cvt_pk_bf16_f32 v190, v30, v31
    s_cmp_eq_u32 s29, 2
    s_cbranch_scc1 L_p1_xv2
    buffer_store_dword v188, v178, s[52:55], s27 offen sc1
    buffer_store_dword v190, v178, s[52:55], s28 offen sc1
    s_branch L_p1_xe2
L_p1_xv2:
    buffer_store_dwordx2 v[188:189], v179, s[52:55], s27 offen sc1
    buffer_store_dwordx2 v[190:191], v179, s[52:55], s28 offen sc1
L_p1_xe2:
L_p1_done:
    v_lshrrev_b32 v16, 4, v0
    v_min_u32 v16, 2, v16
    v_lshlrev_b32 v16, 5, v16
    v_add_u32 v16, s56, v16
    v_mul_u32_u24 v16, 10923, v16
    v_lshrrev_b32 v16, 16, v16
    v_and_b32 v17, 15, v0
    v_lshl_add_u32 v16, v16, 4, v17
    v_lshlrev_b32 v16, 7, v16
    s_lshl_b32 s62, s5, 4
    s_add_u32 s62, s62, s4
    s_lshl_b32 s62, s62, 7
    s_add_u32 s62, s62, 393216
    s_mov_b32 s63, 393216
    s_lshr_b32 s66, s3, 1
    v_lshrrev_b32 v196, 5, v0
    v_bfe_u32 v197, v0, 2, 2
    v_lshl_add_u32 v198, v196, 3, v197
    v_lshlrev_b32 v198, 7, v198
    v_lshrrev_b32 v197, 1, v197
    v_xor_b32 v197, s66, v197
    v_lshl_add_u32 v198, v197, 6, v198
    v_and_b32 v197, 1, v0
    v_lshl_add_u32 v198, v197, 5, v198
    v_and_b32 v197, 16, v0
    v_add_u32 v198, v198, v197
    v_and_b32 v197, 2, v0
    v_lshl_add_u32 v198, v197, 2, v198
    s_lshl_b32 s68, s66, 15
    s_add_u32 s68, s68, 24576
    v_add_u32 v160, s68, v198
    v_xor_b32 v161, 64, v160
    s_lshl_b32 s68, s66, 12
    s_add_u32 s68, s68, 90112
    v_add_u32 v162, s68, v198
    v_xor_b32 v163, 64, v162
    s_lshl_b32 s67, s39, 3
    s_lshl_b32 s68, s43, 1
    s_add_u32 s67, s67, s68
    s_and_b32 s68, s3, 1
    s_add_u32 s67, s67, s68
    s_mul_i32 s10, s67, 36864
    s_add_u32 s10, s10, 8060928
    s_lshl_b32 s11, s66, 11
    s_add_u32 s11, s11, s10
    s_add_u32 s11, s11, 32768
    s_lshl_b32 s68, s66, 14
    s_add_u32 s10, s10, s68
    v_lshlrev_b32 v164, 4, v0
    s_lshr_b32 s69, s38, 2
    s_mul_i32 s69, s69, 3072
    s_mul_i32 s68, s3, 6144
    s_add_u32 s68, s68, s69
    v_add_u32 v165, s68, v164
    s_mov_b32 s68, 155648
    s_cmp_ge_u32 s38, 4
    s_cmov_b32 s68, 114688
    s_lshl_b32 s70, s38, 10
    s_add_u32 s68, s68, s70
    v_add_u32 v167, s68, v164
    v_xor_b32 v168, 2048, v167
    s_xor_b32 s68, s3, 2
    s_mul_i32 s68, s68, 6144
    s_add_u32 s68, s68, s69
    v_add_u32 v166, s68, v164
    v_and_b32 v197, 31, v0
    v_lshlrev_b32 v198, 1, v196
    v_bfe_u32 v199, v0, 1, 2
    v_xor_b32 v198, v198, v199
    v_lshlrev_b32 v198, 4, v198
    v_lshl_add_u32 v198, v197, 6, v198
    v_add_u32 v169, s68, v198
    v_xor_b32 v170, 16, v169
    v_lshlrev_b32 v197, 2, v197
    v_lshl_add_u32 v174, v196, 9, v197
    v_lshrrev_b32 v197, 2, v0
    v_and_b32 v198, 3, v0
    v_bfe_u32 v199, v0, 3, 2
    v_xor_b32 v199, v198, v199
    v_lshlrev_b32 v199, 4, v199
    v_lshl_add_u32 v199, v197, 6, v199
    v_add_u32 v171, s68, v199
    v_mul_u32_u24 v197, 2304, v197
    v_lshl_add_u32 v197, v198, 4, v197
    s_mul_i32 s68, s67, 73728
    s_lshl_b32 s69, s42, 7
    s_add_u32 s68, s68, s69
    s_lshl_b32 s69, s66, 6
    s_add_u32 s68, s68, s69
    s_add_u32 s68, s68, 1152
    v_add_u32 v172, s68, v197
    v_add_u32 v173, 36864, v172
    s_lshl_b32 s68, s38, 2
    s_add_u32 s68, s68, 163716
    v_mov_b32 v175, s68
    s_xor_b32 s68, s38, 2
    s_lshl_b32 s68, s68, 2
    s_add_u32 s68, s68, 163716
    v_mov_b32 v176, s68
    v_and_b32 v177, 15, v0
    v_lshlrev_b32 v177, 5, v177
    s_lshr_b32 s12, s67, 1
    s_lshl_b32 s12, s12, 10
    s_lshl_b32 s68, s66, 9
    s_add_u32 s12, s12, s68
    s_add_u32 s12, s12, 425984
    s_mul_i32 s68, s3, 512
    s_add_u32 s68, s68, 3072
    v_lshl_add_u32 v178, v0, 3, s68
    s_mul_i32 s68, s3, 589824
    s_lshl_b32 s69, s58, 1
    s_add_u32 s68, s68, s69
    v_mul_u32_u24 v179, 9216, v0
    v_add_u32 v179, s68, v179
    v_and_b32 v196, 15, v0
    v_lshrrev_b32 v197, 4, v0
    v_lshlrev_b32 v198, 4, v197
    v_lshl_add_u32 v199, v196, 5, v198
    s_mul_i32 s68, s3, 4608
    s_add_u32 s68, s68, 98304
    v_add_u32 v182, s68, v199
    v_lshlrev_b32 v199, 1, v196
    v_sub_u32 v198, v198, v199
    v_add_u32 v199, 1, v0
    v_and_b32 v199, 3, v199
    v_mul_u32_u24 v199, 2242, v199
    s_mul_i32 s68, s3, 9728
    s_add_u32 s68, s68, 116766
    v_add3_u32 v180, v198, v199, s68
    v_lshlrev_b32 v197, 3, v197
    v_lshl_add_u32 v197, v196, 5, v197
    s_mul_i32 s68, s3, 6144
    s_add_u32 s68, s68, 3072
    v_add_u32 v183, s68, v197
    s_waitcnt vmcnt(0)
    v_mov_b32 v18, 163712
    v_mov_b32 v19, 1
    s_mov_b64 exec, 1
    ds_add_u32 v18, v19
    s_mov_b64 exec, -1
    s_cmp_lg_u32 s38, 0
    s_cbranch_scc1 L_sync1_other
    s_mov_b32 s61, 400000
    v_mov_b32 v250, 0
L_rdy_f1:
    v_cmp_le_u32 vcc, 16, v251
    s_sub_u32 s61, s61, 1
    s_cmp_eq_u32 s61, 0
    s_cbranch_scc1 L_rdyok_f1
    s_cbranch_vccnz L_rdyok_f1
    global_load_dword v251, v250, s[34:35] sc1
    s_waitcnt vmcnt(0)
    s_branch L_rdy_f1
L_rdyok_f1:
    s_mov_b32 s61, 3200000
L_spin_drain:
    ds_read_b32 v19, v18
    s_sub_u32 s61, s61, 1
    s_cmp_eq_u32 s61, 0
    s_cbranch_scc1 L_spun_drain
    s_waitcnt lgkmcnt(0)
    v_cmp_gt_u32 vcc, 4, v19
    s_nop 0
    s_cbranch_vccnz L_spin_drain
L_spun_drain:
    s_waitcnt lgkmcnt(0)
    v_mov_b32 v250, 0
    v_mov_b32 v251, 1
    s_mov_b64 exec, 1
    buffer_store_dword v251, v250, s[52:55], s62 offen sc1
    s_mov_b64 exec, -1
    s_and_b32 s70, s40, 7
    s_lshl_b32 s70, s70, 1
    s_lshl_b32 s70, 3, s70
    s_or_b32 s70, s70, 0x30000
    s_mov_b32 s71, 3
    s_mov_b64 exec, s[70:71]
    s_mov_b32 s61, 400000
L_poll_f1a:
    buffer_load_dword v17, v16, s[52:55], s63 offen sc1
    s_sub_u32 s61, s61, 1
    s_cmp_eq_u32 s61, 0
    s_cbranch_scc1 L_polled_f1a
    s_waitcnt vmcnt(0)
    v_cmp_ne_u32 vcc, 1, v17
    s_nop 0
    s_cbranch_vccnz L_poll_f1a
L_polled_f1a:
    s_mov_b64 exec, -1
    v_mov_b32 v18, 163748
    v_mov_b32 v19, 1
    s_mov_b64 exec, 1
    ds_add_u32 v18, v19
    s_mov_b64 exec, -1
L_sync1_other:
    v_mov_b32 v110, 163748
    s_mul_i32 s60, s56, 73728
    s_add_u32 s60, s60, 720896
    s_and_b32 s62, s57, 0xfffffffe
    s_lshl_b32 s63, s62, 7
    s_add_u32 s63, s63, s60
    s_add_u32 s63, s63, 65536
    s_lshl_b32 s62, s62, 10
    s_add_u32 s62, s62, s60
    v_lshlrev_b32 v108, 2, v0
    s_mov_b32 s61, 3200000
L_spin_goa:
    ds_read_b32 v111, v110
    s_sub_u32 s61, s61, 1
    s_cmp_eq_u32 s61, 0
    s_cbranch_scc1 L_spun_goa
    s_waitcnt lgkmcnt(0)
    v_cmp_gt_u32 vcc, 1, v111
    s_nop 0
    s_cbranch_vccnz L_spin_goa
L_spun_goa:
    s_waitcnt lgkmcnt(0)
    buffer_load_dword v12, v108, s[52:55], s63 offen sc1
    buffer_load_dwordx4 v[8:11], v1, s[52:55], s62 offen sc1
    buffer_load_dwordx4 v[124:127], v1, s[52:55], s62 offen offset:1024 sc1
    s_add_u32 s60, s82, 18432
    buffer_load_dword v104, v2, s[52:55], s60 offen sc1
    buffer_load_dwordx4 v[96:99], v1, s[52:55], s82 offen sc1
    s_add_u32 m0, s83, 0
    s_add_u32 s69, s82, 0
    buffer_load_dwordx4 v6, s[52:55], s69 offen sc1 lds
    s_add_u32 m0, s83, 8192
    s_add_u32 s69, s82, 0
    buffer_load_dwordx4 v7, s[52:55], s69 offen sc1 lds
    s_add_u32 m0, s92, 16384
    s_add_u32 s69, s82, 0
    s_mov_b64 exec, 0xffffff
    buffer_load_dwordx4 v14, s[52:55], s69 offen sc1 lds
    s_mov_b64 exec, -1
    s_add_u32 m0, s83, 4096
    s_add_u32 s69, s82, 4096
    buffer_load_dwordx4 v6, s[52:55], s69 offen sc1 lds
    s_add_u32 m0, s83, 12288
    s_add_u32 s69, s82, 0
    buffer_load_dwordx4 v228, s[52:55], s69 offen sc1 lds
    s_add_u32 m0, s92, 17920
    s_add_u32 s69, s82, 0
    s_mov_b64 exec, 0xffffff
    buffer_load_dwordx4 v229, s[52:55], s69 offen sc1 lds
    s_mov_b64 exec, -1
    v_mov_b32 v105, 0x3f80
    v_mov_b32 v13, 0
    s_lshl_b32 s60, s3, 8
    s_add_u32 s60, s60, 155648
    v_lshl_add_u32 v101, v0, 2, s60
    s_waitcnt vmcnt(6)
    v_mfma_f32_32x32x4_2b_bf16 v[32:63], v[104:105], v[12:13], 0
    s_nop 15
    s_nop 1
    v_mfma_f32_32x32x16_bf16 v[32:47], v[96:99], v[8:11], v[32:47]
    v_mfma_f32_32x32x16_bf16 v[48:63], v[96:99], v[124:127], v[48:63]
    s_nop 10
    v_max3_f32 v15, v32, v33, v34
    v_max3_f32 v15, v15, v35, v36
    v_max3_f32 v15, v15, v37, v38
    v_max3_f32 v15, v15, v39, v40
    v_max3_f32 v15, v15, v41, v42
    v_max3_f32 v15, v15, v43, v44
    v_max3_f32 v15, v15, v45, v46
    v_max_f32 v15, v15, v47
    v_max3_f32 v100, v48, v49, v50
    v_max3_f32 v100, v100, v51, v52
    v_max3_f32 v100, v100, v53, v54
    v_max3_f32 v100, v100, v55, v56
    v_max3_f32 v100, v100, v57, v58
    v_max3_f32 v100, v100, v59, v60
    v_max3_f32 v100, v100, v61, v62
    v_max_f32 v100, v100, v63
    s_nop 1
    v_permlane32_swap_b32 v15, v100
    v_max_f32 v15, v15, v100
    v_lshrrev_b32 v15, 16, v15
    v_xor_b32 v13, 0x8000, v15
    ds_write_b32 v101, v13
    s_cmp_lg_u32 s38, 0
    s_cbranch_scc1 L_sync1_done
    s_mov_b32 s63, 393216
    s_mov_b32 s70, 0xffff0000
    s_mov_b32 s71, 0xffff
    s_mov_b64 exec, s[70:71]
    s_mov_b32 s61, 400000
L_poll_f1b:
    buffer_load_dword v17, v16, s[52:55], s63 offen sc1
    s_sub_u32 s61, s61, 1
    s_cmp_eq_u32 s61, 0
    s_cbranch_scc1 L_polled_f1b
    s_waitcnt vmcnt(0)
    v_cmp_ne_u32 vcc, 1, v17
    s_nop 0
    s_cbranch_vccnz L_poll_f1b
L_polled_f1b:
    s_mov_b64 exec, -1
L_sync1_done:
    s_branch L_attn
L_bwave:
    s_cmp_lt_u32 s39, 2
    s_cselect_b32 s60, 24, 16
    s_cmp_lt_u32 s40, s60
    s_cselect_b32 s41, 1, 0
    s_lshl_b32 s56, s39, 2
    s_lshr_b32 s60, s40, 3
    s_add_u32 s56, s56, s60
    s_and_b32 s60, s40, 7
    s_lshl_b32 s60, s60, 3
    s_lshl_b32 s61, s3, 1
    s_add_u32 s60, s60, s61
    s_lshr_b32 s61, s38, 2
    s_add_u32 s57, s60, s61
    s_mul_i32 s60, s40, s41
    s_lshl_b32 s61, s39, 6
    s_mul_i32 s58, s39, 32
    s_add_u32 s58, s58, 448
    s_cmp_lt_u32 s60, 16
    s_cmov_b32 s58, s61
    s_lshl_b32 s60, s60, 2
    s_add_u32 s58, s58, s60
    s_waitcnt lgkmcnt(0)
    s_cmp_eq_u32 s41, 0
    s_cbranch_scc1 L_nopar
L_nopar:
    s_mov_b32 s52, s36
    s_and_b32 s53, s37, 0xffff
    s_mov_b32 s54, 10420224
    s_mov_b32 s55, 0x20000
    s_cmp_lt_u32 s2, 240
    s_cbranch_scc1 L_noclr
    s_cmp_lg_u32 s38, 4
    s_cbranch_scc1 L_noclr
    v_lshlrev_b32 v92, 4, v0
    v_mov_b32 v96, 0
    v_mov_b32 v97, 0
    v_mov_b32 v98, 0
    v_mov_b32 v99, 0
    s_sub_u32 s60, s2, 240
    s_lshl_b32 s60, s60, 12
    s_add_u32 s60, s60, 393216
    buffer_store_dwordx4 v[96:99], v92, s[52:55], s60 offen sc1
    buffer_store_dwordx4 v[96:99], v92, s[52:55], s60 offen offset:1024 sc1
    buffer_store_dwordx4 v[96:99], v92, s[52:55], s60 offen offset:2048 sc1
    buffer_store_dwordx4 v[96:99], v92, s[52:55], s60 offen offset:3072 sc1
    v_mov_b32 v93, 1
    s_waitcnt vmcnt(0)
    s_mov_b64 exec, 1
    global_atomic_add v96, v93, s[34:35] sc1
    s_mov_b64 exec, -1
L_noclr:
    s_and_b32 s60, s40, 7
    s_lshr_b32 s61, s40, 3
    s_lshl_b32 s61, s61, 1
    s_add_u32 s62, s61, s60
    s_cmp_ge_u32 s62, 9
    s_cselect_b32 s61, 9, 0
    s_sub_u32 s62, s62, s61
    s_add_u32 s62, s62, 2
    s_cmp_ge_u32 s62, 9
    s_cselect_b32 s61, 9, 0
    s_sub_u32 s62, s62, s61
    s_lshl_b32 s66, s4, 7
    s_lshl_b32 s67, s3, 5
    s_add_u32 s66, s66, s67
    s_mul_i32 s66, s66, 1152
    v_lshrrev_b32 v92, 3, v0
    v_mul_u32_u24 v92, 1152, v92
    v_lshrrev_b32 v93, 4, v0
    v_and_b32 v94, 7, v0
    v_xor_b32 v95, v94, v93
    v_lshlrev_b32 v95, 4, v95
    v_add3_u32 v82, v92, v95, s66
    v_xor_b32 v95, 64, v95
    s_add_u32 s66, s66, 9216
    v_add3_u32 v83, v92, v95, s66
    v_and_b32 v94, 15, v0
    v_lshlrev_b32 v95, 2, v93
    v_xor_b32 v94, v94, v95
    s_mul_i32 s66, s5, 216
    s_and_b32 s67, s66, 31
    s_add_u32 s67, s67, 215
    s_lshr_b32 s67, s67, 4
    v_min_u32 v94, s67, v94
    v_lshlrev_b32 v94, 4, v94
    s_and_b32 s66, s66, 0xffffffe0
    s_mul_i32 s67, s3, 55296
    s_add_u32 s66, s66, s67
    v_mul_u32_u24 v93, 3456, v93
    v_add3_u32 v84, v93, v94, s66
    s_lshl_b32 s65, s3, 12
    s_waitcnt lgkmcnt(0)
    s_mov_b32 s44, s26
    s_and_b32 s45, s27, 0xffff
    s_mov_b32 s46, 2359296
    s_mov_b32 s47, 0x20000
    s_mov_b32 s48, s28
    s_and_b32 s49, s29, 0xffff
    s_mov_b32 s50, 1990656
    s_mov_b32 s51, 0x20000
    s_cmp_eq_u32 s41, 0
    s_cbranch_scc1 L_load_n
    s_mul_i32 s82, s56, 155648
    s_add_u32 s82, s82, 3080192
    s_lshl_b32 s83, s38, 10
    s_mul_i32 s92, s38, 384
    v_lshlrev_b32 v1, 4, v0
    v_add_u32 v6, s83, v1
    s_lshl_b32 s60, s38, 6
    v_add_u32 v234, s60, v0
    v_mul_u32_u24 v230, 3277, v234
    v_lshrrev_b32 v230, 16, v230
    v_mul_u32_u24 v231, 20, v230
    v_sub_u32 v231, v234, v231
    v_lshrrev_b32 v232, 2, v230
    v_lshlrev_b32 v232, 10, v232
    v_and_b32 v233, 3, v230
    v_lshl_add_u32 v232, v233, 7, v232
    v_lshl_add_u32 v232, v231, 4, v232
    v_add_u32 v233, 8512, v232
    v_add_u32 v232, 8192, v232
    v_cmp_lt_u32 vcc, 11, v231
    v_lshlrev_b32 v230, 6, v230
    v_lshl_add_u32 v230, v231, 4, v230
    v_cndmask_b32 v232, v232, v233, vcc
    v_subrev_u32 v231, 8, v231
    v_cmp_gt_u32 vcc, 4, v231
    v_add_u32 v230, 16256, v230
    s_nop 0
    v_cndmask_b32 v7, v232, v230, vcc
    s_mul_i32 s60, s38, 24
    s_add_u32 s60, s60, 512
    v_add_u32 v234, s60, v0
    v_mul_u32_u24 v230, 3277, v234
    v_lshrrev_b32 v230, 16, v230
    v_mul_u32_u24 v231, 20, v230
    v_sub_u32 v231, v234, v231
    v_lshrrev_b32 v232, 2, v230
    v_lshlrev_b32 v232, 10, v232
    v_and_b32 v233, 3, v230
    v_lshl_add_u32 v232, v233, 7, v232
    v_lshl_add_u32 v232, v231, 4, v232
    v_add_u32 v233, 8512, v232
    v_add_u32 v232, 8192, v232
    v_cmp_lt_u32 vcc, 11, v231
    v_lshlrev_b32 v230, 6, v230
    v_lshl_add_u32 v230, v231, 4, v230
    v_cndmask_b32 v232, v232, v233, vcc
    v_subrev_u32 v231, 8, v231
    v_cmp_gt_u32 vcc, 4, v231
    v_add_u32 v230, 16256, v230
    s_nop 0
    v_cndmask_b32 v14, v232, v230, vcc
    v_cmp_lt_u32 vcc, 639, v234
    v_lshlrev_b32 v230, 4, v234
    v_add_u32 v230, 8192, v230
    v_cndmask_b32 v14, v14, v230, vcc
    v_and_b32 v2, 31, v0
    v_lshlrev_b32 v2, 2, v2
    v_lshrrev_b32 v230, 5, v0
    v_mul_u32_u24 v234, 320, v230
    v_bfe_u32 v230, v0, 2, 2
    v_and_b32 v231, 1, v0
    v_lshlrev_b32 v232, 4, v230
    v_lshl_add_u32 v232, v231, 3, v232
    v_and_b32 v231, 2, v0
    v_mul_u32_u24 v231, 96, v231
    v_add_u32 v232, v232, v231
    v_lshlrev_b32 v233, 3, v230
    v_add_u32 v233, 128, v233
    v_and_b32 v231, 3, v0
    v_cmp_ne_u32 vcc, 0, v231
    v_mov_b32 v230, 262144
    v_and_b32 v231, 16, v0
    v_cndmask_b32 v233, v233, v230, vcc
    v_cmp_ne_u32 vcc, 0, v231
    v_mov_b32 v5, 0xdddddddd
    s_nop 0
    v_cndmask_b32 v232, v232, v233, vcc
    v_cndmask_b32 v233, 64, 32, vcc
    v_add_u32 v3, v234, v232
    v_add_u32 v4, v3, v233
    s_cmp_ge_u32 s40, 28
    s_cselect_b32 s59, 1, 0
    s_cbranch_scc1 L_t_dbl_s1
    s_lshr_b32 s42, s40, 2
    s_add_u32 s42, s42, 2
    s_and_b32 s43, s40, 3
    s_branch L_t_map_s1
L_t_dbl_s1:
    s_bfe_u32 s42, s40, 0x10001
    s_and_b32 s43, s40, 1
    s_lshl_b32 s43, s43, 1
    s_lshr_b32 s60, s38, 2
    s_add_u32 s43, s43, s60
L_t_map_s1:
    v_lshrrev_b32 v230, 3, v0
    v_and_b32 v231, 7, v0
    v_and_b32 v232, 16, v0
    v_lshrrev_b32 v232, 2, v232
    v_xor_b32 v231, v231, v232
    v_lshlrev_b32 v231, 4, v231
    s_lshl_b32 s60, s42, 7
    s_mul_i32 s61, s38, 82944
    s_add_u32 s60, s60, s61
    v_mul_u32_u24 v233, 1152, v230
    v_add3_u32 v240, v233, v231, s60
    v_lshrrev_b32 v233, 4, v0
    v_mul_u32_u24 v233, 18, v233
    v_and_b32 v230, 1, v230
    v_add_u32 v233, v233, v230
    v_and_b32 v232, 16, v0
    v_xor_b32 v232, 16, v232
    v_add_u32 v233, v233, v232
    v_mul_u32_u24 v233, 1152, v233
    v_add3_u32 v241, v233, v231, s60
    s_mul_i32 s68, s3, 4608
    s_add_u32 s68, s68, 98304
    s_mul_i32 s69, s3, 9728
    s_add_u32 s69, s69, 116736
    v_mul_u32_u24 v85, 11, v0
    v_lshrrev_b32 v85, 5, v85
    v_mul_u32_u24 v86, 3, v85
    v_sub_u32 v86, v0, v86
    v_lshlrev_b32 v86, 2, v86
    v_add_u32 v86, 52, v86
    s_mov_b64 exec, 0x208
    v_mov_b32 v86, 2112
    s_mov_b64 exec, -1
    v_and_b32 v87, 2, v85
    v_lshl_add_u32 v86, v87, 1, v86
    v_mul_u32_u24 v85, 2240, v85
    v_add3_u32 v227, v85, v86, s69
    v_min_u32 v85, 29, v0
    v_lshlrev_b32 v85, 4, v85
    v_add_u32 v85, s68, v85
    v_bfe_u32 v86, v0, 2, 2
    v_mul_u32_u24 v86, 192, v86
    v_and_b32 v87, 3, v0
    v_lshl_add_u32 v86, v87, 4, v86
    s_add_u32 s70, s69, 9088
    v_add_u32 v86, s70, v86
    v_cmp_lt_u32 vcc, 31, v0
    s_nop 1
    v_cndmask_b32 v216, v85, v86, vcc
    v_bfe_u32 v85, v0, 3, 2
    v_mul_u32_u24 v85, 2240, v85
    v_and_b32 v86, 7, v0
    v_min_u32 v86, 6, v86
    v_cmp_lt_u32 vcc, 3, v86
    v_lshl_add_u32 v85, v86, 4, v85
    v_add_u32 v87, 2048, v85
    v_cndmask_b32 v85, v85, v87, vcc
    v_add_u32 v217, s69, v85
    v_and_b32 v85, 31, v0
    v_lshrrev_b32 v86, 5, v0
    v_lshlrev_b32 v87, 4, v85
    v_lshl_add_u32 v87, v86, 9, v87
    v_sub_u32 v218, s69, v87
    v_lshl_add_u32 v87, v86, 6, v85
    v_add_u32 v87, 130, v87
    v_and_b32 v87, -2, v87
    v_and_b32 v88, 1, v0
    v_xor_b32 v88, 1, v88
    v_mul_u32_u24 v88, 384, v88
    v_sub_u32 v88, v88, v87
    s_add_u32 s70, s69, 9184
    v_add_u32 v219, s70, v88
    v_and_b32 v85, 15, v0
    v_lshrrev_b32 v86, 4, v0
    v_lshlrev_b32 v87, 4, v86
    v_lshl_add_u32 v88, v85, 5, v87
    v_add_u32 v221, s68, v88
    v_add_u32 v88, 1, v0
    v_and_b32 v88, 3, v88
    v_mul_u32_u24 v88, 2242, v88
    v_lshlrev_b32 v89, 1, v85
    v_sub_u32 v87, v87, v89
    s_add_u32 s70, s69, 30
    v_add3_u32 v220, v87, v88, s70
    v_and_b32 v88, 1, v0
    v_xor_b32 v88, 1, v88
    v_mul_u32_u24 v88, 194, v88
    s_add_u32 s70, s69, 8990
    v_add3_u32 v223, v87, v88, s70
    v_bfe_u32 v87, v0, 2, 2
    v_lshlrev_b32 v87, 8, v87
    v_and_b32 v88, 3, v0
    v_lshl_add_u32 v87, v88, 5, v87
    v_lshl_add_u32 v87, v86, 4, v87
    s_add_u32 s70, s68, 432
    v_add_u32 v222, s70, v87
    v_lshlrev_b32 v87, 3, v86
    v_lshl_add_u32 v87, v85, 5, v87
    v_add_u32 v224, s68, v87
    s_lshl_b32 s70, s3, 9
    s_add_u32 s70, s70, 98304
    v_lshl_add_u32 v225, v0, 3, s70
    s_mul_i32 s70, s3, 589824
    s_lshl_b32 s71, s58, 1
    s_add_u32 s70, s70, s71
    s_add_u32 s70, s70, 2359296
    v_mul_u32_u24 v87, 9216, v0
    v_add_u32 v226, s70, v87
    v_mov_b32 v236, 0
    v_mov_b32 v237, 0
    v_mov_b32 v238, 0
    v_mov_b32 v239, 0
    v_lshlrev_b32 v87, 3, v86
    v_sub_u32 v87, v87, v85
    v_mov_b32 v88, 0x3f80
    v_mov_b32 v89, 0x3f800000
    v_add_u32 v85, -4, v87
    v_add_u32 v86, 1, v85
    v_cmp_ge_u32 vcc, 8, v85
    v_cmp_ge_u32 s[70:71], 8, v86
    s_nop 0
    v_cndmask_b32 v85, 0, v88, vcc
    v_cndmask_b32 v86, 0, v89, s[70:71]
    v_or_b32 v228, v85, v86
    v_add_u32 v85, -2, v87
    v_add_u32 v86, 1, v85
    v_cmp_ge_u32 vcc, 8, v85
    v_cmp_ge_u32 s[70:71], 8, v86
    s_nop 0
    v_cndmask_b32 v85, 0, v88, vcc
    v_cndmask_b32 v86, 0, v89, s[70:71]
    v_or_b32 v229, v85, v86
    v_add_u32 v85, 0, v87
    v_add_u32 v86, 1, v85
    v_cmp_ge_u32 vcc, 8, v85
    v_cmp_ge_u32 s[70:71], 8, v86
    s_nop 0
    v_cndmask_b32 v85, 0, v88, vcc
    v_cndmask_b32 v86, 0, v89, s[70:71]
    v_or_b32 v230, v85, v86
    v_add_u32 v85, 2, v87
    v_add_u32 v86, 1, v85
    v_cmp_ge_u32 vcc, 8, v85
    v_cmp_ge_u32 s[70:71], 8, v86
    s_nop 0
    v_cndmask_b32 v85, 0, v88, vcc
    v_cndmask_b32 v86, 0, v89, s[70:71]
    v_or_b32 v231, v85, v86
    v_add_u32 v85, -5, v87
    v_add_u32 v86, 1, v85
    v_cmp_ge_u32 vcc, 6, v85
    v_cmp_ge_u32 s[70:71], 6, v86
    s_nop 0
    v_cndmask_b32 v85, 0, v88, vcc
    v_cndmask_b32 v86, 0, v89, s[70:71]
    v_or_b32 v232, v85, v86
    v_add_u32 v85, -3, v87
    v_add_u32 v86, 1, v85
    v_cmp_ge_u32 vcc, 6, v85
    v_cmp_ge_u32 s[70:71], 6, v86
    s_nop 0
    v_cndmask_b32 v85, 0, v88, vcc
    v_cndmask_b32 v86, 0, v89, s[70:71]
    v_or_b32 v233, v85, v86
    v_add_u32 v85, -1, v87
    v_add_u32 v86, 1, v85
    v_cmp_ge_u32 vcc, 6, v85
    v_cmp_ge_u32 s[70:71], 6, v86
    s_nop 0
    v_cndmask_b32 v85, 0, v88, vcc
    v_cndmask_b32 v86, 0, v89, s[70:71]
    v_or_b32 v234, v85, v86
    v_add_u32 v85, 1, v87
    v_add_u32 v86, 1, v85
    v_cmp_ge_u32 vcc, 6, v85
    v_cmp_ge_u32 s[70:71], 6, v86
    s_nop 0
    v_cndmask_b32 v85, 0, v88, vcc
    v_cndmask_b32 v86, 0, v89, s[70:71]
    v_or_b32 v235, v85, v86
    s_add_u32 s66, s58, s3
    s_lshl_b32 s67, s66, 8
    v_lshl_add_u32 v24, v0, 2, s67
    s_lshl_b32 s66, s66, 1
    v_mov_b32 v25, s66
    global_load_dword v16, v24, s[10:11]
    global_load_dword v17, v24, s[12:13]
    global_load_dword v18, v24, s[14:15]
    global_load_dword v19, v24, s[16:17]
    global_load_dword v20, v24, s[18:19]
    global_load_dword v21, v24, s[20:21]
    global_load_ushort v22, v25, s[22:23]
    global_load_ushort v23, v25, s[24:25]
    s_barrier
    s_lshl_b32 s63, s62, 7
    s_mul_i32 s64, s62, 221184
    s_add_u32 m0, s65, 65536
    s_nop 0
    buffer_load_dwordx4 v82, s[44:47], s63 offen lds
    s_add_u32 m0, s65, 66560
    s_add_u32 s62, s62, 1
    buffer_load_dwordx4 v83, s[44:47], s63 offen lds
    s_add_u32 s63, s63, 18432
    s_add_u32 m0, s65, 67584
    s_nop 0
    buffer_load_dwordx4 v82, s[44:47], s63 offen lds
    s_add_u32 m0, s65, 68608
    s_cmp_eq_u32 s62, 9
    s_cselect_b32 s62, 0, s62
    buffer_load_dwordx4 v83, s[44:47], s63 offen lds
    s_add_u32 m0, s65, 81920
    s_nop 0
    buffer_load_dwordx4 v84, s[48:51], s64 offen lds
    s_add_u32 m0, s65, 82944
    s_add_u32 s64, s64, 13824
    buffer_load_dwordx4 v84, s[48:51], s64 offen lds
    s_add_u32 m0, s65, 83968
    s_add_u32 s64, s64, 13824
    buffer_load_dwordx4 v84, s[48:51], s64 offen lds
    s_add_u32 m0, s65, 84992
    s_add_u32 s64, s64, 13824
    buffer_load_dwordx4 v84, s[48:51], s64 offen lds
    s_barrier
    s_lshl_b32 s63, s62, 7
    s_mul_i32 s64, s62, 221184
    s_add_u32 m0, s65, 98304
    s_nop 0
    buffer_load_dwordx4 v82, s[44:47], s63 offen lds
    s_add_u32 m0, s65, 99328
    s_add_u32 s62, s62, 1
    buffer_load_dwordx4 v83, s[44:47], s63 offen lds
    s_add_u32 s63, s63, 18432
    s_add_u32 m0, s65, 100352
    s_nop 0
    buffer_load_dwordx4 v82, s[44:47], s63 offen lds
    s_add_u32 m0, s65, 101376
    s_cmp_eq_u32 s62, 9
    s_cselect_b32 s62, 0, s62
    buffer_load_dwordx4 v83, s[44:47], s63 offen lds
    s_add_u32 m0, s65, 114688
    s_nop 0
    buffer_load_dwordx4 v84, s[48:51], s64 offen lds
    s_add_u32 m0, s65, 115712
    s_add_u32 s64, s64, 13824
    buffer_load_dwordx4 v84, s[48:51], s64 offen lds
    s_add_u32 m0, s65, 116736
    s_add_u32 s64, s64, 13824
    buffer_load_dwordx4 v84, s[48:51], s64 offen lds
    s_add_u32 m0, s65, 117760
    s_add_u32 s64, s64, 13824
    buffer_load_dwordx4 v84, s[48:51], s64 offen lds
    s_waitcnt vmcnt(8)
    s_barrier
    s_lshl_b32 s63, s62, 7
    s_mul_i32 s64, s62, 221184
    s_add_u32 m0, s65, 0
    s_nop 0
    buffer_load_dwordx4 v82, s[44:47], s63 offen lds
    s_add_u32 m0, s65, 1024
    s_add_u32 s62, s62, 1
    buffer_load_dwordx4 v83, s[44:47], s63 offen lds
    s_add_u32 s63, s63, 18432
    s_add_u32 m0, s65, 2048
    s_nop 0
    buffer_load_dwordx4 v82, s[44:47], s63 offen lds
    s_add_u32 m0, s65, 3072
    s_cmp_eq_u32 s62, 9
    s_cselect_b32 s62, 0, s62
    buffer_load_dwordx4 v83, s[44:47], s63 offen lds
    s_add_u32 m0, s65, 16384
    s_nop 0
    buffer_load_dwordx4 v84, s[48:51], s64 offen lds
    s_add_u32 m0, s65, 17408
    s_add_u32 s64, s64, 13824
    buffer_load_dwordx4 v84, s[48:51], s64 offen lds
    s_add_u32 m0, s65, 18432
    s_add_u32 s64, s64, 13824
    buffer_load_dwordx4 v84, s[48:51], s64 offen lds
    s_add_u32 m0, s65, 19456
    s_add_u32 s64, s64, 13824
    buffer_load_dwordx4 v84, s[48:51], s64 offen lds
    s_waitcnt vmcnt(8)
    s_barrier
    s_lshl_b32 s63, s62, 7
    s_mul_i32 s64, s62, 221184
    s_add_u32 m0, s65, 32768
    s_nop 0
    buffer_load_dwordx4 v82, s[44:47], s63 offen lds
    s_add_u32 m0, s65, 33792
    s_add_u32 s62, s62, 1
    buffer_load_dwordx4 v83, s[44:47], s63 offen lds
    s_add_u32 s63, s63, 18432
    s_add_u32 m0, s65, 34816
    s_nop 0
    buffer_load_dwordx4 v82, s[44:47], s63 offen lds
    s_add_u32 m0, s65, 35840
    s_cmp_eq_u32 s62, 9
    s_cselect_b32 s62, 0, s62
    buffer_load_dwordx4 v83, s[44:47], s63 offen lds
    s_add_u32 m0, s65, 49152
    s_nop 0
    buffer_load_dwordx4 v84, s[48:51], s64 offen lds
    s_add_u32 m0, s65, 50176
    s_add_u32 s64, s64, 13824
    buffer_load_dwordx4 v84, s[48:51], s64 offen lds
    s_add_u32 m0, s65, 51200
    s_add_u32 s64, s64, 13824
    buffer_load_dwordx4 v84, s[48:51], s64 offen lds
    s_add_u32 m0, s65, 52224
    s_add_u32 s64, s64, 13824
    buffer_load_dwordx4 v84, s[48:51], s64 offen lds
    s_waitcnt vmcnt(8)
    s_barrier
    s_lshl_b32 s63, s62, 7
    s_mul_i32 s64, s62, 221184
    s_add_u32 m0, s65, 65536
    s_nop 0
    buffer_load_dwordx4 v82, s[44:47], s63 offen lds
    s_add_u32 m0, s65, 66560
    s_add_u32 s62, s62, 1
    buffer_load_dwordx4 v83, s[44:47], s63 offen lds
    s_add_u32 s63, s63, 18432
    s_add_u32 m0, s65, 67584
    s_nop 0
    buffer_load_dwordx4 v82, s[44:47], s63 offen lds
    s_add_u32 m0, s65, 68608
    s_cmp_eq_u32 s62, 9
    s_cselect_b32 s62, 0, s62
    buffer_load_dwordx4 v83, s[44:47], s63 offen lds
    s_add_u32 m0, s65, 81920
    s_nop 0
    buffer_load_dwordx4 v84, s[48:51], s64 offen lds
    s_add_u32 m0, s65, 82944
    s_add_u32 s64, s64, 13824
    buffer_load_dwordx4 v84, s[48:51], s64 offen lds
    s_add_u32 m0, s65, 83968
    s_add_u32 s64, s64, 13824
    buffer_load_dwordx4 v84, s[48:51], s64 offen lds
    s_add_u32 m0, s65, 84992
    s_add_u32 s64, s64, 13824
    buffer_load_dwordx4 v84, s[48:51], s64 offen lds
    s_waitcnt vmcnt(8)
    s_barrier
    s_lshl_b32 s63, s62, 7
    s_mul_i32 s64, s62, 221184
    s_add_u32 m0, s65, 98304
    s_nop 0
    buffer_load_dwordx4 v82, s[44:47], s63 offen lds
    s_add_u32 m0, s65, 99328
    s_add_u32 s62, s62, 1
    buffer_load_dwordx4 v83, s[44:47], s63 offen lds
    s_add_u32 s63, s63, 18432
    s_add_u32 m0, s65, 100352
    s_nop 0
    buffer_load_dwordx4 v82, s[44:47], s63 offen lds
    s_add_u32 m0, s65, 101376
    s_cmp_eq_u32 s62, 9
    s_cselect_b32 s62, 0, s62
    buffer_load_dwordx4 v83, s[44:47], s63 offen lds
    s_add_u32 m0, s65, 114688
    s_nop 0
    buffer_load_dwordx4 v84, s[48:51], s64 offen lds
    s_add_u32 m0, s65, 115712
    s_add_u32 s64, s64, 13824
    buffer_load_dwordx4 v84, s[48:51], s64 offen lds
    s_add_u32 m0, s65, 116736
    s_add_u32 s64, s64, 13824
    buffer_load_dwordx4 v84, s[48:51], s64 offen lds
    s_add_u32 m0, s65, 117760
    s_add_u32 s64, s64, 13824
    buffer_load_dwordx4 v84, s[48:51], s64 offen lds
    s_waitcnt vmcnt(8)
    s_barrier
    s_lshl_b32 s63, s62, 7
    s_mul_i32 s64, s62, 221184
    s_add_u32 m0, s65, 0
    s_nop 0
    buffer_load_dwordx4 v82, s[44:47], s63 offen lds
    s_add_u32 m0, s65, 1024
    s_add_u32 s62, s62, 1
    buffer_load_dwordx4 v83, s[44:47], s63 offen lds
    s_add_u32 s63, s63, 18432
    s_add_u32 m0, s65, 2048
    s_nop 0
    buffer_load_dwordx4 v82, s[44:47], s63 offen lds
    s_add_u32 m0, s65, 3072
    s_cmp_eq_u32 s62, 9
    s_cselect_b32 s62, 0, s62
    buffer_load_dwordx4 v83, s[44:47], s63 offen lds
    s_add_u32 m0, s65, 16384
    s_nop 0
    buffer_load_dwordx4 v84, s[48:51], s64 offen lds
    s_add_u32 m0, s65, 17408
    s_add_u32 s64, s64, 13824
    buffer_load_dwordx4 v84, s[48:51], s64 offen lds
    s_add_u32 m0, s65, 18432
    s_add_u32 s64, s64, 13824
    buffer_load_dwordx4 v84, s[48:51], s64 offen lds
    s_add_u32 m0, s65, 19456
    s_add_u32 s64, s64, 13824
    buffer_load_dwordx4 v84, s[48:51], s64 offen lds
    s_waitcnt vmcnt(8)
    s_barrier
    s_waitcnt vmcnt(0)
    s_barrier
    v_lshlrev_b32 v24, 16, v22
    v_mul_f32 v24, 0x3fb8aa3b, v24
    v_exp_f32 v24, v24
    v_lshlrev_b32 v44, 16, v16
    v_lshlrev_b32 v45, 16, v17
    v_lshlrev_b32 v46, 16, v18
    v_lshlrev_b32 v47, 16, v19
    v_lshlrev_b32 v48, 16, v20
    v_lshlrev_b32 v49, 16, v21
    v_and_b32 v72, 0xffff0000, v16
    v_and_b32 v73, 0xffff0000, v17
    v_and_b32 v74, 0xffff0000, v18
    v_and_b32 v75, 0xffff0000, v19
    v_and_b32 v76, 0xffff0000, v20
    v_and_b32 v77, 0xffff0000, v21
    v_cvt_pk_bf16_f32 v24, v24, v24
    v_and_b32 v24, 0xffff0000, v24
    v_mul_f32 v44, v24, v44
    v_mul_f32 v45, v24, v45
    v_mul_f32 v46, v24, v46
    v_mul_f32 v47, v24, v47
    v_mul_f32 v44, 0x3fb8aa3b, v44
    v_mul_f32 v45, 0.15915494, v45
    v_mul_f32 v36, v48, v46
    v_mul_f32 v37, v48, v47
    v_fma_f32 v36, -v49, v47, v36
    v_fma_f32 v37, v49, v46, v37
    v_mul_f32 v72, v24, v72
    v_mul_f32 v73, v24, v73
    v_mul_f32 v74, v24, v74
    v_mul_f32 v75, v24, v75
    v_mul_f32 v72, 0x3fb8aa3b, v72
    v_mul_f32 v73, 0.15915494, v73
    v_mul_f32 v64, v76, v74
    v_mul_f32 v65, v76, v75
    v_fma_f32 v64, -v77, v75, v64
    v_fma_f32 v65, v77, v74, v65
    v_mul_f32 v50, 0x3f800000, v44
    v_mul_f32 v51, 0x3f800000, v45
    v_exp_f32 v50, v50
    v_fract_f32 v51, v51
    v_cos_f32 v52, v51
    v_sin_f32 v51, v51
    v_mul_f32 v26, v50, v52
    v_mul_f32 v27, v50, v51
    v_mul_f32 v78, 0x3f800000, v72
    v_mul_f32 v79, 0x3f800000, v73
    v_exp_f32 v78, v78
    v_fract_f32 v79, v79
    v_cos_f32 v80, v79
    v_sin_f32 v79, v79
    v_mul_f32 v54, v78, v80
    v_mul_f32 v55, v78, v79
    v_mul_f32 v50, 0x41000000, v44
    v_mul_f32 v51, 0x41000000, v45
    v_exp_f32 v50, v50
    v_fract_f32 v51, v51
    v_cos_f32 v52, v51
    v_sin_f32 v51, v51
    v_mul_f32 v32, v50, v52
    v_mul_f32 v33, v50, v51
    v_mul_f32 v78, 0x41000000, v72
    v_mul_f32 v79, 0x41000000, v73
    v_exp_f32 v78, v78
    v_fract_f32 v79, v79
    v_cos_f32 v80, v79
    v_sin_f32 v79, v79
    v_mul_f32 v60, v78, v80
    v_mul_f32 v61, v78, v79
    v_mul_f32 v50, 0x43800000, v44
    v_mul_f32 v51, 0x43800000, v45
    v_exp_f32 v50, v50
    v_fract_f32 v51, v51
    v_cos_f32 v52, v51
    v_sin_f32 v51, v51
    v_mul_f32 v34, v50, v52
    v_mul_f32 v35, v50, v51
    v_mul_f32 v78, 0x43800000, v72
    v_mul_f32 v79, 0x43800000, v73
    v_exp_f32 v78, v78
    v_fract_f32 v79, v79
    v_cos_f32 v80, v79
    v_sin_f32 v79, v79
    v_mul_f32 v62, v78, v80
    v_mul_f32 v63, v78, v79
    v_pk_mul_f32 v[42:43], v[26:27], v[26:27] op_sel:[0,0] op_sel_hi:[1,0]
    v_pk_mul_f32 v[70:71], v[54:55], v[54:55] op_sel:[0,0] op_sel_hi:[1,0]
    v_pk_fma_f32 v[28:29], v[26:27], v[26:27], v[42:43] op_sel:[1,1,0] op_sel_hi:[0,1,1] neg_lo:[1,0,0]
    v_pk_fma_f32 v[56:57], v[54:55], v[54:55], v[70:71] op_sel:[1,1,0] op_sel_hi:[0,1,1] neg_lo:[1,0,0]
    v_pk_mul_f32 v[42:43], v[28:29], v[28:29] op_sel:[0,0] op_sel_hi:[1,0]
    v_pk_mul_f32 v[70:71], v[56:57], v[56:57] op_sel:[0,0] op_sel_hi:[1,0]
    v_pk_fma_f32 v[30:31], v[28:29], v[28:29], v[42:43] op_sel:[1,1,0] op_sel_hi:[0,1,1] neg_lo:[1,0,0]
    v_pk_fma_f32 v[58:59], v[56:57], v[56:57], v[70:71] op_sel:[1,1,0] op_sel_hi:[0,1,1] neg_lo:[1,0,0]
    v_cvt_pk_bf16_f32 v96, v36, v37
    v_cvt_pk_bf16_f32 v97, v64, v65
    v_pk_mul_f32 v[42:43], v[36:37], v[26:27] op_sel:[0,0] op_sel_hi:[1,0]
    v_pk_mul_f32 v[70:71], v[64:65], v[54:55] op_sel:[0,0] op_sel_hi:[1,0]
    v_pk_fma_f32 v[40:41], v[36:37], v[26:27], v[42:43] op_sel:[1,1,0] op_sel_hi:[0,1,1] neg_lo:[1,0,0]
    v_pk_fma_f32 v[68:69], v[64:65], v[54:55], v[70:71] op_sel:[1,1,0] op_sel_hi:[0,1,1] neg_lo:[1,0,0]
    v_cvt_pk_bf16_f32 v98, v40, v41
    v_cvt_pk_bf16_f32 v99, v68, v69
    v_pk_mul_f32 v[42:43], v[40:41], v[26:27] op_sel:[0,0] op_sel_hi:[1,0]
    v_pk_mul_f32 v[70:71], v[68:69], v[54:55] op_sel:[0,0] op_sel_hi:[1,0]
    v_pk_fma_f32 v[40:41], v[40:41], v[26:27], v[42:43] op_sel:[1,1,0] op_sel_hi:[0,1,1] neg_lo:[1,0,0]
    v_pk_fma_f32 v[68:69], v[68:69], v[54:55], v[70:71] op_sel:[1,1,0] op_sel_hi:[0,1,1] neg_lo:[1,0,0]
    v_cvt_pk_bf16_f32 v100, v40, v41
    v_cvt_pk_bf16_f32 v101, v68, v69
    v_pk_mul_f32 v[42:43], v[40:41], v[26:27] op_sel:[0,0] op_sel_hi:[1,0]
    v_pk_mul_f32 v[70:71], v[68:69], v[54:55] op_sel:[0,0] op_sel_hi:[1,0]
    v_pk_fma_f32 v[40:41], v[40:41], v[26:27], v[42:43] op_sel:[1,1,0] op_sel_hi:[0,1,1] neg_lo:[1,0,0]
    v_pk_fma_f32 v[68:69], v[68:69], v[54:55], v[70:71] op_sel:[1,1,0] op_sel_hi:[0,1,1] neg_lo:[1,0,0]
    v_cvt_pk_bf16_f32 v102, v40, v41
    v_cvt_pk_bf16_f32 v103, v68, v69
    v_pk_mul_f32 v[42:43], v[40:41], v[26:27] op_sel:[0,0] op_sel_hi:[1,0]
    v_pk_mul_f32 v[70:71], v[68:69], v[54:55] op_sel:[0,0] op_sel_hi:[1,0]
    v_pk_fma_f32 v[40:41], v[40:41], v[26:27], v[42:43] op_sel:[1,1,0] op_sel_hi:[0,1,1] neg_lo:[1,0,0]
    v_pk_fma_f32 v[68:69], v[68:69], v[54:55], v[70:71] op_sel:[1,1,0] op_sel_hi:[0,1,1] neg_lo:[1,0,0]
    v_cvt_pk_bf16_f32 v104, v40, v41
    v_cvt_pk_bf16_f32 v105, v68, v69
    v_pk_mul_f32 v[42:43], v[40:41], v[26:27] op_sel:[0,0] op_sel_hi:[1,0]
    v_pk_mul_f32 v[70:71], v[68:69], v[54:55] op_sel:[0,0] op_sel_hi:[1,0]
    v_pk_fma_f32 v[40:41], v[40:41], v[26:27], v[42:43] op_sel:[1,1,0] op_sel_hi:[0,1,1] neg_lo:[1,0,0]
    v_pk_fma_f32 v[68:69], v[68:69], v[54:55], v[70:71] op_sel:[1,1,0] op_sel_hi:[0,1,1] neg_lo:[1,0,0]
    v_cvt_pk_bf16_f32 v106, v40, v41
    v_cvt_pk_bf16_f32 v107, v68, v69
    v_pk_mul_f32 v[42:43], v[40:41], v[26:27] op_sel:[0,0] op_sel_hi:[1,0]
    v_pk_mul_f32 v[70:71], v[68:69], v[54:55] op_sel:[0,0] op_sel_hi:[1,0]
    v_pk_fma_f32 v[40:41], v[40:41], v[26:27], v[42:43] op_sel:[1,1,0] op_sel_hi:[0,1,1] neg_lo:[1,0,0]
    v_pk_fma_f32 v[68:69], v[68:69], v[54:55], v[70:71] op_sel:[1,1,0] op_sel_hi:[0,1,1] neg_lo:[1,0,0]
    v_cvt_pk_bf16_f32 v108, v40, v41
    v_cvt_pk_bf16_f32 v109, v68, v69
    v_pk_mul_f32 v[42:43], v[40:41], v[26:27] op_sel:[0,0] op_sel_hi:[1,0]
    v_pk_mul_f32 v[70:71], v[68:69], v[54:55] op_sel:[0,0] op_sel_hi:[1,0]
    v_pk_fma_f32 v[40:41], v[40:41], v[26:27], v[42:43] op_sel:[1,1,0] op_sel_hi:[0,1,1] neg_lo:[1,0,0]
    v_pk_fma_f32 v[68:69], v[68:69], v[54:55], v[70:71] op_sel:[1,1,0] op_sel_hi:[0,1,1] neg_lo:[1,0,0]
    v_cvt_pk_bf16_f32 v110, v40, v41
    v_cvt_pk_bf16_f32 v111, v68, v69
    v_pk_mul_f32 v[42:43], v[40:41], v[26:27] op_sel:[0,0] op_sel_hi:[1,0]
    v_pk_mul_f32 v[70:71], v[68:69], v[54:55] op_sel:[0,0] op_sel_hi:[1,0]
    v_pk_fma_f32 v[40:41], v[40:41], v[26:27], v[42:43] op_sel:[1,1,0] op_sel_hi:[0,1,1] neg_lo:[1,0,0]
    v_pk_fma_f32 v[68:69], v[68:69], v[54:55], v[70:71] op_sel:[1,1,0] op_sel_hi:[0,1,1] neg_lo:[1,0,0]
    v_cvt_pk_bf16_f32 v112, v40, v41
    v_cvt_pk_bf16_f32 v113, v68, v69
    v_pk_mul_f32 v[42:43], v[36:37], v[34:35] op_sel:[0,0] op_sel_hi:[1,0]
    v_pk_mul_f32 v[70:71], v[64:65], v[62:63] op_sel:[0,0] op_sel_hi:[1,0]
    v_pk_fma_f32 v[38:39], v[36:37], v[34:35], v[42:43] op_sel:[1,1,0] op_sel_hi:[0,1,1] neg_lo:[1,0,0]
    v_pk_fma_f32 v[66:67], v[64:65], v[62:63], v[70:71] op_sel:[1,1,0] op_sel_hi:[0,1,1] neg_lo:[1,0,0]
    v_cvt_pk_bf16_f32 v114, v38, v39
    v_cvt_pk_bf16_f32 v115, v66, v67
    v_pk_mul_f32 v[42:43], v[38:39], v[28:29] op_sel:[0,0] op_sel_hi:[1,0]
    v_pk_mul_f32 v[70:71], v[66:67], v[56:57] op_sel:[0,0] op_sel_hi:[1,0]
    v_pk_fma_f32 v[40:41], v[38:39], v[28:29], v[42:43] op_sel:[1,1,0] op_sel_hi:[0,1,1] neg_lo:[1,0,0]
    v_pk_fma_f32 v[68:69], v[66:67], v[56:57], v[70:71] op_sel:[1,1,0] op_sel_hi:[0,1,1] neg_lo:[1,0,0]
    v_cvt_pk_bf16_f32 v116, v40, v41
    v_cvt_pk_bf16_f32 v117, v68, v69
    v_pk_mul_f32 v[42:43], v[40:41], v[28:29] op_sel:[0,0] op_sel_hi:[1,0]
    v_pk_mul_f32 v[70:71], v[68:69], v[56:57] op_sel:[0,0] op_sel_hi:[1,0]
    v_pk_fma_f32 v[40:41], v[40:41], v[28:29], v[42:43] op_sel:[1,1,0] op_sel_hi:[0,1,1] neg_lo:[1,0,0]
    v_pk_fma_f32 v[68:69], v[68:69], v[56:57], v[70:71] op_sel:[1,1,0] op_sel_hi:[0,1,1] neg_lo:[1,0,0]
    v_cvt_pk_bf16_f32 v118, v40, v41
    v_cvt_pk_bf16_f32 v119, v68, v69
    v_pk_mul_f32 v[42:43], v[40:41], v[28:29] op_sel:[0,0] op_sel_hi:[1,0]
    v_pk_mul_f32 v[70:71], v[68:69], v[56:57] op_sel:[0,0] op_sel_hi:[1,0]
    v_pk_fma_f32 v[40:41], v[40:41], v[28:29], v[42:43] op_sel:[1,1,0] op_sel_hi:[0,1,1] neg_lo:[1,0,0]
    v_pk_fma_f32 v[68:69], v[68:69], v[56:57], v[70:71] op_sel:[1,1,0] op_sel_hi:[0,1,1] neg_lo:[1,0,0]
    v_cvt_pk_bf16_f32 v120, v40, v41
    v_cvt_pk_bf16_f32 v121, v68, v69
    v_pk_mul_f32 v[42:43], v[40:41], v[28:29] op_sel:[0,0] op_sel_hi:[1,0]
    v_pk_mul_f32 v[70:71], v[68:69], v[56:57] op_sel:[0,0] op_sel_hi:[1,0]
    v_pk_fma_f32 v[40:41], v[40:41], v[28:29], v[42:43] op_sel:[1,1,0] op_sel_hi:[0,1,1] neg_lo:[1,0,0]
    v_pk_fma_f32 v[68:69], v[68:69], v[56:57], v[70:71] op_sel:[1,1,0] op_sel_hi:[0,1,1] neg_lo:[1,0,0]
    v_cvt_pk_bf16_f32 v122, v40, v41
    v_cvt_pk_bf16_f32 v123, v68, v69
    v_pk_mul_f32 v[42:43], v[38:39], v[34:35] op_sel:[0,0] op_sel_hi:[1,0]
    v_pk_mul_f32 v[70:71], v[66:67], v[62:63] op_sel:[0,0] op_sel_hi:[1,0]
    v_pk_fma_f32 v[38:39], v[38:39], v[34:35], v[42:43] op_sel:[1,1,0] op_sel_hi:[0,1,1] neg_lo:[1,0,0]
    v_pk_fma_f32 v[66:67], v[66:67], v[62:63], v[70:71] op_sel:[1,1,0] op_sel_hi:[0,1,1] neg_lo:[1,0,0]
    v_cvt_pk_bf16_f32 v124, v38, v39
    v_cvt_pk_bf16_f32 v125, v66, v67
    v_pk_mul_f32 v[42:43], v[38:39], v[30:31] op_sel:[0,0] op_sel_hi:[1,0]
    v_pk_mul_f32 v[70:71], v[66:67], v[58:59] op_sel:[0,0] op_sel_hi:[1,0]
    v_pk_fma_f32 v[40:41], v[38:39], v[30:31], v[42:43] op_sel:[1,1,0] op_sel_hi:[0,1,1] neg_lo:[1,0,0]
    v_pk_fma_f32 v[68:69], v[66:67], v[58:59], v[70:71] op_sel:[1,1,0] op_sel_hi:[0,1,1] neg_lo:[1,0,0]
    v_cvt_pk_bf16_f32 v126, v40, v41
    v_cvt_pk_bf16_f32 v127, v68, v69
    v_pk_mul_f32 v[42:43], v[40:41], v[30:31] op_sel:[0,0] op_sel_hi:[1,0]
    v_pk_mul_f32 v[70:71], v[68:69], v[58:59] op_sel:[0,0] op_sel_hi:[1,0]
    v_pk_fma_f32 v[40:41], v[40:41], v[30:31], v[42:43] op_sel:[1,1,0] op_sel_hi:[0,1,1] neg_lo:[1,0,0]
    v_pk_fma_f32 v[68:69], v[68:69], v[58:59], v[70:71] op_sel:[1,1,0] op_sel_hi:[0,1,1] neg_lo:[1,0,0]
    v_cvt_pk_bf16_f32 v128, v40, v41
    v_cvt_pk_bf16_f32 v129, v68, v69
    v_pk_mul_f32 v[42:43], v[38:39], v[34:35] op_sel:[0,0] op_sel_hi:[1,0]
    v_pk_mul_f32 v[70:71], v[66:67], v[62:63] op_sel:[0,0] op_sel_hi:[1,0]
    v_pk_fma_f32 v[38:39], v[38:39], v[34:35], v[42:43] op_sel:[1,1,0] op_sel_hi:[0,1,1] neg_lo:[1,0,0]
    v_pk_fma_f32 v[66:67], v[66:67], v[62:63], v[70:71] op_sel:[1,1,0] op_sel_hi:[0,1,1] neg_lo:[1,0,0]
    v_cvt_pk_bf16_f32 v130, v38, v39
    v_cvt_pk_bf16_f32 v131, v66, v67
    v_pk_mul_f32 v[42:43], v[38:39], v[30:31] op_sel:[0,0] op_sel_hi:[1,0]
    v_pk_mul_f32 v[70:71], v[66:67], v[58:59] op_sel:[0,0] op_sel_hi:[1,0]
    v_pk_fma_f32 v[40:41], v[38:39], v[30:31], v[42:43] op_sel:[1,1,0] op_sel_hi:[0,1,1] neg_lo:[1,0,0]
    v_pk_fma_f32 v[68:69], v[66:67], v[58:59], v[70:71] op_sel:[1,1,0] op_sel_hi:[0,1,1] neg_lo:[1,0,0]
    v_cvt_pk_bf16_f32 v132, v40, v41
    v_cvt_pk_bf16_f32 v133, v68, v69
    v_pk_mul_f32 v[42:43], v[40:41], v[30:31] op_sel:[0,0] op_sel_hi:[1,0]
    v_pk_mul_f32 v[70:71], v[68:69], v[58:59] op_sel:[0,0] op_sel_hi:[1,0]
    v_pk_fma_f32 v[40:41], v[40:41], v[30:31], v[42:43] op_sel:[1,1,0] op_sel_hi:[0,1,1] neg_lo:[1,0,0]
    v_pk_fma_f32 v[68:69], v[68:69], v[58:59], v[70:71] op_sel:[1,1,0] op_sel_hi:[0,1,1] neg_lo:[1,0,0]
    v_cvt_pk_bf16_f32 v134, v40, v41
    v_cvt_pk_bf16_f32 v135, v68, v69
    v_pk_mul_f32 v[42:43], v[38:39], v[34:35] op_sel:[0,0] op_sel_hi:[1,0]
    v_pk_mul_f32 v[70:71], v[66:67], v[62:63] op_sel:[0,0] op_sel_hi:[1,0]
    v_pk_fma_f32 v[38:39], v[38:39], v[34:35], v[42:43] op_sel:[1,1,0] op_sel_hi:[0,1,1] neg_lo:[1,0,0]
    v_pk_fma_f32 v[66:67], v[66:67], v[62:63], v[70:71] op_sel:[1,1,0] op_sel_hi:[0,1,1] neg_lo:[1,0,0]
    v_cvt_pk_bf16_f32 v136, v38, v39
    v_cvt_pk_bf16_f32 v137, v66, v67
    v_pk_mul_f32 v[42:43], v[38:39], v[32:33] op_sel:[0,0] op_sel_hi:[1,0]
    v_pk_mul_f32 v[70:71], v[66:67], v[60:61] op_sel:[0,0] op_sel_hi:[1,0]
    v_pk_fma_f32 v[40:41], v[38:39], v[32:33], v[42:43] op_sel:[1,1,0] op_sel_hi:[0,1,1] neg_lo:[1,0,0]
    v_pk_fma_f32 v[68:69], v[66:67], v[60:61], v[70:71] op_sel:[1,1,0] op_sel_hi:[0,1,1] neg_lo:[1,0,0]
    v_cvt_pk_bf16_f32 v138, v40, v41
    v_cvt_pk_bf16_f32 v139, v68, v69
    v_pk_mul_f32 v[42:43], v[38:39], v[34:35] op_sel:[0,0] op_sel_hi:[1,0]
    v_pk_mul_f32 v[70:71], v[66:67], v[62:63] op_sel:[0,0] op_sel_hi:[1,0]
    v_pk_fma_f32 v[38:39], v[38:39], v[34:35], v[42:43] op_sel:[1,1,0] op_sel_hi:[0,1,1] neg_lo:[1,0,0]
    v_pk_fma_f32 v[66:67], v[66:67], v[62:63], v[70:71] op_sel:[1,1,0] op_sel_hi:[0,1,1] neg_lo:[1,0,0]
    v_cvt_pk_bf16_f32 v140, v38, v39
    v_cvt_pk_bf16_f32 v141, v66, v67
    v_pk_mul_f32 v[42:43], v[38:39], v[32:33] op_sel:[0,0] op_sel_hi:[1,0]
    v_pk_mul_f32 v[70:71], v[66:67], v[60:61] op_sel:[0,0] op_sel_hi:[1,0]
    v_pk_fma_f32 v[40:41], v[38:39], v[32:33], v[42:43] op_sel:[1,1,0] op_sel_hi:[0,1,1] neg_lo:[1,0,0]
    v_pk_fma_f32 v[68:69], v[66:67], v[60:61], v[70:71] op_sel:[1,1,0] op_sel_hi:[0,1,1] neg_lo:[1,0,0]
    v_cvt_pk_bf16_f32 v142, v40, v41
    v_cvt_pk_bf16_f32 v143, v68, v69
    v_pk_mul_f32 v[42:43], v[38:39], v[34:35] op_sel:[0,0] op_sel_hi:[1,0]
    v_pk_mul_f32 v[70:71], v[66:67], v[62:63] op_sel:[0,0] op_sel_hi:[1,0]
    v_pk_fma_f32 v[38:39], v[38:39], v[34:35], v[42:43] op_sel:[1,1,0] op_sel_hi:[0,1,1] neg_lo:[1,0,0]
    v_pk_fma_f32 v[66:67], v[66:67], v[62:63], v[70:71] op_sel:[1,1,0] op_sel_hi:[0,1,1] neg_lo:[1,0,0]
    v_cvt_pk_bf16_f32 v144, v38, v39
    v_cvt_pk_bf16_f32 v145, v66, v67
    v_pk_mul_f32 v[42:43], v[38:39], v[32:33] op_sel:[0,0] op_sel_hi:[1,0]
    v_pk_mul_f32 v[70:71], v[66:67], v[60:61] op_sel:[0,0] op_sel_hi:[1,0]
    v_pk_fma_f32 v[40:41], v[38:39], v[32:33], v[42:43] op_sel:[1,1,0] op_sel_hi:[0,1,1] neg_lo:[1,0,0]
    v_pk_fma_f32 v[68:69], v[66:67], v[60:61], v[70:71] op_sel:[1,1,0] op_sel_hi:[0,1,1] neg_lo:[1,0,0]
    v_cvt_pk_bf16_f32 v146, v40, v41
    v_cvt_pk_bf16_f32 v147, v68, v69
    v_pk_mul_f32 v[42:43], v[38:39], v[34:35] op_sel:[0,0] op_sel_hi:[1,0]
    v_pk_mul_f32 v[70:71], v[66:67], v[62:63] op_sel:[0,0] op_sel_hi:[1,0]
    v_pk_fma_f32 v[38:39], v[38:39], v[34:35], v[42:43] op_sel:[1,1,0] op_sel_hi:[0,1,1] neg_lo:[1,0,0]
    v_pk_fma_f32 v[66:67], v[66:67], v[62:63], v[70:71] op_sel:[1,1,0] op_sel_hi:[0,1,1] neg_lo:[1,0,0]
    v_cvt_pk_bf16_f32 v148, v38, v39
    v_cvt_pk_bf16_f32 v149, v66, v67
    v_pk_mul_f32 v[42:43], v[38:39], v[32:33] op_sel:[0,0] op_sel_hi:[1,0]
    v_pk_mul_f32 v[70:71], v[66:67], v[60:61] op_sel:[0,0] op_sel_hi:[1,0]
    v_pk_fma_f32 v[40:41], v[38:39], v[32:33], v[42:43] op_sel:[1,1,0] op_sel_hi:[0,1,1] neg_lo:[1,0,0]
    v_pk_fma_f32 v[68:69], v[66:67], v[60:61], v[70:71] op_sel:[1,1,0] op_sel_hi:[0,1,1] neg_lo:[1,0,0]
    v_cvt_pk_bf16_f32 v150, v40, v41
    v_cvt_pk_bf16_f32 v151, v68, v69
    v_xor_b32 v33, 0x80000000, v33
    v_xor_b32 v61, 0x80000000, v61
    v_mov_b32 v152, 0x3f80
    v_mov_b32 v153, 0x3f80
    v_cvt_pk_bf16_f32 v154, v32, v33
    v_cvt_pk_bf16_f32 v155, v60, v61
    v_pk_mul_f32 v[42:43], v[32:33], v[32:33] op_sel:[0,0] op_sel_hi:[1,0]
    v_pk_mul_f32 v[70:71], v[60:61], v[60:61] op_sel:[0,0] op_sel_hi:[1,0]
    v_pk_fma_f32 v[40:41], v[32:33], v[32:33], v[42:43] op_sel:[1,1,0] op_sel_hi:[0,1,1] neg_lo:[1,0,0]
    v_pk_fma_f32 v[68:69], v[60:61], v[60:61], v[70:71] op_sel:[1,1,0] op_sel_hi:[0,1,1] neg_lo:[1,0,0]
    v_cvt_pk_bf16_f32 v156, v40, v41
    v_cvt_pk_bf16_f32 v157, v68, v69
    v_pk_mul_f32 v[42:43], v[40:41], v[32:33] op_sel:[0,0] op_sel_hi:[1,0]
    v_pk_mul_f32 v[70:71], v[68:69], v[60:61] op_sel:[0,0] op_sel_hi:[1,0]
    v_pk_fma_f32 v[40:41], v[40:41], v[32:33], v[42:43] op_sel:[1,1,0] op_sel_hi:[0,1,1] neg_lo:[1,0,0]
    v_pk_fma_f32 v[68:69], v[68:69], v[60:61], v[70:71] op_sel:[1,1,0] op_sel_hi:[0,1,1] neg_lo:[1,0,0]
    v_cvt_pk_bf16_f32 v158, v40, v41
    v_cvt_pk_bf16_f32 v159, v68, v69
    v_pk_mul_f32 v[42:43], v[40:41], v[32:33] op_sel:[0,0] op_sel_hi:[1,0]
    v_pk_mul_f32 v[70:71], v[68:69], v[60:61] op_sel:[0,0] op_sel_hi:[1,0]
    v_pk_fma_f32 v[40:41], v[40:41], v[32:33], v[42:43] op_sel:[1,1,0] op_sel_hi:[0,1,1] neg_lo:[1,0,0]
    v_pk_fma_f32 v[68:69], v[68:69], v[60:61], v[70:71] op_sel:[1,1,0] op_sel_hi:[0,1,1] neg_lo:[1,0,0]
    v_cvt_pk_bf16_f32 v160, v40, v41
    v_cvt_pk_bf16_f32 v161, v68, v69
    v_pk_mul_f32 v[42:43], v[40:41], v[32:33] op_sel:[0,0] op_sel_hi:[1,0]
    v_pk_mul_f32 v[70:71], v[68:69], v[60:61] op_sel:[0,0] op_sel_hi:[1,0]
    v_pk_fma_f32 v[40:41], v[40:41], v[32:33], v[42:43] op_sel:[1,1,0] op_sel_hi:[0,1,1] neg_lo:[1,0,0]
    v_pk_fma_f32 v[68:69], v[68:69], v[60:61], v[70:71] op_sel:[1,1,0] op_sel_hi:[0,1,1] neg_lo:[1,0,0]
    v_cvt_pk_bf16_f32 v162, v40, v41
    v_cvt_pk_bf16_f32 v163, v68, v69
    v_pk_mul_f32 v[42:43], v[40:41], v[32:33] op_sel:[0,0] op_sel_hi:[1,0]
    v_pk_mul_f32 v[70:71], v[68:69], v[60:61] op_sel:[0,0] op_sel_hi:[1,0]
    v_pk_fma_f32 v[40:41], v[40:41], v[32:33], v[42:43] op_sel:[1,1,0] op_sel_hi:[0,1,1] neg_lo:[1,0,0]
    v_pk_fma_f32 v[68:69], v[68:69], v[60:61], v[70:71] op_sel:[1,1,0] op_sel_hi:[0,1,1] neg_lo:[1,0,0]
    v_cvt_pk_bf16_f32 v164, v40, v41
    v_cvt_pk_bf16_f32 v165, v68, v69
    v_pk_mul_f32 v[42:43], v[40:41], v[32:33] op_sel:[0,0] op_sel_hi:[1,0]
    v_pk_mul_f32 v[70:71], v[68:69], v[60:61] op_sel:[0,0] op_sel_hi:[1,0]
    v_pk_fma_f32 v[40:41], v[40:41], v[32:33], v[42:43] op_sel:[1,1,0] op_sel_hi:[0,1,1] neg_lo:[1,0,0]
    v_pk_fma_f32 v[68:69], v[68:69], v[60:61], v[70:71] op_sel:[1,1,0] op_sel_hi:[0,1,1] neg_lo:[1,0,0]
    v_cvt_pk_bf16_f32 v166, v40, v41
    v_cvt_pk_bf16_f32 v167, v68, v69
    v_pk_mul_f32 v[42:43], v[40:41], v[32:33] op_sel:[0,0] op_sel_hi:[1,0]
    v_pk_mul_f32 v[70:71], v[68:69], v[60:61] op_sel:[0,0] op_sel_hi:[1,0]
    v_pk_fma_f32 v[40:41], v[40:41], v[32:33], v[42:43] op_sel:[1,1,0] op_sel_hi:[0,1,1] neg_lo:[1,0,0]
    v_pk_fma_f32 v[68:69], v[68:69], v[60:61], v[70:71] op_sel:[1,1,0] op_sel_hi:[0,1,1] neg_lo:[1,0,0]
    v_cvt_pk_bf16_f32 v168, v40, v41
    v_cvt_pk_bf16_f32 v169, v68, v69
    v_pk_mul_f32 v[42:43], v[40:41], v[32:33] op_sel:[0,0] op_sel_hi:[1,0]
    v_pk_mul_f32 v[70:71], v[68:69], v[60:61] op_sel:[0,0] op_sel_hi:[1,0]
    v_pk_fma_f32 v[40:41], v[40:41], v[32:33], v[42:43] op_sel:[1,1,0] op_sel_hi:[0,1,1] neg_lo:[1,0,0]
    v_pk_fma_f32 v[68:69], v[68:69], v[60:61], v[70:71] op_sel:[1,1,0] op_sel_hi:[0,1,1] neg_lo:[1,0,0]
    v_cvt_pk_bf16_f32 v170, v40, v41
    v_cvt_pk_bf16_f32 v171, v68, v69
    v_pk_mul_f32 v[42:43], v[40:41], v[32:33] op_sel:[0,0] op_sel_hi:[1,0]
    v_pk_mul_f32 v[70:71], v[68:69], v[60:61] op_sel:[0,0] op_sel_hi:[1,0]
    v_pk_fma_f32 v[40:41], v[40:41], v[32:33], v[42:43] op_sel:[1,1,0] op_sel_hi:[0,1,1] neg_lo:[1,0,0]
    v_pk_fma_f32 v[68:69], v[68:69], v[60:61], v[70:71] op_sel:[1,1,0] op_sel_hi:[0,1,1] neg_lo:[1,0,0]
    v_cvt_pk_bf16_f32 v172, v40, v41
    v_cvt_pk_bf16_f32 v173, v68, v69
    v_pk_mul_f32 v[42:43], v[40:41], v[32:33] op_sel:[0,0] op_sel_hi:[1,0]
    v_pk_mul_f32 v[70:71], v[68:69], v[60:61] op_sel:[0,0] op_sel_hi:[1,0]
    v_pk_fma_f32 v[40:41], v[40:41], v[32:33], v[42:43] op_sel:[1,1,0] op_sel_hi:[0,1,1] neg_lo:[1,0,0]
    v_pk_fma_f32 v[68:69], v[68:69], v[60:61], v[70:71] op_sel:[1,1,0] op_sel_hi:[0,1,1] neg_lo:[1,0,0]
    v_cvt_pk_bf16_f32 v174, v40, v41
    v_cvt_pk_bf16_f32 v175, v68, v69
    v_pk_mul_f32 v[42:43], v[40:41], v[32:33] op_sel:[0,0] op_sel_hi:[1,0]
    v_pk_mul_f32 v[70:71], v[68:69], v[60:61] op_sel:[0,0] op_sel_hi:[1,0]
    v_pk_fma_f32 v[40:41], v[40:41], v[32:33], v[42:43] op_sel:[1,1,0] op_sel_hi:[0,1,1] neg_lo:[1,0,0]
    v_pk_fma_f32 v[68:69], v[68:69], v[60:61], v[70:71] op_sel:[1,1,0] op_sel_hi:[0,1,1] neg_lo:[1,0,0]
    v_cvt_pk_bf16_f32 v176, v40, v41
    v_cvt_pk_bf16_f32 v177, v68, v69
    v_pk_mul_f32 v[42:43], v[40:41], v[32:33] op_sel:[0,0] op_sel_hi:[1,0]
    v_pk_mul_f32 v[70:71], v[68:69], v[60:61] op_sel:[0,0] op_sel_hi:[1,0]
    v_pk_fma_f32 v[40:41], v[40:41], v[32:33], v[42:43] op_sel:[1,1,0] op_sel_hi:[0,1,1] neg_lo:[1,0,0]
    v_pk_fma_f32 v[68:69], v[68:69], v[60:61], v[70:71] op_sel:[1,1,0] op_sel_hi:[0,1,1] neg_lo:[1,0,0]
    v_cvt_pk_bf16_f32 v178, v40, v41
    v_cvt_pk_bf16_f32 v179, v68, v69
    v_pk_mul_f32 v[42:43], v[40:41], v[32:33] op_sel:[0,0] op_sel_hi:[1,0]
    v_pk_mul_f32 v[70:71], v[68:69], v[60:61] op_sel:[0,0] op_sel_hi:[1,0]
    v_pk_fma_f32 v[40:41], v[40:41], v[32:33], v[42:43] op_sel:[1,1,0] op_sel_hi:[0,1,1] neg_lo:[1,0,0]
    v_pk_fma_f32 v[68:69], v[68:69], v[60:61], v[70:71] op_sel:[1,1,0] op_sel_hi:[0,1,1] neg_lo:[1,0,0]
    v_cvt_pk_bf16_f32 v180, v40, v41
    v_cvt_pk_bf16_f32 v181, v68, v69
    v_pk_mul_f32 v[42:43], v[40:41], v[32:33] op_sel:[0,0] op_sel_hi:[1,0]
    v_pk_mul_f32 v[70:71], v[68:69], v[60:61] op_sel:[0,0] op_sel_hi:[1,0]
    v_pk_fma_f32 v[40:41], v[40:41], v[32:33], v[42:43] op_sel:[1,1,0] op_sel_hi:[0,1,1] neg_lo:[1,0,0]
    v_pk_fma_f32 v[68:69], v[68:69], v[60:61], v[70:71] op_sel:[1,1,0] op_sel_hi:[0,1,1] neg_lo:[1,0,0]
    v_cvt_pk_bf16_f32 v182, v40, v41
    v_cvt_pk_bf16_f32 v183, v68, v69
    v_pk_mul_f32 v[42:43], v[40:41], v[32:33] op_sel:[0,0] op_sel_hi:[1,0]
    v_pk_mul_f32 v[70:71], v[68:69], v[60:61] op_sel:[0,0] op_sel_hi:[1,0]
    v_pk_fma_f32 v[40:41], v[40:41], v[32:33], v[42:43] op_sel:[1,1,0] op_sel_hi:[0,1,1] neg_lo:[1,0,0]
    v_pk_fma_f32 v[68:69], v[68:69], v[60:61], v[70:71] op_sel:[1,1,0] op_sel_hi:[0,1,1] neg_lo:[1,0,0]
    v_cvt_pk_bf16_f32 v184, v40, v41
    v_cvt_pk_bf16_f32 v185, v68, v69
    v_pk_mul_f32 v[42:43], v[40:41], v[32:33] op_sel:[0,0] op_sel_hi:[1,0]
    v_pk_mul_f32 v[70:71], v[68:69], v[60:61] op_sel:[0,0] op_sel_hi:[1,0]
    v_pk_fma_f32 v[40:41], v[40:41], v[32:33], v[42:43] op_sel:[1,1,0] op_sel_hi:[0,1,1] neg_lo:[1,0,0]
    v_pk_fma_f32 v[68:69], v[68:69], v[60:61], v[70:71] op_sel:[1,1,0] op_sel_hi:[0,1,1] neg_lo:[1,0,0]
    v_cvt_pk_bf16_f32 v186, v40, v41
    v_cvt_pk_bf16_f32 v187, v68, v69
    v_pk_mul_f32 v[42:43], v[40:41], v[32:33] op_sel:[0,0] op_sel_hi:[1,0]
    v_pk_mul_f32 v[70:71], v[68:69], v[60:61] op_sel:[0,0] op_sel_hi:[1,0]
    v_pk_fma_f32 v[40:41], v[40:41], v[32:33], v[42:43] op_sel:[1,1,0] op_sel_hi:[0,1,1] neg_lo:[1,0,0]
    v_pk_fma_f32 v[68:69], v[68:69], v[60:61], v[70:71] op_sel:[1,1,0] op_sel_hi:[0,1,1] neg_lo:[1,0,0]
    v_cvt_pk_bf16_f32 v188, v40, v41
    v_cvt_pk_bf16_f32 v189, v68, v69
    v_pk_mul_f32 v[42:43], v[40:41], v[32:33] op_sel:[0,0] op_sel_hi:[1,0]
    v_pk_mul_f32 v[70:71], v[68:69], v[60:61] op_sel:[0,0] op_sel_hi:[1,0]
    v_pk_fma_f32 v[40:41], v[40:41], v[32:33], v[42:43] op_sel:[1,1,0] op_sel_hi:[0,1,1] neg_lo:[1,0,0]
    v_pk_fma_f32 v[68:69], v[68:69], v[60:61], v[70:71] op_sel:[1,1,0] op_sel_hi:[0,1,1] neg_lo:[1,0,0]
    v_cvt_pk_bf16_f32 v190, v40, v41
    v_cvt_pk_bf16_f32 v191, v68, v69
    v_pk_mul_f32 v[42:43], v[40:41], v[32:33] op_sel:[0,0] op_sel_hi:[1,0]
    v_pk_mul_f32 v[70:71], v[68:69], v[60:61] op_sel:[0,0] op_sel_hi:[1,0]
    v_pk_fma_f32 v[40:41], v[40:41], v[32:33], v[42:43] op_sel:[1,1,0] op_sel_hi:[0,1,1] neg_lo:[1,0,0]
    v_pk_fma_f32 v[68:69], v[68:69], v[60:61], v[70:71] op_sel:[1,1,0] op_sel_hi:[0,1,1] neg_lo:[1,0,0]
    v_cvt_pk_bf16_f32 v192, v40, v41
    v_cvt_pk_bf16_f32 v193, v68, v69
    v_pk_mul_f32 v[42:43], v[40:41], v[32:33] op_sel:[0,0] op_sel_hi:[1,0]
    v_pk_mul_f32 v[70:71], v[68:69], v[60:61] op_sel:[0,0] op_sel_hi:[1,0]
    v_pk_fma_f32 v[40:41], v[40:41], v[32:33], v[42:43] op_sel:[1,1,0] op_sel_hi:[0,1,1] neg_lo:[1,0,0]
    v_pk_fma_f32 v[68:69], v[68:69], v[60:61], v[70:71] op_sel:[1,1,0] op_sel_hi:[0,1,1] neg_lo:[1,0,0]
    v_cvt_pk_bf16_f32 v194, v40, v41
    v_cvt_pk_bf16_f32 v195, v68, v69
    v_pk_mul_f32 v[42:43], v[40:41], v[32:33] op_sel:[0,0] op_sel_hi:[1,0]
    v_pk_mul_f32 v[70:71], v[68:69], v[60:61] op_sel:[0,0] op_sel_hi:[1,0]
    v_pk_fma_f32 v[40:41], v[40:41], v[32:33], v[42:43] op_sel:[1,1,0] op_sel_hi:[0,1,1] neg_lo:[1,0,0]
    v_pk_fma_f32 v[68:69], v[68:69], v[60:61], v[70:71] op_sel:[1,1,0] op_sel_hi:[0,1,1] neg_lo:[1,0,0]
    v_cvt_pk_bf16_f32 v196, v40, v41
    v_cvt_pk_bf16_f32 v197, v68, v69
    v_pk_mul_f32 v[42:43], v[40:41], v[32:33] op_sel:[0,0] op_sel_hi:[1,0]
    v_pk_mul_f32 v[70:71], v[68:69], v[60:61] op_sel:[0,0] op_sel_hi:[1,0]
    v_pk_fma_f32 v[40:41], v[40:41], v[32:33], v[42:43] op_sel:[1,1,0] op_sel_hi:[0,1,1] neg_lo:[1,0,0]
    v_pk_fma_f32 v[68:69], v[68:69], v[60:61], v[70:71] op_sel:[1,1,0] op_sel_hi:[0,1,1] neg_lo:[1,0,0]
    v_cvt_pk_bf16_f32 v198, v40, v41
    v_cvt_pk_bf16_f32 v199, v68, v69
    v_pk_mul_f32 v[42:43], v[40:41], v[32:33] op_sel:[0,0] op_sel_hi:[1,0]
    v_pk_mul_f32 v[70:71], v[68:69], v[60:61] op_sel:[0,0] op_sel_hi:[1,0]
    v_pk_fma_f32 v[40:41], v[40:41], v[32:33], v[42:43] op_sel:[1,1,0] op_sel_hi:[0,1,1] neg_lo:[1,0,0]
    v_pk_fma_f32 v[68:69], v[68:69], v[60:61], v[70:71] op_sel:[1,1,0] op_sel_hi:[0,1,1] neg_lo:[1,0,0]
    v_cvt_pk_bf16_f32 v200, v40, v41
    v_cvt_pk_bf16_f32 v201, v68, v69
    v_pk_mul_f32 v[42:43], v[40:41], v[32:33] op_sel:[0,0] op_sel_hi:[1,0]
    v_pk_mul_f32 v[70:71], v[68:69], v[60:61] op_sel:[0,0] op_sel_hi:[1,0]
    v_pk_fma_f32 v[40:41], v[40:41], v[32:33], v[42:43] op_sel:[1,1,0] op_sel_hi:[0,1,1] neg_lo:[1,0,0]
    v_pk_fma_f32 v[68:69], v[68:69], v[60:61], v[70:71] op_sel:[1,1,0] op_sel_hi:[0,1,1] neg_lo:[1,0,0]
    v_cvt_pk_bf16_f32 v202, v40, v41
    v_cvt_pk_bf16_f32 v203, v68, v69
    v_pk_mul_f32 v[42:43], v[40:41], v[32:33] op_sel:[0,0] op_sel_hi:[1,0]
    v_pk_mul_f32 v[70:71], v[68:69], v[60:61] op_sel:[0,0] op_sel_hi:[1,0]
    v_pk_fma_f32 v[40:41], v[40:41], v[32:33], v[42:43] op_sel:[1,1,0] op_sel_hi:[0,1,1] neg_lo:[1,0,0]
    v_pk_fma_f32 v[68:69], v[68:69], v[60:61], v[70:71] op_sel:[1,1,0] op_sel_hi:[0,1,1] neg_lo:[1,0,0]
    v_cvt_pk_bf16_f32 v204, v40, v41
    v_cvt_pk_bf16_f32 v205, v68, v69
    v_pk_mul_f32 v[42:43], v[40:41], v[32:33] op_sel:[0,0] op_sel_hi:[1,0]
    v_pk_mul_f32 v[70:71], v[68:69], v[60:61] op_sel:[0,0] op_sel_hi:[1,0]
    v_pk_fma_f32 v[40:41], v[40:41], v[32:33], v[42:43] op_sel:[1,1,0] op_sel_hi:[0,1,1] neg_lo:[1,0,0]
    v_pk_fma_f32 v[68:69], v[68:69], v[60:61], v[70:71] op_sel:[1,1,0] op_sel_hi:[0,1,1] neg_lo:[1,0,0]
    v_cvt_pk_bf16_f32 v206, v40, v41
    v_cvt_pk_bf16_f32 v207, v68, v69
    v_pk_mul_f32 v[42:43], v[40:41], v[32:33] op_sel:[0,0] op_sel_hi:[1,0]
    v_pk_mul_f32 v[70:71], v[68:69], v[60:61] op_sel:[0,0] op_sel_hi:[1,0]
    v_pk_fma_f32 v[40:41], v[40:41], v[32:33], v[42:43] op_sel:[1,1,0] op_sel_hi:[0,1,1] neg_lo:[1,0,0]
    v_pk_fma_f32 v[68:69], v[68:69], v[60:61], v[70:71] op_sel:[1,1,0] op_sel_hi:[0,1,1] neg_lo:[1,0,0]
    v_cvt_pk_bf16_f32 v208, v40, v41
    v_cvt_pk_bf16_f32 v209, v68, v69
    v_pk_mul_f32 v[42:43], v[40:41], v[32:33] op_sel:[0,0] op_sel_hi:[1,0]
    v_pk_mul_f32 v[70:71], v[68:69], v[60:61] op_sel:[0,0] op_sel_hi:[1,0]
    v_pk_fma_f32 v[40:41], v[40:41], v[32:33], v[42:43] op_sel:[1,1,0] op_sel_hi:[0,1,1] neg_lo:[1,0,0]
    v_pk_fma_f32 v[68:69], v[68:69], v[60:61], v[70:71] op_sel:[1,1,0] op_sel_hi:[0,1,1] neg_lo:[1,0,0]
    v_cvt_pk_bf16_f32 v210, v40, v41
    v_cvt_pk_bf16_f32 v211, v68, v69
    v_pk_mul_f32 v[42:43], v[40:41], v[32:33] op_sel:[0,0] op_sel_hi:[1,0]
    v_pk_mul_f32 v[70:71], v[68:69], v[60:61] op_sel:[0,0] op_sel_hi:[1,0]
    v_pk_fma_f32 v[40:41], v[40:41], v[32:33], v[42:43] op_sel:[1,1,0] op_sel_hi:[0,1,1] neg_lo:[1,0,0]
    v_pk_fma_f32 v[68:69], v[68:69], v[60:61], v[70:71] op_sel:[1,1,0] op_sel_hi:[0,1,1] neg_lo:[1,0,0]
    v_cvt_pk_bf16_f32 v212, v40, v41
    v_cvt_pk_bf16_f32 v213, v68, v69
    v_pk_mul_f32 v[42:43], v[40:41], v[32:33] op_sel:[0,0] op_sel_hi:[1,0]
    v_pk_mul_f32 v[70:71], v[68:69], v[60:61] op_sel:[0,0] op_sel_hi:[1,0]
    v_pk_fma_f32 v[40:41], v[40:41], v[32:33], v[42:43] op_sel:[1,1,0] op_sel_hi:[0,1,1] neg_lo:[1,0,0]
    v_pk_fma_f32 v[68:69], v[68:69], v[60:61], v[70:71] op_sel:[1,1,0] op_sel_hi:[0,1,1] neg_lo:[1,0,0]
    v_cvt_pk_bf16_f32 v214, v40, v41
    v_cvt_pk_bf16_f32 v215, v68, v69
    v_mov_b32 v85, 163756
    s_mov_b32 s61, 3200000
L_spin_ring:
    ds_read_b32 v86, v85
    s_sub_u32 s61, s61, 1
    s_cmp_eq_u32 s61, 0
    s_cbranch_scc1 L_spun_ring
    s_waitcnt lgkmcnt(0)
    v_cmp_gt_u32 vcc, 4, v86
    s_nop 0
    s_cbranch_vccnz L_spin_ring
L_spun_ring:
    s_waitcnt lgkmcnt(0)
    s_mul_i32 s62, s3, 16896
    s_add_u32 s62, s62, 19456
    v_lshl_add_u32 v85, v0, 3, s62
    v_add_u32 v86, 67584, v85
    ds_write_b64 v86, v[96:97] offset:0
    ds_write_b64 v86, v[98:99] offset:528
    ds_write_b64 v86, v[100:101] offset:1056
    ds_write_b64 v86, v[102:103] offset:1584
    ds_write_b64 v86, v[104:105] offset:4224
    ds_write_b64 v86, v[106:107] offset:4752
    ds_write_b64 v86, v[108:109] offset:5280
    ds_write_b64 v86, v[110:111] offset:5808
    ds_write_b64 v86, v[112:113] offset:8448
    ds_write_b64 v86, v[114:115] offset:2112
    ds_write_b64 v86, v[114:115] offset:2640
    ds_write_b64 v86, v[116:117] offset:3168
    ds_write_b64 v86, v[118:119] offset:3696
    ds_write_b64 v86, v[118:119] offset:6336
    ds_write_b64 v86, v[118:119] offset:6864
    ds_write_b64 v86, v[120:121] offset:7392
    ds_write_b64 v86, v[122:123] offset:7920
    ds_write_b64 v86, v[122:123] offset:10560
    ds_write_b64 v86, v[124:125] offset:8976
    ds_write_b64 v86, v[126:127] offset:9504
    ds_write_b64 v86, v[128:129] offset:10032
    ds_write_b64 v86, v[130:131] offset:11088
    ds_write_b64 v86, v[132:133] offset:11616
    ds_write_b64 v86, v[134:135] offset:12144
    ds_write_b64 v86, v[136:137] offset:12672
    ds_write_b64 v86, v[138:139] offset:13200
    ds_write_b64 v86, v[140:141] offset:13728
    ds_write_b64 v86, v[142:143] offset:14256
    ds_write_b64 v86, v[144:145] offset:14784
    ds_write_b64 v86, v[146:147] offset:15312
    ds_write_b64 v86, v[148:149] offset:15840
    ds_write_b64 v86, v[150:151] offset:16368
    ds_write_b64 v85, v[152:153] offset:0
    ds_write_b64 v85, v[154:155] offset:528
    ds_write_b64 v85, v[156:157] offset:1056
    ds_write_b64 v85, v[158:159] offset:1584
    ds_write_b64 v85, v[160:161] offset:2112
    ds_write_b64 v85, v[162:163] offset:2640
    ds_write_b64 v85, v[164:165] offset:3168
    ds_write_b64 v85, v[166:167] offset:3696
    ds_write_b64 v85, v[168:169] offset:4224
    ds_write_b64 v85, v[170:171] offset:4752
    ds_write_b64 v85, v[172:173] offset:5280
    ds_write_b64 v85, v[174:175] offset:5808
    ds_write_b64 v85, v[176:177] offset:6336
    ds_write_b64 v85, v[178:179] offset:6864
    ds_write_b64 v85, v[180:181] offset:7392
    ds_write_b64 v85, v[182:183] offset:7920
    ds_write_b64 v85, v[184:185] offset:8448
    ds_write_b64 v85, v[186:187] offset:8976
    ds_write_b64 v85, v[188:189] offset:9504
    ds_write_b64 v85, v[190:191] offset:10032
    ds_write_b64 v85, v[192:193] offset:10560
    ds_write_b64 v85, v[194:195] offset:11088
    ds_write_b64 v85, v[196:197] offset:11616
    ds_write_b64 v85, v[198:199] offset:12144
    ds_write_b64 v85, v[200:201] offset:12672
    ds_write_b64 v85, v[202:203] offset:13200
    ds_write_b64 v85, v[204:205] offset:13728
    ds_write_b64 v85, v[206:207] offset:14256
    ds_write_b64 v85, v[208:209] offset:14784
    ds_write_b64 v85, v[210:211] offset:15312
    ds_write_b64 v85, v[212:213] offset:15840
    ds_write_b64 v85, v[214:215] offset:16368
    v_lshlrev_b32 v15, 16, v23
    v_cmp_eq_u32 vcc, 0, v0
    v_and_b32 v212, 31, v0
    v_mul_u32_u24 v212, 528, v212
    v_cndmask_b32 v15, 0, v15, vcc
    v_lshrrev_b32 v213, 5, v0
    v_lshlrev_b32 v213, 4, v213
    v_add3_u32 v212, v212, v213, s62
    v_add_u32 v213, 67584, v212
    ds_read_b128 v[32:35], v213 offset:0
    ds_read_b128 v[36:39], v212 offset:0
    ds_read_b128 v[40:43], v213 offset:32
    ds_read_b128 v[44:47], v212 offset:32
    ds_read_b128 v[48:51], v213 offset:64
    ds_read_b128 v[52:55], v212 offset:64
    ds_read_b128 v[56:59], v213 offset:96
    ds_read_b128 v[60:63], v212 offset:96
    s_waitcnt lgkmcnt(0)
    ds_read_b128 v[64:67], v213 offset:128
    ds_read_b128 v[68:71], v212 offset:128
    ds_read_b128 v[72:75], v213 offset:160
    ds_read_b128 v[76:79], v212 offset:160
    ds_read_b128 v[80:83], v213 offset:192
    ds_read_b128 v[84:87], v212 offset:192
    ds_read_b128 v[88:91], v213 offset:224
    ds_read_b128 v[92:95], v212 offset:224
    v_mfma_f32_32x32x16_bf16 v[16:31], v[32:35], v[36:39], 0
    v_mfma_f32_32x32x16_bf16 v[16:31], v[40:43], v[44:47], v[16:31]
    v_mfma_f32_32x32x16_bf16 v[16:31], v[48:51], v[52:55], v[16:31]
    v_mfma_f32_32x32x16_bf16 v[16:31], v[56:59], v[60:63], v[16:31]
    s_waitcnt lgkmcnt(0)
    ds_read_b128 v[32:35], v213 offset:256
    ds_read_b128 v[36:39], v212 offset:256
    ds_read_b128 v[40:43], v213 offset:288
    ds_read_b128 v[44:47], v212 offset:288
    ds_read_b128 v[48:51], v213 offset:320
    ds_read_b128 v[52:55], v212 offset:320
    ds_read_b128 v[56:59], v213 offset:352
    ds_read_b128 v[60:63], v212 offset:352
    v_mfma_f32_32x32x16_bf16 v[16:31], v[64:67], v[68:71], v[16:31]
    v_mfma_f32_32x32x16_bf16 v[16:31], v[72:75], v[76:79], v[16:31]
    v_mfma_f32_32x32x16_bf16 v[16:31], v[80:83], v[84:87], v[16:31]
    v_mfma_f32_32x32x16_bf16 v[16:31], v[88:91], v[92:95], v[16:31]
    s_waitcnt lgkmcnt(0)
    ds_read_b128 v[64:67], v213 offset:384
    ds_read_b128 v[68:71], v212 offset:384
    ds_read_b128 v[72:75], v213 offset:416
    ds_read_b128 v[76:79], v212 offset:416
    ds_read_b128 v[80:83], v213 offset:448
    ds_read_b128 v[84:87], v212 offset:448
    ds_read_b128 v[88:91], v213 offset:480
    ds_read_b128 v[92:95], v212 offset:480
    v_mfma_f32_32x32x16_bf16 v[16:31], v[32:35], v[36:39], v[16:31]
    v_mfma_f32_32x32x16_bf16 v[16:31], v[40:43], v[44:47], v[16:31]
    v_mfma_f32_32x32x16_bf16 v[16:31], v[48:51], v[52:55], v[16:31]
    v_mfma_f32_32x32x16_bf16 v[16:31], v[56:59], v[60:63], v[16:31]
    s_waitcnt lgkmcnt(0)
    v_mfma_f32_32x32x16_bf16 v[16:31], v[64:67], v[68:71], v[16:31]
    v_mfma_f32_32x32x16_bf16 v[16:31], v[72:75], v[76:79], v[16:31]
    v_mfma_f32_32x32x16_bf16 v[16:31], v[80:83], v[84:87], v[16:31]
    v_mfma_f32_32x32x16_bf16 v[16:31], v[88:91], v[92:95], v[16:31]
    v_mov_b32 v110, 163748
    s_mul_i32 s60, s56, 73728
    s_add_u32 s60, s60, 720896
    s_and_b32 s62, s57, 0xfffffffe
    s_lshl_b32 s63, s62, 7
    s_add_u32 s63, s63, s60
    s_add_u32 s63, s63, 65536
    s_lshl_b32 s62, s62, 10
    s_add_u32 s62, s62, s60
    v_lshlrev_b32 v108, 2, v0
    s_mov_b32 s61, 3200000
L_spin_gos:
    ds_read_b32 v111, v110
    s_sub_u32 s61, s61, 1
    s_cmp_eq_u32 s61, 0
    s_cbranch_scc1 L_spun_gos
    s_waitcnt lgkmcnt(0)
    v_cmp_gt_u32 vcc, 1, v111
    s_nop 0
    s_cbranch_vccnz L_spin_gos
L_spun_gos:
    s_waitcnt lgkmcnt(0)
    buffer_load_dword v12, v108, s[52:55], s63 offen sc1
    buffer_load_dwordx4 v[8:11], v1, s[52:55], s62 offen sc1
    buffer_load_dwordx4 v[124:127], v1, s[52:55], s62 offen offset:1024 sc1
    v_add_f32 v16, v16, v15
    v_cvt_pk_bf16_f32 v176, v28, v28
    v_cvt_pk_bf16_f32 v178, v29, v29
    v_cvt_pk_bf16_f32 v179, v31, v31
    v_cvt_pk_bf16_f32 v180, v16, v16
    v_readfirstlane_b32 s68, v176
    v_readfirstlane_b32 s69, v180
    s_and_b32 s70, s68, 0xffff0000
    s_and_b32 s69, s69, 0xffff
    v_mov_b32 v176, s68
    s_mov_b64 exec, 0x41
    v_mov_b32 v176, s70
    s_mov_b64 exec, 0x208
    v_mov_b32 v176, s69
    s_mov_b64 exec, -1
    v_cvt_pk_bf16_f32 v160, v23, v22
    v_cvt_pk_bf16_f32 v161, v21, v20
    v_cvt_pk_bf16_f32 v162, v19, v18
    v_cvt_pk_bf16_f32 v163, v17, v16
    v_cvt_pk_bf16_f32 v164, v24, v23
    v_cvt_pk_bf16_f32 v165, v22, v21
    v_cvt_pk_bf16_f32 v166, v20, v19
    v_cvt_pk_bf16_f32 v167, v18, v17
    v_cvt_pk_bf16_f32 v168, v27, v27
    v_cvt_pk_bf16_f32 v169, v26, v26
    v_cvt_pk_bf16_f32 v170, v26, v25
    v_cvt_pk_bf16_f32 v171, v25, v25
    v_cvt_pk_bf16_f32 v172, v27, v27
    v_cvt_pk_bf16_f32 v173, v27, v26
    v_cvt_pk_bf16_f32 v174, v26, v26
    v_cvt_pk_bf16_f32 v175, v25, v25
    s_branch L_attn
L_load_n:
    s_mul_i32 s82, s56, 155648
    s_add_u32 s82, s82, 3080192
    s_lshl_b32 s83, s38, 10
    s_mul_i32 s92, s38, 384
    v_lshlrev_b32 v1, 4, v0
    v_add_u32 v6, s83, v1
    s_lshl_b32 s60, s38, 6
    v_add_u32 v234, s60, v0
    v_mul_u32_u24 v230, 3277, v234
    v_lshrrev_b32 v230, 16, v230
    v_mul_u32_u24 v231, 20, v230
    v_sub_u32 v231, v234, v231
    v_lshrrev_b32 v232, 2, v230
    v_lshlrev_b32 v232, 10, v232
    v_and_b32 v233, 3, v230
    v_lshl_add_u32 v232, v233, 7, v232
    v_lshl_add_u32 v232, v231, 4, v232
    v_add_u32 v233, 8512, v232
    v_add_u32 v232, 8192, v232
    v_cmp_lt_u32 vcc, 11, v231
    v_lshlrev_b32 v230, 6, v230
    v_lshl_add_u32 v230, v231, 4, v230
    v_cndmask_b32 v232, v232, v233, vcc
    v_subrev_u32 v231, 8, v231
    v_cmp_gt_u32 vcc, 4, v231
    v_add_u32 v230, 16256, v230
    s_nop 0
    v_cndmask_b32 v7, v232, v230, vcc
    s_mul_i32 s60, s38, 24
    s_add_u32 s60, s60, 512
    v_add_u32 v234, s60, v0
    v_mul_u32_u24 v230, 3277, v234
    v_lshrrev_b32 v230, 16, v230
    v_mul_u32_u24 v231, 20, v230
    v_sub_u32 v231, v234, v231
    v_lshrrev_b32 v232, 2, v230
    v_lshlrev_b32 v232, 10, v232
    v_and_b32 v233, 3, v230
    v_lshl_add_u32 v232, v233, 7, v232
    v_lshl_add_u32 v232, v231, 4, v232
    v_add_u32 v233, 8512, v232
    v_add_u32 v232, 8192, v232
    v_cmp_lt_u32 vcc, 11, v231
    v_lshlrev_b32 v230, 6, v230
    v_lshl_add_u32 v230, v231, 4, v230
    v_cndmask_b32 v232, v232, v233, vcc
    v_subrev_u32 v231, 8, v231
    v_cmp_gt_u32 vcc, 4, v231
    v_add_u32 v230, 16256, v230
    s_nop 0
    v_cndmask_b32 v14, v232, v230, vcc
    v_cmp_lt_u32 vcc, 639, v234
    v_lshlrev_b32 v230, 4, v234
    v_add_u32 v230, 8192, v230
    v_cndmask_b32 v14, v14, v230, vcc
    v_and_b32 v2, 31, v0
    v_lshlrev_b32 v2, 2, v2
    v_lshrrev_b32 v230, 5, v0
    v_mul_u32_u24 v234, 320, v230
    v_bfe_u32 v230, v0, 2, 2
    v_and_b32 v231, 1, v0
    v_lshlrev_b32 v232, 4, v230
    v_lshl_add_u32 v232, v231, 3, v232
    v_and_b32 v231, 2, v0
    v_mul_u32_u24 v231, 96, v231
    v_add_u32 v232, v232, v231
    v_lshlrev_b32 v233, 3, v230
    v_add_u32 v233, 128, v233
    v_and_b32 v231, 3, v0
    v_cmp_ne_u32 vcc, 0, v231
    v_mov_b32 v230, 262144
    v_and_b32 v231, 16, v0
    v_cndmask_b32 v233, v233, v230, vcc
    v_cmp_ne_u32 vcc, 0, v231
    v_mov_b32 v5, 0xdddddddd
    s_nop 0
    v_cndmask_b32 v232, v232, v233, vcc
    v_cndmask_b32 v233, 64, 32, vcc
    v_add_u32 v3, v234, v232
    v_add_u32 v4, v3, v233
    s_cmp_ge_u32 s40, 28
    s_cselect_b32 s59, 1, 0
    s_cbranch_scc1 L_t_dbl_s2
    s_lshr_b32 s42, s40, 2
    s_add_u32 s42, s42, 2
    s_and_b32 s43, s40, 3
    s_branch L_t_map_s2
L_t_dbl_s2:
    s_bfe_u32 s42, s40, 0x10001
    s_and_b32 s43, s40, 1
    s_lshl_b32 s43, s43, 1
    s_lshr_b32 s60, s38, 2
    s_add_u32 s43, s43, s60
L_t_map_s2:
    v_lshrrev_b32 v230, 3, v0
    v_and_b32 v231, 7, v0
    v_and_b32 v232, 16, v0
    v_lshrrev_b32 v232, 2, v232
    v_xor_b32 v231, v231, v232
    v_lshlrev_b32 v231, 4, v231
    s_lshl_b32 s60, s42, 7
    s_mul_i32 s61, s38, 82944
    s_add_u32 s60, s60, s61
    v_mul_u32_u24 v233, 1152, v230
    v_add3_u32 v240, v233, v231, s60
    v_lshrrev_b32 v233, 4, v0
    v_mul_u32_u24 v233, 18, v233
    v_and_b32 v230, 1, v230
    v_add_u32 v233, v233, v230
    v_and_b32 v232, 16, v0
    v_xor_b32 v232, 16, v232
    v_add_u32 v233, v233, v232
    v_mul_u32_u24 v233, 1152, v233
    v_add3_u32 v241, v233, v231, s60
    s_barrier
    s_lshl_b32 s63, s62, 7
    s_mul_i32 s64, s62, 221184
    s_add_u32 m0, s65, 65536
    s_nop 0
    buffer_load_dwordx4 v82, s[44:47], s63 offen lds
    s_add_u32 m0, s65, 66560
    s_add_u32 s62, s62, 1
    buffer_load_dwordx4 v83, s[44:47], s63 offen lds
    s_add_u32 s63, s63, 18432
    s_add_u32 m0, s65, 67584
    s_nop 0
    buffer_load_dwordx4 v82, s[44:47], s63 offen lds
    s_add_u32 m0, s65, 68608
    s_cmp_eq_u32 s62, 9
    s_cselect_b32 s62, 0, s62
    buffer_load_dwordx4 v83, s[44:47], s63 offen lds
    s_add_u32 m0, s65, 81920
    s_nop 0
    buffer_load_dwordx4 v84, s[48:51], s64 offen lds
    s_add_u32 m0, s65, 82944
    s_add_u32 s64, s64, 13824
    buffer_load_dwordx4 v84, s[48:51], s64 offen lds
    s_add_u32 m0, s65, 83968
    s_add_u32 s64, s64, 13824
    buffer_load_dwordx4 v84, s[48:51], s64 offen lds
    s_add_u32 m0, s65, 84992
    s_add_u32 s64, s64, 13824
    buffer_load_dwordx4 v84, s[48:51], s64 offen lds
    s_barrier
    s_lshl_b32 s63, s62, 7
    s_mul_i32 s64, s62, 221184
    s_add_u32 m0, s65, 98304
    s_nop 0
    buffer_load_dwordx4 v82, s[44:47], s63 offen lds
    s_add_u32 m0, s65, 99328
    s_add_u32 s62, s62, 1
    buffer_load_dwordx4 v83, s[44:47], s63 offen lds
    s_add_u32 s63, s63, 18432
    s_add_u32 m0, s65, 100352
    s_nop 0
    buffer_load_dwordx4 v82, s[44:47], s63 offen lds
    s_add_u32 m0, s65, 101376
    s_cmp_eq_u32 s62, 9
    s_cselect_b32 s62, 0, s62
    buffer_load_dwordx4 v83, s[44:47], s63 offen lds
    s_add_u32 m0, s65, 114688
    s_nop 0
    buffer_load_dwordx4 v84, s[48:51], s64 offen lds
    s_add_u32 m0, s65, 115712
    s_add_u32 s64, s64, 13824
    buffer_load_dwordx4 v84, s[48:51], s64 offen lds
    s_add_u32 m0, s65, 116736
    s_add_u32 s64, s64, 13824
    buffer_load_dwordx4 v84, s[48:51], s64 offen lds
    s_add_u32 m0, s65, 117760
    s_add_u32 s64, s64, 13824
    buffer_load_dwordx4 v84, s[48:51], s64 offen lds
    s_waitcnt vmcnt(8)
    s_barrier
    s_lshl_b32 s63, s62, 7
    s_mul_i32 s64, s62, 221184
    s_add_u32 m0, s65, 0
    s_nop 0
    buffer_load_dwordx4 v82, s[44:47], s63 offen lds
    s_add_u32 m0, s65, 1024
    s_add_u32 s62, s62, 1
    buffer_load_dwordx4 v83, s[44:47], s63 offen lds
    s_add_u32 s63, s63, 18432
    s_add_u32 m0, s65, 2048
    s_nop 0
    buffer_load_dwordx4 v82, s[44:47], s63 offen lds
    s_add_u32 m0, s65, 3072
    s_cmp_eq_u32 s62, 9
    s_cselect_b32 s62, 0, s62
    buffer_load_dwordx4 v83, s[44:47], s63 offen lds
    s_add_u32 m0, s65, 16384
    s_nop 0
    buffer_load_dwordx4 v84, s[48:51], s64 offen lds
    s_add_u32 m0, s65, 17408
    s_add_u32 s64, s64, 13824
    buffer_load_dwordx4 v84, s[48:51], s64 offen lds
    s_add_u32 m0, s65, 18432
    s_add_u32 s64, s64, 13824
    buffer_load_dwordx4 v84, s[48:51], s64 offen lds
    s_add_u32 m0, s65, 19456
    s_add_u32 s64, s64, 13824
    buffer_load_dwordx4 v84, s[48:51], s64 offen lds
    s_waitcnt vmcnt(8)
    s_barrier
    s_lshl_b32 s63, s62, 7
    s_mul_i32 s64, s62, 221184
    s_add_u32 m0, s65, 32768
    s_nop 0
    buffer_load_dwordx4 v82, s[44:47], s63 offen lds
    s_add_u32 m0, s65, 33792
    s_add_u32 s62, s62, 1
    buffer_load_dwordx4 v83, s[44:47], s63 offen lds
    s_add_u32 s63, s63, 18432
    s_add_u32 m0, s65, 34816
    s_nop 0
    buffer_load_dwordx4 v82, s[44:47], s63 offen lds
    s_add_u32 m0, s65, 35840
    s_cmp_eq_u32 s62, 9
    s_cselect_b32 s62, 0, s62
    buffer_load_dwordx4 v83, s[44:47], s63 offen lds
    s_add_u32 m0, s65, 49152
    s_nop 0
    buffer_load_dwordx4 v84, s[48:51], s64 offen lds
    s_add_u32 m0, s65, 50176
    s_add_u32 s64, s64, 13824
    buffer_load_dwordx4 v84, s[48:51], s64 offen lds
    s_add_u32 m0, s65, 51200
    s_add_u32 s64, s64, 13824
    buffer_load_dwordx4 v84, s[48:51], s64 offen lds
    s_add_u32 m0, s65, 52224
    s_add_u32 s64, s64, 13824
    buffer_load_dwordx4 v84, s[48:51], s64 offen lds
    s_waitcnt vmcnt(8)
    s_barrier
    s_lshl_b32 s63, s62, 7
    s_mul_i32 s64, s62, 221184
    s_add_u32 m0, s65, 65536
    s_nop 0
    buffer_load_dwordx4 v82, s[44:47], s63 offen lds
    s_add_u32 m0, s65, 66560
    s_add_u32 s62, s62, 1
    buffer_load_dwordx4 v83, s[44:47], s63 offen lds
    s_add_u32 s63, s63, 18432
    s_add_u32 m0, s65, 67584
    s_nop 0
    buffer_load_dwordx4 v82, s[44:47], s63 offen lds
    s_add_u32 m0, s65, 68608
    s_cmp_eq_u32 s62, 9
    s_cselect_b32 s62, 0, s62
    buffer_load_dwordx4 v83, s[44:47], s63 offen lds
    s_add_u32 m0, s65, 81920
    s_nop 0
    buffer_load_dwordx4 v84, s[48:51], s64 offen lds
    s_add_u32 m0, s65, 82944
    s_add_u32 s64, s64, 13824
    buffer_load_dwordx4 v84, s[48:51], s64 offen lds
    s_add_u32 m0, s65, 83968
    s_add_u32 s64, s64, 13824
    buffer_load_dwordx4 v84, s[48:51], s64 offen lds
    s_add_u32 m0, s65, 84992
    s_add_u32 s64, s64, 13824
    buffer_load_dwordx4 v84, s[48:51], s64 offen lds
    s_waitcnt vmcnt(8)
    s_barrier
    s_lshl_b32 s63, s62, 7
    s_mul_i32 s64, s62, 221184
    s_add_u32 m0, s65, 98304
    s_nop 0
    buffer_load_dwordx4 v82, s[44:47], s63 offen lds
    s_add_u32 m0, s65, 99328
    s_add_u32 s62, s62, 1
    buffer_load_dwordx4 v83, s[44:47], s63 offen lds
    s_add_u32 s63, s63, 18432
    s_add_u32 m0, s65, 100352
    s_nop 0
    buffer_load_dwordx4 v82, s[44:47], s63 offen lds
    s_add_u32 m0, s65, 101376
    s_cmp_eq_u32 s62, 9
    s_cselect_b32 s62, 0, s62
    buffer_load_dwordx4 v83, s[44:47], s63 offen lds
    s_add_u32 m0, s65, 114688
    s_nop 0
    buffer_load_dwordx4 v84, s[48:51], s64 offen lds
    s_add_u32 m0, s65, 115712
    s_add_u32 s64, s64, 13824
    buffer_load_dwordx4 v84, s[48:51], s64 offen lds
    s_add_u32 m0, s65, 116736
    s_add_u32 s64, s64, 13824
    buffer_load_dwordx4 v84, s[48:51], s64 offen lds
    s_add_u32 m0, s65, 117760
    s_add_u32 s64, s64, 13824
    buffer_load_dwordx4 v84, s[48:51], s64 offen lds
    s_waitcnt vmcnt(8)
    s_barrier
    s_lshl_b32 s63, s62, 7
    s_mul_i32 s64, s62, 221184
    s_add_u32 m0, s65, 0
    s_nop 0
    buffer_load_dwordx4 v82, s[44:47], s63 offen lds
    s_add_u32 m0, s65, 1024
    s_add_u32 s62, s62, 1
    buffer_load_dwordx4 v83, s[44:47], s63 offen lds
    s_add_u32 s63, s63, 18432
    s_add_u32 m0, s65, 2048
    s_nop 0
    buffer_load_dwordx4 v82, s[44:47], s63 offen lds
    s_add_u32 m0, s65, 3072
    s_cmp_eq_u32 s62, 9
    s_cselect_b32 s62, 0, s62
    buffer_load_dwordx4 v83, s[44:47], s63 offen lds
    s_add_u32 m0, s65, 16384
    s_nop 0
    buffer_load_dwordx4 v84, s[48:51], s64 offen lds
    s_add_u32 m0, s65, 17408
    s_add_u32 s64, s64, 13824
    buffer_load_dwordx4 v84, s[48:51], s64 offen lds
    s_add_u32 m0, s65, 18432
    s_add_u32 s64, s64, 13824
    buffer_load_dwordx4 v84, s[48:51], s64 offen lds
    s_add_u32 m0, s65, 19456
    s_add_u32 s64, s64, 13824
    buffer_load_dwordx4 v84, s[48:51], s64 offen lds
    s_waitcnt vmcnt(8)
    s_barrier
    s_waitcnt vmcnt(0)
    s_barrier
    s_lshr_b32 s66, s3, 1
    v_lshrrev_b32 v196, 5, v0
    v_bfe_u32 v197, v0, 2, 2
    v_lshl_add_u32 v198, v196, 3, v197
    v_lshlrev_b32 v198, 7, v198
    v_lshrrev_b32 v197, 1, v197
    v_xor_b32 v197, s66, v197
    v_lshl_add_u32 v198, v197, 6, v198
    v_and_b32 v197, 1, v0
    v_lshl_add_u32 v198, v197, 5, v198
    v_and_b32 v197, 16, v0
    v_add_u32 v198, v198, v197
    v_and_b32 v197, 2, v0
    v_lshl_add_u32 v198, v197, 2, v198
    s_lshl_b32 s68, s66, 15
    s_add_u32 s68, s68, 24576
    v_add_u32 v160, s68, v198
    v_xor_b32 v161, 64, v160
    s_lshl_b32 s68, s66, 12
    s_add_u32 s68, s68, 90112
    v_add_u32 v162, s68, v198
    v_xor_b32 v163, 64, v162
    s_lshl_b32 s67, s39, 3
    s_lshl_b32 s68, s43, 1
    s_add_u32 s67, s67, s68
    s_and_b32 s68, s3, 1
    s_add_u32 s67, s67, s68
    s_mul_i32 s10, s67, 36864
    s_add_u32 s10, s10, 8060928
    s_lshl_b32 s11, s66, 11
    s_add_u32 s11, s11, s10
    s_add_u32 s11, s11, 32768
    s_lshl_b32 s68, s66, 14
    s_add_u32 s10, s10, s68
    v_lshlrev_b32 v164, 4, v0
    s_lshr_b32 s69, s38, 2
    s_mul_i32 s69, s69, 3072
    s_mul_i32 s68, s3, 6144
    s_add_u32 s68, s68, s69
    v_add_u32 v165, s68, v164
    s_mov_b32 s68, 155648
    s_cmp_ge_u32 s38, 4
    s_cmov_b32 s68, 114688
    s_lshl_b32 s70, s38, 10
    s_add_u32 s68, s68, s70
    v_add_u32 v167, s68, v164
    v_xor_b32 v168, 2048, v167
    s_xor_b32 s68, s3, 2
    s_mul_i32 s68, s68, 6144
    s_add_u32 s68, s68, s69
    v_add_u32 v166, s68, v164
    v_and_b32 v197, 31, v0
    v_lshlrev_b32 v198, 1, v196
    v_bfe_u32 v199, v0, 1, 2
    v_xor_b32 v198, v198, v199
    v_lshlrev_b32 v198, 4, v198
    v_lshl_add_u32 v198, v197, 6, v198
    v_add_u32 v169, s68, v198
    v_xor_b32 v170, 16, v169
    v_lshlrev_b32 v197, 2, v197
    v_lshl_add_u32 v174, v196, 9, v197
    v_lshrrev_b32 v197, 2, v0
    v_and_b32 v198, 3, v0
    v_bfe_u32 v199, v0, 3, 2
    v_xor_b32 v199, v198, v199
    v_lshlrev_b32 v199, 4, v199
    v_lshl_add_u32 v199, v197, 6, v199
    v_add_u32 v171, s68, v199
    v_mul_u32_u24 v197, 2304, v197
    v_lshl_add_u32 v197, v198, 4, v197
    s_mul_i32 s68, s67, 73728
    s_lshl_b32 s69, s42, 7
    s_add_u32 s68, s68, s69
    s_lshl_b32 s69, s66, 6
    s_add_u32 s68, s68, s69
    s_add_u32 s68, s68, 1152
    v_add_u32 v172, s68, v197
    v_add_u32 v173, 36864, v172
    s_lshl_b32 s68, s38, 2
    s_add_u32 s68, s68, 163716
    v_mov_b32 v175, s68
    s_xor_b32 s68, s38, 2
    s_lshl_b32 s68, s68, 2
    s_add_u32 s68, s68, 163716
    v_mov_b32 v176, s68
    v_and_b32 v177, 15, v0
    v_lshlrev_b32 v177, 5, v177
    s_lshr_b32 s12, s67, 1
    s_lshl_b32 s12, s12, 10
    s_lshl_b32 s68, s66, 9
    s_add_u32 s12, s12, s68
    s_add_u32 s12, s12, 425984
    s_mul_i32 s68, s3, 512
    s_add_u32 s68, s68, 3072
    v_lshl_add_u32 v178, v0, 3, s68
    s_mul_i32 s68, s3, 589824
    s_lshl_b32 s69, s58, 1
    s_add_u32 s68, s68, s69
    v_mul_u32_u24 v179, 9216, v0
    v_add_u32 v179, s68, v179
    v_and_b32 v196, 15, v0
    v_lshrrev_b32 v197, 4, v0
    v_lshlrev_b32 v198, 4, v197
    v_lshl_add_u32 v199, v196, 5, v198
    s_mul_i32 s68, s3, 4608
    s_add_u32 s68, s68, 98304
    v_add_u32 v182, s68, v199
    v_lshlrev_b32 v199, 1, v196
    v_sub_u32 v198, v198, v199
    v_add_u32 v199, 1, v0
    v_and_b32 v199, 3, v199
    v_mul_u32_u24 v199, 2242, v199
    s_mul_i32 s68, s3, 9728
    s_add_u32 s68, s68, 116766
    v_add3_u32 v180, v198, v199, s68
    v_lshlrev_b32 v197, 3, v197
    v_lshl_add_u32 v197, v196, 5, v197
    s_mul_i32 s68, s3, 6144
    s_add_u32 s68, s68, 3072
    v_add_u32 v183, s68, v197
    v_mov_b32 v110, 163748
    s_mul_i32 s60, s56, 73728
    s_add_u32 s60, s60, 720896
    s_and_b32 s62, s57, 0xfffffffe
    s_lshl_b32 s63, s62, 7
    s_add_u32 s63, s63, s60
    s_add_u32 s63, s63, 65536
    s_lshl_b32 s62, s62, 10
    s_add_u32 s62, s62, s60
    v_lshlrev_b32 v108, 2, v0
    s_mov_b32 s61, 3200000
L_spin_gon:
    ds_read_b32 v111, v110
    s_sub_u32 s61, s61, 1
    s_cmp_eq_u32 s61, 0
    s_cbranch_scc1 L_spun_gon
    s_waitcnt lgkmcnt(0)
    v_cmp_gt_u32 vcc, 1, v111
    s_nop 0
    s_cbranch_vccnz L_spin_gon
L_spun_gon:
    s_waitcnt lgkmcnt(0)
    buffer_load_dword v12, v108, s[52:55], s63 offen sc1
    buffer_load_dwordx4 v[8:11], v1, s[52:55], s62 offen sc1
    buffer_load_dwordx4 v[124:127], v1, s[52:55], s62 offen offset:1024 sc1
L_attn:
    s_mov_b32 s48, s30
    s_and_b32 s49, s31, 0xffff
    s_mov_b32 s50, 663552
    s_mov_b32 s51, 0x20000
    v_mov_b32 v128, 0
    v_mov_b32 v129, 0
    v_mov_b32 v130, 0
    v_mov_b32 v131, 0
    v_mov_b32 v132, 0
    v_mov_b32 v133, 0
    v_mov_b32 v134, 0
    v_mov_b32 v135, 0
    v_mov_b32 v136, 0
    v_mov_b32 v137, 0
    v_mov_b32 v138, 0
    v_mov_b32 v139, 0
    v_mov_b32 v140, 0
    v_mov_b32 v141, 0
    v_mov_b32 v142, 0
    v_mov_b32 v143, 0
    v_mov_b32 v88, 0
    v_mov_b32 v89, 0
    v_mov_b32 v90, 0
    v_mov_b32 v91, 0
    v_mov_b32 v92, 0
    v_mov_b32 v93, 0
    v_mov_b32 v94, 0
    v_mov_b32 v95, 0
    v_mov_b32 v112, 0
    v_mov_b32 v113, 0
    v_mov_b32 v114, 0
    v_mov_b32 v115, 0
    v_mov_b32 v105, 0x3f80
    s_lshl_b32 s60, s3, 8
    s_add_u32 s60, s60, 155648
    v_lshl_add_u32 v101, v0, 2, s60
    s_lshr_b32 s70, s38, 2
    s_lshl_b32 s71, s70, 10
    s_lshl_b32 s72, s70, 7
    s_mul_i32 s73, s70, 1280
    s_mul_i32 s64, s57, 36864
    s_add_u32 s64, s64, 8060928
    s_lshl_b32 s65, s56, 10
    s_add_u32 s65, s65, s64
    s_lshl_b32 s60, s56, 7
    s_add_u32 s64, s64, s60
    s_add_u32 s64, s64, 32768
    s_waitcnt vmcnt(0) lgkmcnt(0)
    s_barrier
    v_add_u32 v1, s71, v1
    v_add_u32 v2, s72, v2
    ds_read_b32 v13, v101
    ds_read_b32 v104, v2 offset:18432
    ds_read_b128 v[96:99], v1 offset:0
    v_add_u32 v3, s73, v3
    v_add_u32 v4, s73, v4
    ds_read_b64_tr_b16 v[108:109], v3 offset:8192
    ds_read_b64_tr_b16 v[110:111], v4 offset:8192
    s_waitcnt lgkmcnt(3)
    v_mfma_f32_32x32x4_2b_bf16 v[32:63], v[104:105], v[12:13], 0
    ds_read_b32 v104, v2 offset:18688
    s_add_u32 m0, s83, 19456
    s_add_u32 s69, s82, 19456
    buffer_load_dwordx4 v6, s[52:55], s69 offen sc1 lds
    s_add_u32 m0, s83, 27648
    s_add_u32 s69, s82, 19456
    buffer_load_dwordx4 v7, s[52:55], s69 offen sc1 lds
    s_add_u32 m0, s92, 35840
    s_add_u32 s69, s82, 19456
    s_mov_b64 exec, 0xffffff
    buffer_load_dwordx4 v14, s[52:55], s69 offen sc1 lds
    s_mov_b64 exec, -1
    v_mov_b32 v16, 0
    v_mov_b32 v17, 0
    v_mov_b32 v18, 0
    v_mov_b32 v19, 0
    v_mov_b32 v20, 0
    v_mov_b32 v21, 0
    v_mov_b32 v22, 0
    v_mov_b32 v23, 0
    v_mov_b32 v24, 0
    v_mov_b32 v25, 0
    v_mov_b32 v26, 0
    v_mov_b32 v27, 0
    v_mov_b32 v28, 0
    v_mov_b32 v29, 0
    v_mov_b32 v30, 0
    v_mov_b32 v31, 0
    s_waitcnt lgkmcnt(3)
    v_mfma_f32_32x32x16_bf16 v[32:47], v[96:99], v[8:11], v[32:47]
    v_mfma_f32_32x32x16_bf16 v[48:63], v[96:99], v[124:127], v[48:63]
    ds_read_b128 v[96:99], v1 offset:2048
    s_waitcnt lgkmcnt(0)
    v_mov_b32 v152, 163712
    v_mov_b32 v153, 1
    s_nop 6
    v_exp_f32 v32, v32
    v_exp_f32 v33, v33
    v_smfmac_f32_32x32x32_bf16 v[128:143], v[112:115], v[88:95], v5
    s_setprio 3
    ds_read_b64_tr_b16 v[112:113], v3 offset:8832
    ds_read_b64_tr_b16 v[114:115], v4 offset:8832
    v_exp_f32 v34, v34
    v_exp_f32 v35, v35
    v_exp_f32 v36, v36
    v_exp_f32 v37, v37
    v_mfma_f32_32x32x4_2b_bf16 v[64:95], v[104:105], v[12:13], 0
    ds_read_b32 v104, v2 offset:18944
    v_exp_f32 v38, v38
    v_exp_f32 v39, v39
    v_exp_f32 v40, v40
    v_exp_f32 v41, v41
    v_exp_f32 v42, v42
    v_exp_f32 v43, v43
    v_exp_f32 v44, v44
    v_exp_f32 v45, v45
    s_waitcnt lgkmcnt(0)
    v_smfmac_f32_32x32x32_bf16 v[16:31], v[108:111], v[32:39], v5
    s_add_u32 m0, s83, 38912
    s_add_u32 s69, s82, 38912
    buffer_load_dwordx4 v6, s[52:55], s69 offen sc1 lds
    v_exp_f32 v46, v46
    v_exp_f32 v47, v47
    v_exp_f32 v48, v48
    v_exp_f32 v49, v49
    v_smfmac_f32_32x32x32_bf16 v[16:31], v[112:115], v[40:47], v5
    s_add_u32 m0, s83, 47104
    s_add_u32 s69, s82, 38912
    buffer_load_dwordx4 v7, s[52:55], s69 offen sc1 lds
    v_exp_f32 v50, v50
    v_exp_f32 v51, v51
    v_exp_f32 v52, v52
    v_exp_f32 v53, v53
    v_mfma_f32_32x32x16_bf16 v[64:79], v[96:99], v[8:11], v[64:79]
    v_exp_f32 v54, v54
    v_exp_f32 v55, v55
    v_exp_f32 v56, v56
    v_exp_f32 v57, v57
    v_mfma_f32_32x32x16_bf16 v[80:95], v[96:99], v[124:127], v[80:95]
    ds_read_b128 v[96:99], v1 offset:4096
    v_exp_f32 v58, v58
    v_exp_f32 v59, v59
    v_exp_f32 v60, v60
    v_exp_f32 v61, v61
    v_smfmac_f32_32x32x32_bf16 v[128:143], v[108:111], v[48:55], v5
    s_add_u32 m0, s92, 55296
    s_add_u32 s69, s82, 38912
    s_mov_b64 exec, 0xffffff
    buffer_load_dwordx4 v14, s[52:55], s69 offen sc1 lds
    s_mov_b64 exec, -1
    ds_read_b64_tr_b16 v[108:109], v3 offset:10752
    ds_read_b64_tr_b16 v[110:111], v4 offset:10752
    v_exp_f32 v62, v62
    v_exp_f32 v63, v63
    v_exp_f32 v64, v64
    v_exp_f32 v65, v65
    v_smfmac_f32_32x32x32_bf16 v[128:143], v[112:115], v[56:63], v5
    s_waitcnt vmcnt(3)
    s_mov_b64 exec, 1
    ds_add_u32 v152, v153 offset:64
    s_mov_b64 exec, -1
    s_setprio 2
    ds_read_b64_tr_b16 v[112:113], v3 offset:11392
    ds_read_b64_tr_b16 v[114:115], v4 offset:11392
    v_exp_f32 v66, v66
    v_exp_f32 v67, v67
    v_exp_f32 v68, v68
    v_exp_f32 v69, v69
    v_mfma_f32_32x32x4_2b_bf16 v[32:63], v[104:105], v[12:13], 0
    ds_read_b32 v104, v2 offset:19200
    v_exp_f32 v70, v70
    v_exp_f32 v71, v71
    v_exp_f32 v72, v72
    v_exp_f32 v73, v73
    v_exp_f32 v74, v74
    v_exp_f32 v75, v75
    v_exp_f32 v76, v76
    v_exp_f32 v77, v77
    s_waitcnt lgkmcnt(0)
    v_smfmac_f32_32x32x32_bf16 v[16:31], v[108:111], v[64:71], v5
    s_add_u32 m0, s83, 58368
    s_add_u32 s69, s82, 58368
    buffer_load_dwordx4 v6, s[52:55], s69 offen sc1 lds
    v_exp_f32 v78, v78
    v_exp_f32 v79, v79
    v_exp_f32 v80, v80
    v_exp_f32 v81, v81
    v_smfmac_f32_32x32x32_bf16 v[16:31], v[112:115], v[72:79], v5
    s_add_u32 m0, s83, 66560
    s_add_u32 s69, s82, 58368
    buffer_load_dwordx4 v7, s[52:55], s69 offen sc1 lds
    v_exp_f32 v82, v82
    v_exp_f32 v83, v83
    v_exp_f32 v84, v84
    v_exp_f32 v85, v85
    v_mfma_f32_32x32x16_bf16 v[32:47], v[96:99], v[8:11], v[32:47]
    ds_read_b32 v154, v152 offset:64
    v_exp_f32 v86, v86
    v_exp_f32 v87, v87
    v_exp_f32 v88, v88
    v_exp_f32 v89, v89
    v_mfma_f32_32x32x16_bf16 v[48:63], v[96:99], v[124:127], v[48:63]
    ds_read_b128 v[96:99], v1 offset:6144
    v_exp_f32 v90, v90
    v_exp_f32 v91, v91
    v_exp_f32 v92, v92
    v_exp_f32 v93, v93
    v_smfmac_f32_32x32x32_bf16 v[128:143], v[108:111], v[80:87], v5
    s_add_u32 m0, s92, 74752
    s_add_u32 s69, s82, 58368
    s_mov_b64 exec, 0xffffff
    buffer_load_dwordx4 v14, s[52:55], s69 offen sc1 lds
    s_mov_b64 exec, -1
    ds_read_b64_tr_b16 v[108:109], v3 offset:13312
    ds_read_b64_tr_b16 v[110:111], v4 offset:13312
    v_exp_f32 v94, v94
    v_exp_f32 v95, v95
    v_exp_f32 v32, v32
    v_exp_f32 v33, v33
    v_smfmac_f32_32x32x32_bf16 v[128:143], v[112:115], v[88:95], v5
    s_waitcnt lgkmcnt(3)
    v_cmp_gt_u32 vcc, 8, v154
    s_nop 0
    s_cbranch_vccnz L_ck16
L_ckb16:
    s_setprio 1
    ds_read_b64_tr_b16 v[112:113], v3 offset:13952
    ds_read_b64_tr_b16 v[114:115], v4 offset:13952
    v_exp_f32 v34, v34
    v_exp_f32 v35, v35
    v_exp_f32 v36, v36
    v_exp_f32 v37, v37
    v_mfma_f32_32x32x4_2b_bf16 v[64:95], v[104:105], v[12:13], 0
    ds_read_b32 v104, v2 offset:37888
    v_exp_f32 v38, v38
    v_exp_f32 v39, v39
    v_exp_f32 v40, v40
    v_exp_f32 v41, v41
    v_exp_f32 v42, v42
    v_exp_f32 v43, v43
    v_exp_f32 v44, v44
    v_exp_f32 v45, v45
    s_waitcnt lgkmcnt(0)
    v_smfmac_f32_32x32x32_bf16 v[16:31], v[108:111], v[32:39], v5
    s_add_u32 m0, s83, 77824
    s_add_u32 s69, s82, 77824
    buffer_load_dwordx4 v6, s[52:55], s69 offen sc1 lds
    v_exp_f32 v46, v46
    v_exp_f32 v47, v47
    v_exp_f32 v48, v48
    v_exp_f32 v49, v49
    v_smfmac_f32_32x32x32_bf16 v[16:31], v[112:115], v[40:47], v5
    s_add_u32 m0, s83, 86016
    s_add_u32 s69, s82, 77824
    buffer_load_dwordx4 v7, s[52:55], s69 offen sc1 lds
    v_exp_f32 v50, v50
    v_exp_f32 v51, v51
    v_exp_f32 v52, v52
    v_exp_f32 v53, v53
    v_mfma_f32_32x32x16_bf16 v[64:79], v[96:99], v[8:11], v[64:79]
    v_exp_f32 v54, v54
    v_exp_f32 v55, v55
    v_exp_f32 v56, v56
    v_exp_f32 v57, v57
    v_mfma_f32_32x32x16_bf16 v[80:95], v[96:99], v[124:127], v[80:95]
    ds_read_b128 v[96:99], v1 offset:19456
    v_exp_f32 v58, v58
    v_exp_f32 v59, v59
    v_exp_f32 v60, v60
    v_exp_f32 v61, v61
    v_smfmac_f32_32x32x32_bf16 v[128:143], v[108:111], v[48:55], v5
    s_add_u32 m0, s92, 94208
    s_add_u32 s69, s82, 77824
    s_mov_b64 exec, 0xffffff
    buffer_load_dwordx4 v14, s[52:55], s69 offen sc1 lds
    s_mov_b64 exec, -1
    ds_read_b64_tr_b16 v[108:109], v3 offset:15872
    ds_read_b64_tr_b16 v[110:111], v4 offset:15872
    v_exp_f32 v62, v62
    v_exp_f32 v63, v63
    v_exp_f32 v64, v64
    v_exp_f32 v65, v65
    v_smfmac_f32_32x32x32_bf16 v[128:143], v[112:115], v[56:63], v5
    s_setprio 0
    ds_read_b64_tr_b16 v[112:113], v3 offset:16512
    ds_read_b64_tr_b16 v[114:115], v4 offset:16512
    v_exp_f32 v66, v66
    v_exp_f32 v67, v67
    v_exp_f32 v68, v68
    v_exp_f32 v69, v69
    v_mfma_f32_32x32x4_2b_bf16 v[32:63], v[104:105], v[12:13], 0
    ds_read_b32 v104, v2 offset:38144
    v_exp_f32 v70, v70
    v_exp_f32 v71, v71
    v_exp_f32 v72, v72
    v_exp_f32 v73, v73
    v_exp_f32 v74, v74
    v_exp_f32 v75, v75
    v_exp_f32 v76, v76
    v_exp_f32 v77, v77
    s_waitcnt lgkmcnt(0)
    v_smfmac_f32_32x32x32_bf16 v[16:31], v[108:111], v[64:71], v5
    v_exp_f32 v78, v78
    v_exp_f32 v79, v79
    v_exp_f32 v80, v80
    v_exp_f32 v81, v81
    v_smfmac_f32_32x32x32_bf16 v[16:31], v[112:115], v[72:79], v5
    v_exp_f32 v82, v82
    v_exp_f32 v83, v83
    v_exp_f32 v84, v84
    v_exp_f32 v85, v85
    v_mfma_f32_32x32x16_bf16 v[32:47], v[96:99], v[8:11], v[32:47]
    v_exp_f32 v86, v86
    v_exp_f32 v87, v87
    v_exp_f32 v88, v88
    v_exp_f32 v89, v89
    v_mfma_f32_32x32x16_bf16 v[48:63], v[96:99], v[124:127], v[48:63]
    ds_read_b128 v[96:99], v1 offset:21504
    v_exp_f32 v90, v90
    v_exp_f32 v91, v91
    v_exp_f32 v92, v92
    v_exp_f32 v93, v93
    v_smfmac_f32_32x32x32_bf16 v[128:143], v[108:111], v[80:87], v5
    ds_read_b64_tr_b16 v[108:109], v3 offset:27648
    ds_read_b64_tr_b16 v[110:111], v4 offset:27648
    v_exp_f32 v94, v94
    v_exp_f32 v95, v95
    v_exp_f32 v32, v32
    v_exp_f32 v33, v33
    v_smfmac_f32_32x32x32_bf16 v[128:143], v[112:115], v[88:95], v5
    s_waitcnt vmcnt(0)
    s_mov_b64 exec, 1
    ds_add_u32 v152, v153 offset:68
    s_mov_b64 exec, -1
    s_setprio 3
    ds_read_b64_tr_b16 v[112:113], v3 offset:28288
    ds_read_b64_tr_b16 v[114:115], v4 offset:28288
    v_exp_f32 v34, v34
    v_exp_f32 v35, v35
    v_exp_f32 v36, v36
    v_exp_f32 v37, v37
    v_mfma_f32_32x32x4_2b_bf16 v[64:95], v[104:105], v[12:13], 0
    ds_read_b32 v104, v2 offset:38400
    v_exp_f32 v38, v38
    v_exp_f32 v39, v39
    v_exp_f32 v40, v40
    v_exp_f32 v41, v41
    v_exp_f32 v42, v42
    v_exp_f32 v43, v43
    v_exp_f32 v44, v44
    v_exp_f32 v45, v45
    s_waitcnt lgkmcnt(0)
    v_smfmac_f32_32x32x32_bf16 v[16:31], v[108:111], v[32:39], v5
    s_add_u32 m0, s83, 97280
    s_add_u32 s69, s82, 97280
    buffer_load_dwordx4 v6, s[52:55], s69 offen sc1 lds
    v_exp_f32 v46, v46
    v_exp_f32 v47, v47
    v_exp_f32 v48, v48
    v_exp_f32 v49, v49
    v_smfmac_f32_32x32x32_bf16 v[16:31], v[112:115], v[40:47], v5
    s_add_u32 m0, s83, 105472
    s_add_u32 s69, s82, 97280
    buffer_load_dwordx4 v7, s[52:55], s69 offen sc1 lds
    v_exp_f32 v50, v50
    v_exp_f32 v51, v51
    v_exp_f32 v52, v52
    v_exp_f32 v53, v53
    v_mfma_f32_32x32x16_bf16 v[64:79], v[96:99], v[8:11], v[64:79]
    v_exp_f32 v54, v54
    v_exp_f32 v55, v55
    v_exp_f32 v56, v56
    v_exp_f32 v57, v57
    v_mfma_f32_32x32x16_bf16 v[80:95], v[96:99], v[124:127], v[80:95]
    ds_read_b128 v[96:99], v1 offset:23552
    v_exp_f32 v58, v58
    v_exp_f32 v59, v59
    v_exp_f32 v60, v60
    v_exp_f32 v61, v61
    v_smfmac_f32_32x32x32_bf16 v[128:143], v[108:111], v[48:55], v5
    s_add_u32 m0, s92, 113664
    s_add_u32 s69, s82, 97280
    s_mov_b64 exec, 0xffffff
    buffer_load_dwordx4 v14, s[52:55], s69 offen sc1 lds
    s_mov_b64 exec, -1
    ds_read_b64_tr_b16 v[108:109], v3 offset:30208
    ds_read_b64_tr_b16 v[110:111], v4 offset:30208
    v_exp_f32 v62, v62
    v_exp_f32 v63, v63
    v_exp_f32 v64, v64
    v_exp_f32 v65, v65
    v_smfmac_f32_32x32x32_bf16 v[128:143], v[112:115], v[56:63], v5
    s_setprio 2
    ds_read_b64_tr_b16 v[112:113], v3 offset:30848
    ds_read_b64_tr_b16 v[114:115], v4 offset:30848
    v_exp_f32 v66, v66
    v_exp_f32 v67, v67
    v_exp_f32 v68, v68
    v_exp_f32 v69, v69
    v_mfma_f32_32x32x4_2b_bf16 v[32:63], v[104:105], v[12:13], 0
    ds_read_b32 v104, v2 offset:38656
    v_exp_f32 v70, v70
    v_exp_f32 v71, v71
    v_exp_f32 v72, v72
    v_exp_f32 v73, v73
    v_exp_f32 v74, v74
    v_exp_f32 v75, v75
    v_exp_f32 v76, v76
    v_exp_f32 v77, v77
    s_waitcnt lgkmcnt(0)
    v_smfmac_f32_32x32x32_bf16 v[16:31], v[108:111], v[64:71], v5
    s_add_u32 m0, s83, 116736
    s_add_u32 s69, s82, 116736
    buffer_load_dwordx4 v6, s[52:55], s69 offen sc1 lds
    v_exp_f32 v78, v78
    v_exp_f32 v79, v79
    v_exp_f32 v80, v80
    v_exp_f32 v81, v81
    v_smfmac_f32_32x32x32_bf16 v[16:31], v[112:115], v[72:79], v5
    s_add_u32 m0, s83, 124928
    s_add_u32 s69, s82, 116736
    buffer_load_dwordx4 v7, s[52:55], s69 offen sc1 lds
    v_exp_f32 v82, v82
    v_exp_f32 v83, v83
    v_exp_f32 v84, v84
    v_exp_f32 v85, v85
    v_mfma_f32_32x32x16_bf16 v[32:47], v[96:99], v[8:11], v[32:47]
    ds_read_b32 v154, v152 offset:68
    v_exp_f32 v86, v86
    v_exp_f32 v87, v87
    v_exp_f32 v88, v88
    v_exp_f32 v89, v89
    v_mfma_f32_32x32x16_bf16 v[48:63], v[96:99], v[124:127], v[48:63]
    ds_read_b128 v[96:99], v1 offset:25600
    v_exp_f32 v90, v90
    v_exp_f32 v91, v91
    v_exp_f32 v92, v92
    v_exp_f32 v93, v93
    v_smfmac_f32_32x32x32_bf16 v[128:143], v[108:111], v[80:87], v5
    s_add_u32 m0, s92, 133120
    s_add_u32 s69, s82, 116736
    s_mov_b64 exec, 0xffffff
    buffer_load_dwordx4 v14, s[52:55], s69 offen sc1 lds
    s_mov_b64 exec, -1
    ds_read_b64_tr_b16 v[108:109], v3 offset:32768
    ds_read_b64_tr_b16 v[110:111], v4 offset:32768
    v_exp_f32 v94, v94
    v_exp_f32 v95, v95
    v_exp_f32 v32, v32
    v_exp_f32 v33, v33
    v_smfmac_f32_32x32x32_bf16 v[128:143], v[112:115], v[88:95], v5
    s_waitcnt lgkmcnt(3)
    v_cmp_gt_u32 vcc, 8, v154
    s_nop 0
    s_cbranch_vccnz L_ck17
L_ckb17:
    s_setprio 1
    ds_read_b64_tr_b16 v[112:113], v3 offset:33408
    ds_read_b64_tr_b16 v[114:115], v4 offset:33408
    v_exp_f32 v34, v34
    v_exp_f32 v35, v35
    v_exp_f32 v36, v36
    v_exp_f32 v37, v37
    v_mfma_f32_32x32x4_2b_bf16 v[64:95], v[104:105], v[12:13], 0
    ds_read_b32 v104, v2 offset:57344
    v_exp_f32 v38, v38
    v_exp_f32 v39, v39
    v_exp_f32 v40, v40
    v_exp_f32 v41, v41
    v_exp_f32 v42, v42
    v_exp_f32 v43, v43
    v_exp_f32 v44, v44
    v_exp_f32 v45, v45
    s_waitcnt lgkmcnt(0)
    v_smfmac_f32_32x32x32_bf16 v[16:31], v[108:111], v[32:39], v5
    s_add_u32 m0, s83, 136192
    s_add_u32 s69, s82, 136192
    buffer_load_dwordx4 v6, s[52:55], s69 offen sc1 lds
    v_exp_f32 v46, v46
    v_exp_f32 v47, v47
    v_exp_f32 v48, v48
    v_exp_f32 v49, v49
    v_smfmac_f32_32x32x32_bf16 v[16:31], v[112:115], v[40:47], v5
    s_add_u32 m0, s83, 144384
    s_add_u32 s69, s82, 136192
    buffer_load_dwordx4 v7, s[52:55], s69 offen sc1 lds
    v_exp_f32 v50, v50
    v_exp_f32 v51, v51
    v_exp_f32 v52, v52
    v_exp_f32 v53, v53
    v_mfma_f32_32x32x16_bf16 v[64:79], v[96:99], v[8:11], v[64:79]
    v_exp_f32 v54, v54
    v_exp_f32 v55, v55
    v_exp_f32 v56, v56
    v_exp_f32 v57, v57
    v_mfma_f32_32x32x16_bf16 v[80:95], v[96:99], v[124:127], v[80:95]
    ds_read_b128 v[96:99], v1 offset:38912
    v_exp_f32 v58, v58
    v_exp_f32 v59, v59
    v_exp_f32 v60, v60
    v_exp_f32 v61, v61
    v_smfmac_f32_32x32x32_bf16 v[128:143], v[108:111], v[48:55], v5
    s_add_u32 m0, s92, 152576
    s_add_u32 s69, s82, 136192
    s_mov_b64 exec, 0xffffff
    buffer_load_dwordx4 v14, s[52:55], s69 offen sc1 lds
    s_mov_b64 exec, -1
    ds_read_b64_tr_b16 v[108:109], v3 offset:35328
    ds_read_b64_tr_b16 v[110:111], v4 offset:35328
    v_exp_f32 v62, v62
    v_exp_f32 v63, v63
    v_exp_f32 v64, v64
    v_exp_f32 v65, v65
    v_smfmac_f32_32x32x32_bf16 v[128:143], v[112:115], v[56:63], v5
    s_setprio 0
    ds_read_b64_tr_b16 v[112:113], v3 offset:35968
    ds_read_b64_tr_b16 v[114:115], v4 offset:35968
    v_exp_f32 v66, v66
    v_exp_f32 v67, v67
    v_exp_f32 v68, v68
    v_exp_f32 v69, v69
    v_mfma_f32_32x32x4_2b_bf16 v[32:63], v[104:105], v[12:13], 0
    ds_read_b32 v104, v2 offset:57600
    v_exp_f32 v70, v70
    v_exp_f32 v71, v71
    v_exp_f32 v72, v72
    v_exp_f32 v73, v73
    v_exp_f32 v74, v74
    v_exp_f32 v75, v75
    v_exp_f32 v76, v76
    v_exp_f32 v77, v77
    s_waitcnt lgkmcnt(0)
    v_smfmac_f32_32x32x32_bf16 v[16:31], v[108:111], v[64:71], v5
    v_exp_f32 v78, v78
    v_exp_f32 v79, v79
    v_exp_f32 v80, v80
    v_exp_f32 v81, v81
    v_smfmac_f32_32x32x32_bf16 v[16:31], v[112:115], v[72:79], v5
    v_exp_f32 v82, v82
    v_exp_f32 v83, v83
    v_exp_f32 v84, v84
    v_exp_f32 v85, v85
    v_mfma_f32_32x32x16_bf16 v[32:47], v[96:99], v[8:11], v[32:47]
    v_exp_f32 v86, v86
    v_exp_f32 v87, v87
    v_exp_f32 v88, v88
    v_exp_f32 v89, v89
    v_mfma_f32_32x32x16_bf16 v[48:63], v[96:99], v[124:127], v[48:63]
    ds_read_b128 v[96:99], v1 offset:40960
    v_exp_f32 v90, v90
    v_exp_f32 v91, v91
    v_exp_f32 v92, v92
    v_exp_f32 v93, v93
    v_smfmac_f32_32x32x32_bf16 v[128:143], v[108:111], v[80:87], v5
    ds_read_b64_tr_b16 v[108:109], v3 offset:47104
    ds_read_b64_tr_b16 v[110:111], v4 offset:47104
    v_exp_f32 v94, v94
    v_exp_f32 v95, v95
    v_exp_f32 v32, v32
    v_exp_f32 v33, v33
    v_smfmac_f32_32x32x32_bf16 v[128:143], v[112:115], v[88:95], v5
    s_setprio 3
    ds_read_b64_tr_b16 v[112:113], v3 offset:47744
    ds_read_b64_tr_b16 v[114:115], v4 offset:47744
    v_exp_f32 v34, v34
    v_exp_f32 v35, v35
    v_exp_f32 v36, v36
    v_exp_f32 v37, v37
    v_mfma_f32_32x32x4_2b_bf16 v[64:95], v[104:105], v[12:13], 0
    ds_read_b32 v104, v2 offset:57856
    v_exp_f32 v38, v38
    v_exp_f32 v39, v39
    v_exp_f32 v40, v40
    v_exp_f32 v41, v41
    v_exp_f32 v42, v42
    v_exp_f32 v43, v43
    v_exp_f32 v44, v44
    v_exp_f32 v45, v45
    s_waitcnt lgkmcnt(0)
    v_smfmac_f32_32x32x32_bf16 v[16:31], v[108:111], v[32:39], v5
    v_exp_f32 v46, v46
    v_exp_f32 v47, v47
    v_exp_f32 v48, v48
    v_exp_f32 v49, v49
    v_smfmac_f32_32x32x32_bf16 v[16:31], v[112:115], v[40:47], v5
    v_exp_f32 v50, v50
    v_exp_f32 v51, v51
    v_exp_f32 v52, v52
    v_exp_f32 v53, v53
    v_mfma_f32_32x32x16_bf16 v[64:79], v[96:99], v[8:11], v[64:79]
    v_exp_f32 v54, v54
    v_exp_f32 v55, v55
    v_exp_f32 v56, v56
    v_exp_f32 v57, v57
    v_mfma_f32_32x32x16_bf16 v[80:95], v[96:99], v[124:127], v[80:95]
    ds_read_b128 v[96:99], v1 offset:43008
    v_exp_f32 v58, v58
    v_exp_f32 v59, v59
    v_exp_f32 v60, v60
    v_exp_f32 v61, v61
    v_smfmac_f32_32x32x32_bf16 v[128:143], v[108:111], v[48:55], v5
    ds_read_b64_tr_b16 v[108:109], v3 offset:49664
    ds_read_b64_tr_b16 v[110:111], v4 offset:49664
    v_exp_f32 v62, v62
    v_exp_f32 v63, v63
    v_exp_f32 v64, v64
    v_exp_f32 v65, v65
    v_smfmac_f32_32x32x32_bf16 v[128:143], v[112:115], v[56:63], v5
    s_waitcnt vmcnt(0)
    s_mov_b64 exec, 1
    ds_add_u32 v152, v153 offset:72
    s_mov_b64 exec, -1
    s_setprio 2
    ds_read_b64_tr_b16 v[112:113], v3 offset:50304
    ds_read_b64_tr_b16 v[114:115], v4 offset:50304
    v_exp_f32 v66, v66
    v_exp_f32 v67, v67
    v_exp_f32 v68, v68
    v_exp_f32 v69, v69
    v_mfma_f32_32x32x4_2b_bf16 v[32:63], v[104:105], v[12:13], 0
    ds_read_b32 v104, v2 offset:58112
    v_exp_f32 v70, v70
    v_exp_f32 v71, v71
    v_exp_f32 v72, v72
    v_exp_f32 v73, v73
    v_exp_f32 v74, v74
    v_exp_f32 v75, v75
    v_exp_f32 v76, v76
    v_exp_f32 v77, v77
    s_waitcnt lgkmcnt(0)
    v_smfmac_f32_32x32x32_bf16 v[16:31], v[108:111], v[64:71], v5
    v_exp_f32 v78, v78
    v_exp_f32 v79, v79
    v_exp_f32 v80, v80
    v_exp_f32 v81, v81
    v_smfmac_f32_32x32x32_bf16 v[16:31], v[112:115], v[72:79], v5
    v_exp_f32 v82, v82
    v_exp_f32 v83, v83
    v_exp_f32 v84, v84
    v_exp_f32 v85, v85
    v_mfma_f32_32x32x16_bf16 v[32:47], v[96:99], v[8:11], v[32:47]
    v_exp_f32 v86, v86
    v_exp_f32 v87, v87
    v_exp_f32 v88, v88
    v_exp_f32 v89, v89
    v_mfma_f32_32x32x16_bf16 v[48:63], v[96:99], v[124:127], v[48:63]
    ds_read_b128 v[96:99], v1 offset:45056
    v_exp_f32 v90, v90
    v_exp_f32 v91, v91
    v_exp_f32 v92, v92
    v_exp_f32 v93, v93
    v_smfmac_f32_32x32x32_bf16 v[128:143], v[108:111], v[80:87], v5
    ds_read_b64_tr_b16 v[108:109], v3 offset:52224
    ds_read_b64_tr_b16 v[110:111], v4 offset:52224
    v_exp_f32 v94, v94
    v_exp_f32 v95, v95
    v_exp_f32 v32, v32
    v_exp_f32 v33, v33
    v_smfmac_f32_32x32x32_bf16 v[128:143], v[112:115], v[88:95], v5
    s_setprio 1
    ds_read_b64_tr_b16 v[112:113], v3 offset:52864
    ds_read_b64_tr_b16 v[114:115], v4 offset:52864
    v_exp_f32 v34, v34
    v_exp_f32 v35, v35
    v_exp_f32 v36, v36
    v_exp_f32 v37, v37
    v_mfma_f32_32x32x4_2b_bf16 v[64:95], v[104:105], v[12:13], 0
    v_add_u32 v2, 58368, v2
    ds_read_b32 v104, v2 offset:18432
    v_exp_f32 v38, v38
    v_exp_f32 v39, v39
    v_exp_f32 v40, v40
    v_exp_f32 v41, v41
    v_exp_f32 v42, v42
    v_exp_f32 v43, v43
    v_exp_f32 v44, v44
    v_exp_f32 v45, v45
    s_waitcnt lgkmcnt(0)
    v_smfmac_f32_32x32x32_bf16 v[16:31], v[108:111], v[32:39], v5
    s_cmp_eq_u32 s41, 0
    s_cbranch_scc1 L_nog0
    s_lshl_b32 s60, s38, 8
    s_mul_i32 s60, s60, 1152
    s_lshl_b32 s61, s58, 1
    s_add_u32 s60, s60, s61
    v_mul_u32_u24 v242, 4608, v0
    v_add_u32 v242, s60, v242
    global_load_dwordx2 v[248:249], v242, s[8:9] offset:3456
L_nog0:
    v_exp_f32 v46, v46
    v_exp_f32 v47, v47
    v_exp_f32 v48, v48
    v_exp_f32 v49, v49
    v_smfmac_f32_32x32x32_bf16 v[16:31], v[112:115], v[40:47], v5
    v_exp_f32 v50, v50
    v_exp_f32 v51, v51
    v_exp_f32 v52, v52
    v_exp_f32 v53, v53
    v_mfma_f32_32x32x16_bf16 v[64:79], v[96:99], v[8:11], v[64:79]
    v_exp_f32 v54, v54
    v_exp_f32 v55, v55
    v_exp_f32 v56, v56
    v_exp_f32 v57, v57
    v_mfma_f32_32x32x16_bf16 v[80:95], v[96:99], v[124:127], v[80:95]
    ds_read_b128 v[96:99], v1 offset:58368
    v_exp_f32 v58, v58
    v_exp_f32 v59, v59
    v_exp_f32 v60, v60
    v_exp_f32 v61, v61
    v_smfmac_f32_32x32x32_bf16 v[128:143], v[108:111], v[48:55], v5
    ds_read_b64_tr_b16 v[108:109], v3 offset:54784
    ds_read_b64_tr_b16 v[110:111], v4 offset:54784
    v_exp_f32 v62, v62
    v_exp_f32 v63, v63
    v_exp_f32 v64, v64
    v_exp_f32 v65, v65
    v_smfmac_f32_32x32x32_bf16 v[128:143], v[112:115], v[56:63], v5
    s_setprio 0
    ds_read_b64_tr_b16 v[112:113], v3 offset:55424
    ds_read_b64_tr_b16 v[114:115], v4 offset:55424
    v_exp_f32 v66, v66
    v_exp_f32 v67, v67
    v_exp_f32 v68, v68
    v_exp_f32 v69, v69
    v_mfma_f32_32x32x4_2b_bf16 v[32:63], v[104:105], v[12:13], 0
    ds_read_b32 v104, v2 offset:18688
    v_exp_f32 v70, v70
    v_exp_f32 v71, v71
    v_exp_f32 v72, v72
    v_exp_f32 v73, v73
    v_exp_f32 v74, v74
    v_exp_f32 v75, v75
    v_exp_f32 v76, v76
    v_exp_f32 v77, v77
    s_waitcnt lgkmcnt(0)
    v_smfmac_f32_32x32x32_bf16 v[16:31], v[108:111], v[64:71], v5
    s_cmp_eq_u32 s41, 0
    s_cbranch_scc1 L_nog1
    global_load_dwordx2 v[246:247], v242, s[8:9] offset:2304
L_nog1:
    v_exp_f32 v78, v78
    v_exp_f32 v79, v79
    v_exp_f32 v80, v80
    v_exp_f32 v81, v81
    v_smfmac_f32_32x32x32_bf16 v[16:31], v[112:115], v[72:79], v5
    v_exp_f32 v82, v82
    v_exp_f32 v83, v83
    v_exp_f32 v84, v84
    v_exp_f32 v85, v85
    v_mfma_f32_32x32x16_bf16 v[32:47], v[96:99], v[8:11], v[32:47]
    v_exp_f32 v86, v86
    v_exp_f32 v87, v87
    v_exp_f32 v88, v88
    v_exp_f32 v89, v89
    v_mfma_f32_32x32x16_bf16 v[48:63], v[96:99], v[124:127], v[48:63]
    ds_read_b128 v[96:99], v1 offset:60416
    v_exp_f32 v90, v90
    v_exp_f32 v91, v91
    v_exp_f32 v92, v92
    v_exp_f32 v93, v93
    v_smfmac_f32_32x32x32_bf16 v[128:143], v[108:111], v[80:87], v5
    v_add_u32 v3, 58368, v3
    ds_read_b64_tr_b16 v[108:109], v3 offset:8192
    v_add_u32 v4, 58368, v4
    ds_read_b64_tr_b16 v[110:111], v4 offset:8192
    v_exp_f32 v94, v94
    v_exp_f32 v95, v95
    v_exp_f32 v32, v32
    v_exp_f32 v33, v33
    v_smfmac_f32_32x32x32_bf16 v[128:143], v[112:115], v[88:95], v5
    s_setprio 3
    ds_read_b64_tr_b16 v[112:113], v3 offset:8832
    ds_read_b64_tr_b16 v[114:115], v4 offset:8832
    v_exp_f32 v34, v34
    v_exp_f32 v35, v35
    v_exp_f32 v36, v36
    v_exp_f32 v37, v37
    v_mfma_f32_32x32x4_2b_bf16 v[64:95], v[104:105], v[12:13], 0
    ds_read_b32 v104, v2 offset:18944
    v_exp_f32 v38, v38
    v_exp_f32 v39, v39
    v_exp_f32 v40, v40
    v_exp_f32 v41, v41
    v_exp_f32 v42, v42
    v_exp_f32 v43, v43
    v_exp_f32 v44, v44
    v_exp_f32 v45, v45
    s_waitcnt lgkmcnt(0)
    v_smfmac_f32_32x32x32_bf16 v[16:31], v[108:111], v[32:39], v5
    s_cmp_eq_u32 s41, 0
    s_cbranch_scc1 L_nog2
    global_load_dwordx2 v[244:245], v242, s[8:9] offset:1152
L_nog2:
    v_exp_f32 v46, v46
    v_exp_f32 v47, v47
    v_exp_f32 v48, v48
    v_exp_f32 v49, v49
    v_smfmac_f32_32x32x32_bf16 v[16:31], v[112:115], v[40:47], v5
    v_exp_f32 v50, v50
    v_exp_f32 v51, v51
    v_exp_f32 v52, v52
    v_exp_f32 v53, v53
    v_mfma_f32_32x32x16_bf16 v[64:79], v[96:99], v[8:11], v[64:79]
    v_exp_f32 v54, v54
    v_exp_f32 v55, v55
    v_exp_f32 v56, v56
    v_exp_f32 v57, v57
    v_mfma_f32_32x32x16_bf16 v[80:95], v[96:99], v[124:127], v[80:95]
    ds_read_b128 v[96:99], v1 offset:62464
    v_exp_f32 v58, v58
    v_exp_f32 v59, v59
    v_exp_f32 v60, v60
    v_exp_f32 v61, v61
    v_smfmac_f32_32x32x32_bf16 v[128:143], v[108:111], v[48:55], v5
    ds_read_b64_tr_b16 v[108:109], v3 offset:10752
    ds_read_b64_tr_b16 v[110:111], v4 offset:10752
    v_exp_f32 v62, v62
    v_exp_f32 v63, v63
    v_exp_f32 v64, v64
    v_exp_f32 v65, v65
    v_smfmac_f32_32x32x32_bf16 v[128:143], v[112:115], v[56:63], v5
    s_setprio 2
    ds_read_b64_tr_b16 v[112:113], v3 offset:11392
    ds_read_b64_tr_b16 v[114:115], v4 offset:11392
    v_exp_f32 v66, v66
    v_exp_f32 v67, v67
    v_exp_f32 v68, v68
    v_exp_f32 v69, v69
    v_mfma_f32_32x32x4_2b_bf16 v[32:63], v[104:105], v[12:13], 0
    ds_read_b32 v104, v2 offset:19200
    v_exp_f32 v70, v70
    v_exp_f32 v71, v71
    v_exp_f32 v72, v72
    v_exp_f32 v73, v73
    v_exp_f32 v74, v74
    v_exp_f32 v75, v75
    v_exp_f32 v76, v76
    v_exp_f32 v77, v77
    s_waitcnt lgkmcnt(0)
    v_smfmac_f32_32x32x32_bf16 v[16:31], v[108:111], v[64:71], v5
    s_cmp_eq_u32 s41, 0
    s_cbranch_scc1 L_nog3
    global_load_dwordx2 v[242:243], v242, s[8:9]
L_nog3:
    v_exp_f32 v78, v78
    v_exp_f32 v79, v79
    v_exp_f32 v80, v80
    v_exp_f32 v81, v81
    v_smfmac_f32_32x32x32_bf16 v[16:31], v[112:115], v[72:79], v5
    v_exp_f32 v82, v82
    v_exp_f32 v83, v83
    v_exp_f32 v84, v84
    v_exp_f32 v85, v85
    v_mfma_f32_32x32x16_bf16 v[32:47], v[96:99], v[8:11], v[32:47]
    v_exp_f32 v86, v86
    v_exp_f32 v87, v87
    v_exp_f32 v88, v88
    v_exp_f32 v89, v89
    v_mfma_f32_32x32x16_bf16 v[48:63], v[96:99], v[124:127], v[48:63]
    ds_read_b128 v[96:99], v1 offset:64512
    v_exp_f32 v90, v90
    v_exp_f32 v91, v91
    v_exp_f32 v92, v92
    v_exp_f32 v93, v93
    v_smfmac_f32_32x32x32_bf16 v[128:143], v[108:111], v[80:87], v5
    ds_read_b64_tr_b16 v[108:109], v3 offset:13312
    ds_read_b64_tr_b16 v[110:111], v4 offset:13312
    v_exp_f32 v94, v94
    v_exp_f32 v95, v95
    v_exp_f32 v32, v32
    v_exp_f32 v33, v33
    v_smfmac_f32_32x32x32_bf16 v[128:143], v[112:115], v[88:95], v5
    s_setprio 1
    ds_read_b64_tr_b16 v[112:113], v3 offset:13952
    ds_read_b64_tr_b16 v[114:115], v4 offset:13952
    v_exp_f32 v34, v34
    v_exp_f32 v35, v35
    v_exp_f32 v36, v36
    v_exp_f32 v37, v37
    v_mfma_f32_32x32x4_2b_bf16 v[64:95], v[104:105], v[12:13], 0
    ds_read_b32 v104, v2 offset:37888
    v_exp_f32 v38, v38
    v_exp_f32 v39, v39
    v_exp_f32 v40, v40
    v_exp_f32 v41, v41
    v_exp_f32 v42, v42
    v_exp_f32 v43, v43
    v_exp_f32 v44, v44
    v_exp_f32 v45, v45
    s_waitcnt lgkmcnt(0)
    v_smfmac_f32_32x32x32_bf16 v[16:31], v[108:111], v[32:39], v5
    v_exp_f32 v46, v46
    v_exp_f32 v47, v47
    v_exp_f32 v48, v48
    v_exp_f32 v49, v49
    v_smfmac_f32_32x32x32_bf16 v[16:31], v[112:115], v[40:47], v5
    v_exp_f32 v50, v50
    v_exp_f32 v51, v51
    v_exp_f32 v52, v52
    v_exp_f32 v53, v53
    v_mfma_f32_32x32x16_bf16 v[64:79], v[96:99], v[8:11], v[64:79]
    v_exp_f32 v54, v54
    v_exp_f32 v55, v55
    v_exp_f32 v56, v56
    v_exp_f32 v57, v57
    v_mfma_f32_32x32x16_bf16 v[80:95], v[96:99], v[124:127], v[80:95]
    v_add_u32 v1, 58368, v1
    ds_read_b128 v[96:99], v1 offset:19456
    v_exp_f32 v58, v58
    v_exp_f32 v59, v59
    v_exp_f32 v60, v60
    v_exp_f32 v61, v61
    v_smfmac_f32_32x32x32_bf16 v[128:143], v[108:111], v[48:55], v5
    ds_read_b64_tr_b16 v[108:109], v3 offset:15872
    ds_read_b64_tr_b16 v[110:111], v4 offset:15872
    v_exp_f32 v62, v62
    v_exp_f32 v63, v63
    v_exp_f32 v64, v64
    v_exp_f32 v65, v65
    v_smfmac_f32_32x32x32_bf16 v[128:143], v[112:115], v[56:63], v5
    s_setprio 0
    ds_read_b64_tr_b16 v[112:113], v3 offset:16512
    ds_read_b64_tr_b16 v[114:115], v4 offset:16512
    v_exp_f32 v66, v66
    v_exp_f32 v67, v67
    v_exp_f32 v68, v68
    v_exp_f32 v69, v69
    v_mfma_f32_32x32x4_2b_bf16 v[32:63], v[104:105], v[12:13], 0
    ds_read_b32 v104, v2 offset:38144
    v_exp_f32 v70, v70
    v_exp_f32 v71, v71
    v_exp_f32 v72, v72
    v_exp_f32 v73, v73
    v_exp_f32 v74, v74
    v_exp_f32 v75, v75
    v_exp_f32 v76, v76
    v_exp_f32 v77, v77
    s_waitcnt lgkmcnt(0)
    v_smfmac_f32_32x32x32_bf16 v[16:31], v[108:111], v[64:71], v5
    v_exp_f32 v78, v78
    v_exp_f32 v79, v79
    v_exp_f32 v80, v80
    v_exp_f32 v81, v81
    v_smfmac_f32_32x32x32_bf16 v[16:31], v[112:115], v[72:79], v5
    v_exp_f32 v82, v82
    v_exp_f32 v83, v83
    v_exp_f32 v84, v84
    v_exp_f32 v85, v85
    v_mfma_f32_32x32x16_bf16 v[32:47], v[96:99], v[8:11], v[32:47]
    v_exp_f32 v86, v86
    v_exp_f32 v87, v87
    v_exp_f32 v88, v88
    v_exp_f32 v89, v89
    v_mfma_f32_32x32x16_bf16 v[48:63], v[96:99], v[124:127], v[48:63]
    ds_read_b128 v[96:99], v1 offset:21504
    v_exp_f32 v90, v90
    v_exp_f32 v91, v91
    v_exp_f32 v92, v92
    v_exp_f32 v93, v93
    v_smfmac_f32_32x32x32_bf16 v[128:143], v[108:111], v[80:87], v5
    ds_read_b64_tr_b16 v[108:109], v3 offset:27648
    ds_read_b64_tr_b16 v[110:111], v4 offset:27648
    v_exp_f32 v94, v94
    v_exp_f32 v95, v95
    v_exp_f32 v32, v32
    v_exp_f32 v33, v33
    v_smfmac_f32_32x32x32_bf16 v[128:143], v[112:115], v[88:95], v5
    s_setprio 3
    ds_read_b64_tr_b16 v[112:113], v3 offset:28288
    ds_read_b64_tr_b16 v[114:115], v4 offset:28288
    v_exp_f32 v34, v34
    v_exp_f32 v35, v35
    v_exp_f32 v36, v36
    v_exp_f32 v37, v37
    v_mfma_f32_32x32x4_2b_bf16 v[64:95], v[104:105], v[12:13], 0
    ds_read_b32 v104, v2 offset:38400
    v_exp_f32 v38, v38
    v_exp_f32 v39, v39
    v_exp_f32 v40, v40
    v_exp_f32 v41, v41
    v_exp_f32 v42, v42
    v_exp_f32 v43, v43
    v_exp_f32 v44, v44
    v_exp_f32 v45, v45
    s_waitcnt lgkmcnt(0)
    v_smfmac_f32_32x32x32_bf16 v[16:31], v[108:111], v[32:39], v5
    v_exp_f32 v46, v46
    v_exp_f32 v47, v47
    v_exp_f32 v48, v48
    v_exp_f32 v49, v49
    v_smfmac_f32_32x32x32_bf16 v[16:31], v[112:115], v[40:47], v5
    v_exp_f32 v50, v50
    v_exp_f32 v51, v51
    v_exp_f32 v52, v52
    v_exp_f32 v53, v53
    v_mfma_f32_32x32x16_bf16 v[64:79], v[96:99], v[8:11], v[64:79]
    v_exp_f32 v54, v54
    v_exp_f32 v55, v55
    v_exp_f32 v56, v56
    v_exp_f32 v57, v57
    v_mfma_f32_32x32x16_bf16 v[80:95], v[96:99], v[124:127], v[80:95]
    ds_read_b128 v[96:99], v1 offset:23552
    v_exp_f32 v58, v58
    v_exp_f32 v59, v59
    v_exp_f32 v60, v60
    v_exp_f32 v61, v61
    v_smfmac_f32_32x32x32_bf16 v[128:143], v[108:111], v[48:55], v5
    ds_read_b64_tr_b16 v[108:109], v3 offset:30208
    ds_read_b64_tr_b16 v[110:111], v4 offset:30208
    v_exp_f32 v62, v62
    v_exp_f32 v63, v63
    v_exp_f32 v64, v64
    v_exp_f32 v65, v65
    v_smfmac_f32_32x32x32_bf16 v[128:143], v[112:115], v[56:63], v5
    s_setprio 2
    ds_read_b64_tr_b16 v[112:113], v3 offset:30848
    ds_read_b64_tr_b16 v[114:115], v4 offset:30848
    v_exp_f32 v66, v66
    v_exp_f32 v67, v67
    v_exp_f32 v68, v68
    v_exp_f32 v69, v69
    v_mfma_f32_32x32x4_2b_bf16 v[32:63], v[104:105], v[12:13], 0
    ds_read_b32 v104, v2 offset:38656
    v_exp_f32 v70, v70
    v_exp_f32 v71, v71
    v_exp_f32 v72, v72
    v_exp_f32 v73, v73
    v_exp_f32 v74, v74
    v_exp_f32 v75, v75
    v_exp_f32 v76, v76
    v_exp_f32 v77, v77
    s_waitcnt lgkmcnt(0)
    v_smfmac_f32_32x32x32_bf16 v[16:31], v[108:111], v[64:71], v5
    v_exp_f32 v78, v78
    v_exp_f32 v79, v79
    v_exp_f32 v80, v80
    v_exp_f32 v81, v81
    v_smfmac_f32_32x32x32_bf16 v[16:31], v[112:115], v[72:79], v5
    v_exp_f32 v82, v82
    v_exp_f32 v83, v83
    v_exp_f32 v84, v84
    v_exp_f32 v85, v85
    v_mfma_f32_32x32x16_bf16 v[32:47], v[96:99], v[8:11], v[32:47]
    ds_read_b32 v154, v152 offset:72
    v_exp_f32 v86, v86
    v_exp_f32 v87, v87
    v_exp_f32 v88, v88
    v_exp_f32 v89, v89
    v_mfma_f32_32x32x16_bf16 v[48:63], v[96:99], v[124:127], v[48:63]
    ds_read_b128 v[96:99], v1 offset:25600
    v_exp_f32 v90, v90
    v_exp_f32 v91, v91
    v_exp_f32 v92, v92
    v_exp_f32 v93, v93
    v_smfmac_f32_32x32x32_bf16 v[128:143], v[108:111], v[80:87], v5
    ds_read_b64_tr_b16 v[108:109], v3 offset:32768
    ds_read_b64_tr_b16 v[110:111], v4 offset:32768
    v_exp_f32 v94, v94
    v_exp_f32 v95, v95
    v_exp_f32 v32, v32
    v_exp_f32 v33, v33
    v_smfmac_f32_32x32x32_bf16 v[128:143], v[112:115], v[88:95], v5
    s_waitcnt lgkmcnt(3)
    v_cmp_gt_u32 vcc, 8, v154
    s_nop 0
    s_cbranch_vccnz L_ck18
L_ckb18:
    s_setprio 1
    ds_read_b64_tr_b16 v[112:113], v3 offset:33408
    ds_read_b64_tr_b16 v[114:115], v4 offset:33408
    v_exp_f32 v34, v34
    v_exp_f32 v35, v35
    v_exp_f32 v36, v36
    v_exp_f32 v37, v37
    v_mfma_f32_32x32x4_2b_bf16 v[64:95], v[104:105], v[12:13], 0
    ds_read_b32 v104, v2 offset:57344
    v_exp_f32 v38, v38
    v_exp_f32 v39, v39
    v_exp_f32 v40, v40
    v_exp_f32 v41, v41
    v_exp_f32 v42, v42
    v_exp_f32 v43, v43
    v_exp_f32 v44, v44
    v_exp_f32 v45, v45
    s_waitcnt lgkmcnt(0)
    v_smfmac_f32_32x32x32_bf16 v[16:31], v[108:111], v[32:39], v5
    v_exp_f32 v46, v46
    v_exp_f32 v47, v47
    v_exp_f32 v48, v48
    v_exp_f32 v49, v49
    v_smfmac_f32_32x32x32_bf16 v[16:31], v[112:115], v[40:47], v5
    v_exp_f32 v50, v50
    v_exp_f32 v51, v51
    v_exp_f32 v52, v52
    v_exp_f32 v53, v53
    v_mfma_f32_32x32x16_bf16 v[64:79], v[96:99], v[8:11], v[64:79]
    v_exp_f32 v54, v54
    v_exp_f32 v55, v55
    v_exp_f32 v56, v56
    v_exp_f32 v57, v57
    v_mfma_f32_32x32x16_bf16 v[80:95], v[96:99], v[124:127], v[80:95]
    ds_read_b128 v[96:99], v1 offset:38912
    v_exp_f32 v58, v58
    v_exp_f32 v59, v59
    v_exp_f32 v60, v60
    v_exp_f32 v61, v61
    v_smfmac_f32_32x32x32_bf16 v[128:143], v[108:111], v[48:55], v5
    ds_read_b64_tr_b16 v[108:109], v3 offset:35328
    ds_read_b64_tr_b16 v[110:111], v4 offset:35328
    v_exp_f32 v62, v62
    v_exp_f32 v63, v63
    v_exp_f32 v64, v64
    v_exp_f32 v65, v65
    v_smfmac_f32_32x32x32_bf16 v[128:143], v[112:115], v[56:63], v5
    s_setprio 0
    ds_read_b64_tr_b16 v[112:113], v3 offset:35968
    ds_read_b64_tr_b16 v[114:115], v4 offset:35968
    v_exp_f32 v66, v66
    v_exp_f32 v67, v67
    v_exp_f32 v68, v68
    v_exp_f32 v69, v69
    v_mfma_f32_32x32x4_2b_bf16 v[32:63], v[104:105], v[12:13], 0
    ds_read_b32 v104, v2 offset:57600
    v_exp_f32 v70, v70
    v_exp_f32 v71, v71
    v_exp_f32 v72, v72
    v_exp_f32 v73, v73
    v_exp_f32 v74, v74
    v_exp_f32 v75, v75
    v_exp_f32 v76, v76
    v_exp_f32 v77, v77
    s_waitcnt lgkmcnt(0)
    v_smfmac_f32_32x32x32_bf16 v[16:31], v[108:111], v[64:71], v5
    v_exp_f32 v78, v78
    v_exp_f32 v79, v79
    v_exp_f32 v80, v80
    v_exp_f32 v81, v81
    v_smfmac_f32_32x32x32_bf16 v[16:31], v[112:115], v[72:79], v5
    v_exp_f32 v82, v82
    v_exp_f32 v83, v83
    v_exp_f32 v84, v84
    v_exp_f32 v85, v85
    v_mfma_f32_32x32x16_bf16 v[32:47], v[96:99], v[8:11], v[32:47]
    v_exp_f32 v86, v86
    v_exp_f32 v87, v87
    v_exp_f32 v88, v88
    v_exp_f32 v89, v89
    v_mfma_f32_32x32x16_bf16 v[48:63], v[96:99], v[124:127], v[48:63]
    ds_read_b128 v[96:99], v1 offset:40960
    v_exp_f32 v90, v90
    v_exp_f32 v91, v91
    v_exp_f32 v92, v92
    v_exp_f32 v93, v93
    v_smfmac_f32_32x32x32_bf16 v[128:143], v[108:111], v[80:87], v5
    ds_read_b64_tr_b16 v[108:109], v3 offset:47104
    ds_read_b64_tr_b16 v[110:111], v4 offset:47104
    v_exp_f32 v94, v94
    v_exp_f32 v95, v95
    v_exp_f32 v32, v32
    v_exp_f32 v33, v33
    v_smfmac_f32_32x32x32_bf16 v[128:143], v[112:115], v[88:95], v5
    s_setprio 3
    ds_read_b64_tr_b16 v[112:113], v3 offset:47744
    ds_read_b64_tr_b16 v[114:115], v4 offset:47744
    v_exp_f32 v34, v34
    v_exp_f32 v35, v35
    v_exp_f32 v36, v36
    v_exp_f32 v37, v37
    v_mfma_f32_32x32x4_2b_bf16 v[64:95], v[104:105], v[12:13], 0
    ds_read_b32 v104, v2 offset:57856
    v_exp_f32 v38, v38
    v_exp_f32 v39, v39
    v_exp_f32 v40, v40
    v_exp_f32 v41, v41
    v_exp_f32 v42, v42
    v_exp_f32 v43, v43
    v_exp_f32 v44, v44
    v_exp_f32 v45, v45
    s_waitcnt lgkmcnt(0)
    v_smfmac_f32_32x32x32_bf16 v[16:31], v[108:111], v[32:39], v5
    v_exp_f32 v46, v46
    v_exp_f32 v47, v47
    v_exp_f32 v48, v48
    v_exp_f32 v49, v49
    v_smfmac_f32_32x32x32_bf16 v[16:31], v[112:115], v[40:47], v5
    v_exp_f32 v50, v50
    v_exp_f32 v51, v51
    v_exp_f32 v52, v52
    v_exp_f32 v53, v53
    v_mfma_f32_32x32x16_bf16 v[64:79], v[96:99], v[8:11], v[64:79]
    v_exp_f32 v54, v54
    v_exp_f32 v55, v55
    v_exp_f32 v56, v56
    v_exp_f32 v57, v57
    v_mfma_f32_32x32x16_bf16 v[80:95], v[96:99], v[124:127], v[80:95]
    ds_read_b128 v[96:99], v1 offset:43008
    v_exp_f32 v58, v58
    v_exp_f32 v59, v59
    v_exp_f32 v60, v60
    v_exp_f32 v61, v61
    v_smfmac_f32_32x32x32_bf16 v[128:143], v[108:111], v[48:55], v5
    ds_read_b64_tr_b16 v[108:109], v3 offset:49664
    ds_read_b64_tr_b16 v[110:111], v4 offset:49664
    v_exp_f32 v62, v62
    v_exp_f32 v63, v63
    v_exp_f32 v64, v64
    v_exp_f32 v65, v65
    v_smfmac_f32_32x32x32_bf16 v[128:143], v[112:115], v[56:63], v5
    s_mov_b64 exec, 1
    ds_add_u32 v152, v153 offset:76
    s_mov_b64 exec, -1
    s_setprio 2
    ds_read_b64_tr_b16 v[112:113], v3 offset:50304
    ds_read_b64_tr_b16 v[114:115], v4 offset:50304
    v_exp_f32 v66, v66
    v_exp_f32 v67, v67
    v_exp_f32 v68, v68
    v_exp_f32 v69, v69
    v_mfma_f32_32x32x4_2b_bf16 v[32:63], v[104:105], v[12:13], 0
    ds_read_b32 v104, v2 offset:58112
    v_exp_f32 v70, v70
    v_exp_f32 v71, v71
    v_exp_f32 v72, v72
    v_exp_f32 v73, v73
    v_exp_f32 v74, v74
    v_exp_f32 v75, v75
    v_exp_f32 v76, v76
    v_exp_f32 v77, v77
    s_waitcnt lgkmcnt(0)
    v_smfmac_f32_32x32x32_bf16 v[16:31], v[108:111], v[64:71], v5
    v_exp_f32 v78, v78
    v_exp_f32 v79, v79
    v_exp_f32 v80, v80
    v_exp_f32 v81, v81
    v_smfmac_f32_32x32x32_bf16 v[16:31], v[112:115], v[72:79], v5
    v_exp_f32 v82, v82
    v_exp_f32 v83, v83
    v_exp_f32 v84, v84
    v_exp_f32 v85, v85
    v_mfma_f32_32x32x16_bf16 v[32:47], v[96:99], v[8:11], v[32:47]
    v_exp_f32 v86, v86
    v_exp_f32 v87, v87
    v_exp_f32 v88, v88
    v_exp_f32 v89, v89
    v_mfma_f32_32x32x16_bf16 v[48:63], v[96:99], v[124:127], v[48:63]
    ds_read_b128 v[96:99], v1 offset:45056
    v_exp_f32 v90, v90
    v_exp_f32 v91, v91
    v_exp_f32 v92, v92
    v_exp_f32 v93, v93
    v_smfmac_f32_32x32x32_bf16 v[128:143], v[108:111], v[80:87], v5
    ds_read_b64_tr_b16 v[108:109], v3 offset:52224
    ds_read_b64_tr_b16 v[110:111], v4 offset:52224
    v_exp_f32 v94, v94
    v_exp_f32 v95, v95
    v_exp_f32 v32, v32
    v_exp_f32 v33, v33
    v_smfmac_f32_32x32x32_bf16 v[128:143], v[112:115], v[88:95], v5
    s_setprio 1
    ds_read_b64_tr_b16 v[112:113], v3 offset:52864
    ds_read_b64_tr_b16 v[114:115], v4 offset:52864
    v_exp_f32 v34, v34
    v_exp_f32 v35, v35
    v_exp_f32 v36, v36
    v_exp_f32 v37, v37
    v_mfma_f32_32x32x4_2b_bf16 v[64:95], v[104:105], v[12:13], 0
    v_add_u32 v2, 58368, v2
    ds_read_b32 v104, v2 offset:18432
    v_exp_f32 v38, v38
    v_exp_f32 v39, v39
    v_exp_f32 v40, v40
    v_exp_f32 v41, v41
    v_exp_f32 v42, v42
    v_exp_f32 v43, v43
    v_exp_f32 v44, v44
    v_exp_f32 v45, v45
    s_waitcnt lgkmcnt(0)
    v_smfmac_f32_32x32x32_bf16 v[16:31], v[108:111], v[32:39], v5
    v_exp_f32 v46, v46
    v_exp_f32 v47, v47
    v_exp_f32 v48, v48
    v_exp_f32 v49, v49
    v_smfmac_f32_32x32x32_bf16 v[16:31], v[112:115], v[40:47], v5
    v_exp_f32 v50, v50
    v_exp_f32 v51, v51
    v_exp_f32 v52, v52
    v_exp_f32 v53, v53
    v_mfma_f32_32x32x16_bf16 v[64:79], v[96:99], v[8:11], v[64:79]
    ds_read_b32 v154, v152 offset:76
    v_exp_f32 v54, v54
    v_exp_f32 v55, v55
    v_exp_f32 v56, v56
    v_exp_f32 v57, v57
    v_mfma_f32_32x32x16_bf16 v[80:95], v[96:99], v[124:127], v[80:95]
    ds_read_b128 v[96:99], v1 offset:58368
    v_exp_f32 v58, v58
    v_exp_f32 v59, v59
    v_exp_f32 v60, v60
    v_exp_f32 v61, v61
    v_smfmac_f32_32x32x32_bf16 v[128:143], v[108:111], v[48:55], v5
    ds_read_b64_tr_b16 v[108:109], v3 offset:54784
    ds_read_b64_tr_b16 v[110:111], v4 offset:54784
    v_exp_f32 v62, v62
    v_exp_f32 v63, v63
    v_exp_f32 v64, v64
    v_exp_f32 v65, v65
    v_smfmac_f32_32x32x32_bf16 v[128:143], v[112:115], v[56:63], v5
    s_waitcnt lgkmcnt(3)
    v_cmp_gt_u32 vcc, 8, v154
    s_nop 0
    s_cbranch_vccnz L_ck19
L_ckb19:
    s_setprio 0
    ds_read_b64_tr_b16 v[112:113], v3 offset:55424
    ds_read_b64_tr_b16 v[114:115], v4 offset:55424
    v_exp_f32 v66, v66
    v_exp_f32 v67, v67
    v_exp_f32 v68, v68
    v_exp_f32 v69, v69
    v_mfma_f32_32x32x4_2b_bf16 v[32:63], v[104:105], v[12:13], 0
    ds_read_b32 v104, v2 offset:18688
    v_exp_f32 v70, v70
    v_exp_f32 v71, v71
    v_exp_f32 v72, v72
    v_exp_f32 v73, v73
    v_exp_f32 v74, v74
    v_exp_f32 v75, v75
    v_exp_f32 v76, v76
    v_exp_f32 v77, v77
    s_waitcnt lgkmcnt(0)
    v_smfmac_f32_32x32x32_bf16 v[16:31], v[108:111], v[64:71], v5
    s_lshl_b32 s60, s38, 13
    s_add_u32 m0, s60, 24576
    s_mov_b32 s61, 0
    buffer_load_dwordx4 v240, s[48:51], s61 offen lds
    v_exp_f32 v78, v78
    v_exp_f32 v79, v79
    v_exp_f32 v80, v80
    v_exp_f32 v81, v81
    v_smfmac_f32_32x32x32_bf16 v[16:31], v[112:115], v[72:79], v5
    s_lshl_b32 s60, s38, 13
    s_add_u32 m0, s60, 25600
    s_mov_b32 s61, 9216
    buffer_load_dwordx4 v240, s[48:51], s61 offen lds
    v_exp_f32 v82, v82
    v_exp_f32 v83, v83
    v_exp_f32 v84, v84
    v_exp_f32 v85, v85
    v_mfma_f32_32x32x16_bf16 v[32:47], v[96:99], v[8:11], v[32:47]
    v_exp_f32 v86, v86
    v_exp_f32 v87, v87
    v_exp_f32 v88, v88
    v_exp_f32 v89, v89
    v_mfma_f32_32x32x16_bf16 v[48:63], v[96:99], v[124:127], v[48:63]
    ds_read_b128 v[96:99], v1 offset:60416
    v_exp_f32 v90, v90
    v_exp_f32 v91, v91
    v_exp_f32 v92, v92
    v_exp_f32 v93, v93
    v_smfmac_f32_32x32x32_bf16 v[128:143], v[108:111], v[80:87], v5
    v_add_u32 v3, 58368, v3
    ds_read_b64_tr_b16 v[108:109], v3 offset:8192
    v_add_u32 v4, 58368, v4
    ds_read_b64_tr_b16 v[110:111], v4 offset:8192
    v_exp_f32 v94, v94
    v_exp_f32 v95, v95
    v_exp_f32 v32, v32
    v_exp_f32 v33, v33
    v_smfmac_f32_32x32x32_bf16 v[128:143], v[112:115], v[88:95], v5
    s_mov_b64 exec, 1
    ds_add_u32 v152, v153 offset:80
    s_mov_b64 exec, -1
    s_setprio 3
    ds_read_b64_tr_b16 v[112:113], v3 offset:8832
    ds_read_b64_tr_b16 v[114:115], v4 offset:8832
    v_exp_f32 v34, v34
    v_exp_f32 v35, v35
    v_exp_f32 v36, v36
    v_exp_f32 v37, v37
    v_mfma_f32_32x32x4_2b_bf16 v[64:95], v[104:105], v[12:13], 0
    ds_read_b32 v104, v2 offset:18944
    v_exp_f32 v38, v38
    v_exp_f32 v39, v39
    v_exp_f32 v40, v40
    v_exp_f32 v41, v41
    v_exp_f32 v42, v42
    v_exp_f32 v43, v43
    v_exp_f32 v44, v44
    v_exp_f32 v45, v45
    s_waitcnt lgkmcnt(0)
    v_smfmac_f32_32x32x32_bf16 v[16:31], v[108:111], v[32:39], v5
    s_lshl_b32 s60, s38, 13
    s_add_u32 m0, s60, 26624
    s_mov_b32 s61, 23040
    buffer_load_dwordx4 v240, s[48:51], s61 offen lds
    v_exp_f32 v46, v46
    v_exp_f32 v47, v47
    v_exp_f32 v48, v48
    v_exp_f32 v49, v49
    v_smfmac_f32_32x32x32_bf16 v[16:31], v[112:115], v[40:47], v5
    s_lshl_b32 s60, s38, 13
    s_add_u32 m0, s60, 27648
    s_mov_b32 s61, 32256
    buffer_load_dwordx4 v240, s[48:51], s61 offen lds
    v_exp_f32 v50, v50
    v_exp_f32 v51, v51
    v_exp_f32 v52, v52
    v_exp_f32 v53, v53
    v_mfma_f32_32x32x16_bf16 v[64:79], v[96:99], v[8:11], v[64:79]
    v_exp_f32 v54, v54
    v_exp_f32 v55, v55
    v_exp_f32 v56, v56
    v_exp_f32 v57, v57
    v_mfma_f32_32x32x16_bf16 v[80:95], v[96:99], v[124:127], v[80:95]
    ds_read_b128 v[96:99], v1 offset:62464
    v_exp_f32 v58, v58
    v_exp_f32 v59, v59
    v_exp_f32 v60, v60
    v_exp_f32 v61, v61
    v_smfmac_f32_32x32x32_bf16 v[128:143], v[108:111], v[48:55], v5
    ds_read_b64_tr_b16 v[108:109], v3 offset:10752
    ds_read_b64_tr_b16 v[110:111], v4 offset:10752
    v_exp_f32 v62, v62
    v_exp_f32 v63, v63
    v_exp_f32 v64, v64
    v_exp_f32 v65, v65
    v_smfmac_f32_32x32x32_bf16 v[128:143], v[112:115], v[56:63], v5
    s_setprio 2
    ds_read_b64_tr_b16 v[112:113], v3 offset:11392
    ds_read_b64_tr_b16 v[114:115], v4 offset:11392
    v_exp_f32 v66, v66
    v_exp_f32 v67, v67
    v_exp_f32 v68, v68
    v_exp_f32 v69, v69
    v_mfma_f32_32x32x4_2b_bf16 v[32:63], v[104:105], v[12:13], 0
    ds_read_b32 v104, v2 offset:19200
    v_exp_f32 v70, v70
    v_exp_f32 v71, v71
    v_exp_f32 v72, v72
    v_exp_f32 v73, v73
    v_exp_f32 v74, v74
    v_exp_f32 v75, v75
    v_exp_f32 v76, v76
    v_exp_f32 v77, v77
    s_waitcnt lgkmcnt(0)
    v_smfmac_f32_32x32x32_bf16 v[16:31], v[108:111], v[64:71], v5
    s_lshl_b32 s60, s38, 13
    s_add_u32 m0, s60, 28672
    s_mov_b32 s61, 41472
    buffer_load_dwordx4 v240, s[48:51], s61 offen lds
    v_exp_f32 v78, v78
    v_exp_f32 v79, v79
    v_exp_f32 v80, v80
    v_exp_f32 v81, v81
    v_smfmac_f32_32x32x32_bf16 v[16:31], v[112:115], v[72:79], v5
    s_lshl_b32 s60, s38, 13
    s_add_u32 m0, s60, 29696
    s_mov_b32 s61, 50688
    buffer_load_dwordx4 v240, s[48:51], s61 offen lds
    v_exp_f32 v82, v82
    v_exp_f32 v83, v83
    v_exp_f32 v84, v84
    v_exp_f32 v85, v85
    v_mfma_f32_32x32x16_bf16 v[32:47], v[96:99], v[8:11], v[32:47]
    v_exp_f32 v86, v86
    v_exp_f32 v87, v87
    v_exp_f32 v88, v88
    v_exp_f32 v89, v89
    v_mfma_f32_32x32x16_bf16 v[48:63], v[96:99], v[124:127], v[48:63]
    ds_read_b128 v[96:99], v1 offset:64512
    v_exp_f32 v90, v90
    v_exp_f32 v91, v91
    v_exp_f32 v92, v92
    v_exp_f32 v93, v93
    v_smfmac_f32_32x32x32_bf16 v[128:143], v[108:111], v[80:87], v5
    ds_read_b64_tr_b16 v[108:109], v3 offset:13312
    ds_read_b64_tr_b16 v[110:111], v4 offset:13312
    v_exp_f32 v94, v94
    v_exp_f32 v95, v95
    v_exp_f32 v32, v32
    v_exp_f32 v33, v33
    v_smfmac_f32_32x32x32_bf16 v[128:143], v[112:115], v[88:95], v5
    s_setprio 1
    ds_read_b64_tr_b16 v[112:113], v3 offset:13952
    ds_read_b64_tr_b16 v[114:115], v4 offset:13952
    v_exp_f32 v34, v34
    v_exp_f32 v35, v35
    v_exp_f32 v36, v36
    v_exp_f32 v37, v37
    v_mfma_f32_32x32x4_2b_bf16 v[64:95], v[104:105], v[12:13], 0
    ds_read_b32 v104, v2 offset:37888
    v_exp_f32 v38, v38
    v_exp_f32 v39, v39
    v_exp_f32 v40, v40
    v_exp_f32 v41, v41
    v_exp_f32 v42, v42
    v_exp_f32 v43, v43
    v_exp_f32 v44, v44
    v_exp_f32 v45, v45
    s_waitcnt lgkmcnt(0)
    v_smfmac_f32_32x32x32_bf16 v[16:31], v[108:111], v[32:39], v5
    s_lshl_b32 s60, s38, 13
    s_add_u32 m0, s60, 30720
    s_mov_b32 s61, 64512
    buffer_load_dwordx4 v240, s[48:51], s61 offen lds
    v_exp_f32 v46, v46
    v_exp_f32 v47, v47
    v_exp_f32 v48, v48
    v_exp_f32 v49, v49
    v_smfmac_f32_32x32x32_bf16 v[16:31], v[112:115], v[40:47], v5
    s_lshl_b32 s60, s38, 13
    s_add_u32 m0, s60, 31744
    s_mov_b32 s61, 73728
    buffer_load_dwordx4 v240, s[48:51], s61 offen lds
    v_exp_f32 v50, v50
    v_exp_f32 v51, v51
    v_exp_f32 v52, v52
    v_exp_f32 v53, v53
    v_mfma_f32_32x32x16_bf16 v[64:79], v[96:99], v[8:11], v[64:79]
    v_exp_f32 v54, v54
    v_exp_f32 v55, v55
    v_exp_f32 v56, v56
    v_exp_f32 v57, v57
    v_mfma_f32_32x32x16_bf16 v[80:95], v[96:99], v[124:127], v[80:95]
    v_add_u32 v1, 58368, v1
    ds_read_b128 v[96:99], v1 offset:19456
    v_exp_f32 v58, v58
    v_exp_f32 v59, v59
    v_exp_f32 v60, v60
    v_exp_f32 v61, v61
    v_smfmac_f32_32x32x32_bf16 v[128:143], v[108:111], v[48:55], v5
    ds_read_b64_tr_b16 v[108:109], v3 offset:15872
    ds_read_b64_tr_b16 v[110:111], v4 offset:15872
    v_exp_f32 v62, v62
    v_exp_f32 v63, v63
    v_exp_f32 v64, v64
    v_exp_f32 v65, v65
    v_smfmac_f32_32x32x32_bf16 v[128:143], v[112:115], v[56:63], v5
    s_setprio 0
    ds_read_b64_tr_b16 v[112:113], v3 offset:16512
    ds_read_b64_tr_b16 v[114:115], v4 offset:16512
    v_exp_f32 v66, v66
    v_exp_f32 v67, v67
    v_exp_f32 v68, v68
    v_exp_f32 v69, v69
    v_mfma_f32_32x32x4_2b_bf16 v[32:63], v[104:105], v[12:13], 0
    ds_read_b32 v104, v2 offset:38144
    v_exp_f32 v70, v70
    v_exp_f32 v71, v71
    v_exp_f32 v72, v72
    v_exp_f32 v73, v73
    v_exp_f32 v74, v74
    v_exp_f32 v75, v75
    v_exp_f32 v76, v76
    v_exp_f32 v77, v77
    s_waitcnt lgkmcnt(0)
    v_smfmac_f32_32x32x32_bf16 v[16:31], v[108:111], v[64:71], v5
    s_add_u32 m0, s83, 90112
    s_nop 0
    buffer_load_dwordx4 v241, s[48:51], 0 offen lds
    v_exp_f32 v78, v78
    v_exp_f32 v79, v79
    v_exp_f32 v80, v80
    v_exp_f32 v81, v81
    v_smfmac_f32_32x32x32_bf16 v[16:31], v[112:115], v[72:79], v5
    v_exp_f32 v82, v82
    v_exp_f32 v83, v83
    v_exp_f32 v84, v84
    v_exp_f32 v85, v85
    v_mfma_f32_32x32x16_bf16 v[32:47], v[96:99], v[8:11], v[32:47]
    v_exp_f32 v86, v86
    v_exp_f32 v87, v87
    v_exp_f32 v88, v88
    v_exp_f32 v89, v89
    v_mfma_f32_32x32x16_bf16 v[48:63], v[96:99], v[124:127], v[48:63]
    ds_read_b128 v[96:99], v1 offset:21504
    v_exp_f32 v90, v90
    v_exp_f32 v91, v91
    v_exp_f32 v92, v92
    v_exp_f32 v93, v93
    v_smfmac_f32_32x32x32_bf16 v[128:143], v[108:111], v[80:87], v5
    ds_read_b64_tr_b16 v[108:109], v3 offset:27648
    ds_read_b64_tr_b16 v[110:111], v4 offset:27648
    v_exp_f32 v94, v94
    v_exp_f32 v95, v95
    v_exp_f32 v32, v32
    v_exp_f32 v33, v33
    v_smfmac_f32_32x32x32_bf16 v[128:143], v[112:115], v[88:95], v5
    s_setprio 3
    ds_read_b64_tr_b16 v[112:113], v3 offset:28288
    ds_read_b64_tr_b16 v[114:115], v4 offset:28288
    v_exp_f32 v34, v34
    v_exp_f32 v35, v35
    v_exp_f32 v36, v36
    v_exp_f32 v37, v37
    v_mfma_f32_32x32x4_2b_bf16 v[64:95], v[104:105], v[12:13], 0
    ds_read_b32 v104, v2 offset:38400
    v_exp_f32 v38, v38
    v_exp_f32 v39, v39
    v_exp_f32 v40, v40
    v_exp_f32 v41, v41
    v_exp_f32 v42, v42
    v_exp_f32 v43, v43
    v_exp_f32 v44, v44
    v_exp_f32 v45, v45
    s_waitcnt lgkmcnt(0)
    v_smfmac_f32_32x32x32_bf16 v[16:31], v[108:111], v[32:39], v5
    v_exp_f32 v46, v46
    v_exp_f32 v47, v47
    v_exp_f32 v48, v48
    v_exp_f32 v49, v49
    v_smfmac_f32_32x32x32_bf16 v[16:31], v[112:115], v[40:47], v5
    v_exp_f32 v50, v50
    v_exp_f32 v51, v51
    v_exp_f32 v52, v52
    v_exp_f32 v53, v53
    v_mfma_f32_32x32x16_bf16 v[64:79], v[96:99], v[8:11], v[64:79]
    v_exp_f32 v54, v54
    v_exp_f32 v55, v55
    v_exp_f32 v56, v56
    v_exp_f32 v57, v57
    v_mfma_f32_32x32x16_bf16 v[80:95], v[96:99], v[124:127], v[80:95]
    ds_read_b128 v[96:99], v1 offset:23552
    v_exp_f32 v58, v58
    v_exp_f32 v59, v59
    v_exp_f32 v60, v60
    v_exp_f32 v61, v61
    v_smfmac_f32_32x32x32_bf16 v[128:143], v[108:111], v[48:55], v5
    ds_read_b64_tr_b16 v[108:109], v3 offset:30208
    ds_read_b64_tr_b16 v[110:111], v4 offset:30208
    v_exp_f32 v62, v62
    v_exp_f32 v63, v63
    v_exp_f32 v64, v64
    v_exp_f32 v65, v65
    v_smfmac_f32_32x32x32_bf16 v[128:143], v[112:115], v[56:63], v5
    s_setprio 0
    s_cmp_lt_u32 s38, 4
    s_cbranch_scc1 L_bfirst
    s_setprio 3
L_bfirst:
    ds_read_b64_tr_b16 v[112:113], v3 offset:30848
    ds_read_b64_tr_b16 v[114:115], v4 offset:30848
    v_exp_f32 v66, v66
    v_exp_f32 v67, v67
    v_exp_f32 v68, v68
    v_exp_f32 v69, v69
    v_mfma_f32_32x32x4_2b_bf16 v[32:63], v[104:105], v[12:13], 0
    ds_read_b32 v104, v2 offset:38656
    v_exp_f32 v70, v70
    v_exp_f32 v71, v71
    v_exp_f32 v72, v72
    v_exp_f32 v73, v73
    v_exp_f32 v74, v74
    v_exp_f32 v75, v75
    v_exp_f32 v76, v76
    v_exp_f32 v77, v77
    s_waitcnt lgkmcnt(0)
    v_smfmac_f32_32x32x32_bf16 v[16:31], v[108:111], v[64:71], v5
    v_exp_f32 v78, v78
    v_exp_f32 v79, v79
    v_exp_f32 v80, v80
    v_exp_f32 v81, v81
    v_smfmac_f32_32x32x32_bf16 v[16:31], v[112:115], v[72:79], v5
    v_exp_f32 v82, v82
    v_exp_f32 v83, v83
    v_exp_f32 v84, v84
    v_exp_f32 v85, v85
    v_mfma_f32_32x32x16_bf16 v[32:47], v[96:99], v[8:11], v[32:47]
    v_exp_f32 v86, v86
    v_exp_f32 v87, v87
    v_exp_f32 v88, v88
    v_exp_f32 v89, v89
    v_mfma_f32_32x32x16_bf16 v[48:63], v[96:99], v[124:127], v[48:63]
    ds_read_b128 v[96:99], v1 offset:25600
    v_exp_f32 v90, v90
    v_exp_f32 v91, v91
    v_exp_f32 v92, v92
    v_exp_f32 v93, v93
    v_smfmac_f32_32x32x32_bf16 v[128:143], v[108:111], v[80:87], v5
    ds_read_b64_tr_b16 v[108:109], v3 offset:32768
    ds_read_b64_tr_b16 v[110:111], v4 offset:32768
    v_exp_f32 v94, v94
    v_exp_f32 v95, v95
    v_exp_f32 v32, v32
    v_exp_f32 v33, v33
    v_smfmac_f32_32x32x32_bf16 v[128:143], v[112:115], v[88:95], v5
    ds_read_b64_tr_b16 v[112:113], v3 offset:33408
    ds_read_b64_tr_b16 v[114:115], v4 offset:33408
    v_exp_f32 v34, v34
    v_exp_f32 v35, v35
    v_exp_f32 v36, v36
    v_exp_f32 v37, v37
    v_mfma_f32_32x32x4_2b_bf16 v[64:95], v[104:105], v[12:13], 0
    v_exp_f32 v38, v38
    v_exp_f32 v39, v39
    v_exp_f32 v40, v40
    v_exp_f32 v41, v41
    v_exp_f32 v42, v42
    v_exp_f32 v43, v43
    v_exp_f32 v44, v44
    v_exp_f32 v45, v45
    s_waitcnt lgkmcnt(0)
    v_smfmac_f32_32x32x32_bf16 v[16:31], v[108:111], v[32:39], v5
    v_exp_f32 v46, v46
    v_exp_f32 v47, v47
    v_exp_f32 v48, v48
    v_exp_f32 v49, v49
    v_smfmac_f32_32x32x32_bf16 v[16:31], v[112:115], v[40:47], v5
    v_exp_f32 v50, v50
    v_exp_f32 v51, v51
    v_exp_f32 v52, v52
    v_exp_f32 v53, v53
    v_mfma_f32_32x32x16_bf16 v[64:79], v[96:99], v[8:11], v[64:79]
    ds_read_b32 v154, v152 offset:80
    v_exp_f32 v54, v54
    v_exp_f32 v55, v55
    v_exp_f32 v56, v56
    v_exp_f32 v57, v57
    v_mfma_f32_32x32x16_bf16 v[80:95], v[96:99], v[124:127], v[80:95]
    v_exp_f32 v58, v58
    v_exp_f32 v59, v59
    v_exp_f32 v60, v60
    v_exp_f32 v61, v61
    v_smfmac_f32_32x32x32_bf16 v[128:143], v[108:111], v[48:55], v5
    ds_read_b64_tr_b16 v[108:109], v3 offset:35328
    ds_read_b64_tr_b16 v[110:111], v4 offset:35328
    v_exp_f32 v62, v62
    v_exp_f32 v63, v63
    v_exp_f32 v64, v64
    v_exp_f32 v65, v65
    v_smfmac_f32_32x32x32_bf16 v[128:143], v[112:115], v[56:63], v5
    s_waitcnt lgkmcnt(2)
    v_cmp_gt_u32 vcc, 8, v154
    s_nop 0
    s_cbranch_vccnz L_ck20
L_ckb20:
    ds_read_b64_tr_b16 v[112:113], v3 offset:35968
    ds_read_b64_tr_b16 v[114:115], v4 offset:35968
    v_exp_f32 v66, v66
    v_exp_f32 v67, v67
    v_exp_f32 v68, v68
    v_exp_f32 v69, v69
    v_exp_f32 v70, v70
    v_exp_f32 v71, v71
    v_exp_f32 v72, v72
    v_exp_f32 v73, v73
    v_exp_f32 v74, v74
    v_exp_f32 v75, v75
    v_exp_f32 v76, v76
    v_exp_f32 v77, v77
    s_waitcnt lgkmcnt(0)
    v_smfmac_f32_32x32x32_bf16 v[16:31], v[108:111], v[64:71], v5
    s_waitcnt vmcnt(9)
    s_cmp_eq_u32 s41, 0
    s_cbranch_scc1 L_nou_fast
    s_lshl_b32 s60, s38, 9
    s_add_u32 s60, s60, 98784
    v_lshl_add_u32 v103, v0, 3, s60
    s_mov_b32 s60, 0x05040100
    s_mov_b32 s61, 0x07060302
    v_perm_b32 v144, v244, v242, s60
    v_perm_b32 v145, v248, v246, s60
    ds_write_b64 v103, v[144:145] offset:0
    v_perm_b32 v146, v244, v242, s61
    v_perm_b32 v147, v248, v246, s61
    ds_write_b64 v103, v[146:147] offset:4608
    v_perm_b32 v148, v245, v243, s60
    v_perm_b32 v149, v249, v247, s60
    ds_write_b64 v103, v[148:149] offset:9216
    v_perm_b32 v150, v245, v243, s61
    v_perm_b32 v151, v249, v247, s61
    ds_write_b64 v103, v[150:151] offset:13824
L_nou_fast:
    v_exp_f32 v78, v78
    v_exp_f32 v79, v79
    v_exp_f32 v80, v80
    v_exp_f32 v81, v81
    v_smfmac_f32_32x32x32_bf16 v[16:31], v[112:115], v[72:79], v5
    v_exp_f32 v82, v82
    v_exp_f32 v83, v83
    v_exp_f32 v84, v84
    v_exp_f32 v85, v85
    v_exp_f32 v86, v86
    v_exp_f32 v87, v87
    v_exp_f32 v88, v88
    v_exp_f32 v89, v89
    v_exp_f32 v90, v90
    v_exp_f32 v91, v91
    v_exp_f32 v92, v92
    v_exp_f32 v93, v93
    v_smfmac_f32_32x32x32_bf16 v[128:143], v[108:111], v[80:87], v5
    s_mul_i32 s60, s3, 6144
    v_lshl_add_u32 v101, v0, 4, s60
    v_mov_b32 v100, 163760
    v_add_f32 v15, abs(v16), abs(v17)
    v_add_f32 v15, v15, abs(v18)
    v_add_f32 v15, v15, abs(v19)
    v_add_f32 v15, v15, abs(v20)
    v_add_f32 v15, v15, abs(v21)
    v_add_f32 v15, v15, abs(v22)
    v_add_f32 v15, v15, abs(v23)
    v_add_f32 v15, v15, abs(v24)
    v_add_f32 v15, v15, abs(v25)
    v_add_f32 v15, v15, abs(v26)
    s_cmp_lt_u32 s38, 4
    s_cbranch_scc1 L_att_keepa
    ds_write_b128 v101, v[16:19] offset:0
    ds_write_b128 v101, v[20:23] offset:1024
    ds_write_b128 v101, v[24:27] offset:2048
L_att_keepa:
    v_exp_f32 v94, v94
    v_exp_f32 v95, v95
    s_nop 1
    v_smfmac_f32_32x32x32_bf16 v[128:143], v[112:115], v[88:95], v5
    s_cmp_lt_u32 s38, 4
    s_cbranch_scc1 L_att_keep
    s_nop 9
    ds_write_b128 v101, v[128:131] offset:3072
    ds_write_b128 v101, v[132:135] offset:4096
    ds_write_b128 v101, v[136:139] offset:5120
L_att_keep:
    s_nop 9
    v_add_f32 v15, v15, abs(v128)
    v_add_f32 v15, v15, abs(v129)
    v_add_f32 v15, v15, abs(v130)
    v_add_f32 v15, v15, abs(v131)
    v_add_f32 v15, v15, abs(v132)
    v_add_f32 v15, v15, abs(v133)
    v_add_f32 v15, v15, abs(v134)
    v_add_f32 v15, v15, abs(v135)
    v_add_f32 v15, v15, abs(v136)
    v_add_f32 v15, v15, abs(v137)
    v_add_f32 v15, v15, abs(v138)
    v_min_f32 v102, v26, v138
    s_mov_b32 s62, 0x21800000
    v_cmp_ngt_f32 vcc, 0x7b800000, v15
    v_cmp_nlt_f32 s[60:61], s62, v102
    s_cmp_lt_u32 s38, 4
    s_cselect_b32 s60, s60, 0
    s_or_b32 vcc_lo, vcc_lo, s60
    s_cmp_eq_u64 vcc, 0
    s_cbranch_scc1 L_att_good
    v_mov_b32 v15, 1
    ds_write_b32 v100, v15
L_att_good:
    s_waitcnt vmcnt(0)
    s_waitcnt lgkmcnt(0)
    s_barrier
    ds_read_b32 v15, v100
    s_cmp_lt_u32 s38, 4
    s_cbranch_scc1 L_att_comb
    s_waitcnt lgkmcnt(0)
    v_cmp_ne_u32 vcc, 0, v15
    s_nop 0
    s_cbranch_vccnz L_att_slow
    s_branch L_att_fin
L_att_comb:
    ds_read_b128 v[40:43], v101 offset:0
    ds_read_b128 v[44:47], v101 offset:1024
    ds_read_b128 v[48:51], v101 offset:2048
    ds_read_b128 v[52:55], v101 offset:3072
    ds_read_b128 v[56:59], v101 offset:4096
    ds_read_b128 v[60:63], v101 offset:5120
    v_mov_b32 v102, 163752
    v_mov_b32 v103, 1
    s_mov_b64 exec, 1
    ds_add_u32 v102, v103
    s_mov_b64 exec, -1
    s_waitcnt lgkmcnt(7)
    v_cmp_ne_u32 vcc, 0, v15
    s_nop 0
    s_cbranch_vccnz L_att_slow
    s_waitcnt lgkmcnt(6)
    v_add_f32 v16, v16, v40
    v_add_f32 v17, v17, v41
    v_add_f32 v18, v18, v42
    v_add_f32 v19, v19, v43
    s_waitcnt lgkmcnt(5)
    v_add_f32 v20, v20, v44
    v_add_f32 v21, v21, v45
    v_add_f32 v22, v22, v46
    v_add_f32 v23, v23, v47
    s_waitcnt lgkmcnt(4)
    v_add_f32 v24, v24, v48
    v_add_f32 v25, v25, v49
    v_add_f32 v26, v26, v50
    v_mov_b32 v15, v26
    s_nop 1
    v_permlane32_swap_b32 v15, v26
    v_rcp_f32 v15, v15
    v_lshlrev_b32 v38, 4, v0
    v_and_b32 v39, 31, v0
    v_lshlrev_b32 v39, 2, v39
    v_mul_f32 v16, v15, v16
    v_mul_f32 v17, v15, v17
    v_mul_f32 v18, v15, v18
    v_mul_f32 v19, v15, v19
    v_mul_f32 v20, v15, v20
    v_mul_f32 v21, v15, v21
    v_mul_f32 v22, v15, v22
    v_mul_f32 v23, v15, v23
    v_mul_f32 v24, v15, v24
    v_mul_f32 v25, v15, v25
    v_cvt_pk_bf16_f32 v32, v16, v17
    v_cvt_pk_bf16_f32 v33, v18, v19
    v_cvt_pk_bf16_f32 v34, v20, v21
    v_cvt_pk_bf16_f32 v35, v22, v23
    v_cvt_pk_bf16_f32 v36, v24, v25
    buffer_store_dwordx4 v[32:35], v38, s[52:55], s65 offen sc1
    s_mov_b32 exec_hi, 0
    buffer_store_dword v36, v39, s[52:55], s64 offen sc1
    s_mov_b32 exec_hi, -1
    s_waitcnt lgkmcnt(3)
    v_add_f32 v128, v128, v52
    v_add_f32 v129, v129, v53
    v_add_f32 v130, v130, v54
    v_add_f32 v131, v131, v55
    s_waitcnt lgkmcnt(2)
    v_add_f32 v132, v132, v56
    v_add_f32 v133, v133, v57
    v_add_f32 v134, v134, v58
    v_add_f32 v135, v135, v59
    s_waitcnt lgkmcnt(1)
    v_add_f32 v136, v136, v60
    v_add_f32 v137, v137, v61
    v_add_f32 v138, v138, v62
    v_mov_b32 v15, v138
    s_nop 1
    v_permlane32_swap_b32 v15, v138
    v_rcp_f32 v15, v15
    s_add_u32 s64, s64, 36864
    s_add_u32 s65, s65, 36864
    v_mul_f32 v128, v15, v128
    v_mul_f32 v129, v15, v129
    v_mul_f32 v130, v15, v130
    v_mul_f32 v131, v15, v131
    v_mul_f32 v132, v15, v132
    v_mul_f32 v133, v15, v133
    v_mul_f32 v134, v15, v134
    v_mul_f32 v135, v15, v135
    v_mul_f32 v136, v15, v136
    v_mul_f32 v137, v15, v137
    v_cvt_pk_bf16_f32 v72, v128, v129
    v_cvt_pk_bf16_f32 v73, v130, v131
    v_cvt_pk_bf16_f32 v74, v132, v133
    v_cvt_pk_bf16_f32 v75, v134, v135
    v_cvt_pk_bf16_f32 v76, v136, v137
    buffer_store_dwordx4 v[72:75], v38, s[52:55], s65 offen sc1
    s_mov_b32 exec_hi, 0
    buffer_store_dword v76, v39, s[52:55], s64 offen sc1
    s_mov_b32 exec_hi, -1
L_att_fin:
    s_cmp_lt_u32 s38, 4
    s_cbranch_scc1 L_t_pub
    v_mov_b32 v250, 163752
    s_cmp_eq_u32 s41, 1
    s_cbranch_scc1 L_t_conv
    s_cmp_eq_u32 s59, 0
    s_cbranch_scc1 L_end_tail
    s_mov_b32 s61, 3200000
L_spin_xd:
    ds_read_b32 v251, v250
    s_sub_u32 s61, s61, 1
    s_cmp_eq_u32 s61, 0
    s_cbranch_scc1 L_spun_xd
    s_waitcnt lgkmcnt(0)
    v_cmp_gt_u32 vcc, 4, v251
    s_nop 0
    s_cbranch_vccnz L_spin_xd
L_spun_xd:
    s_waitcnt lgkmcnt(0)
    s_branch L_t_p3
L_t_conv:
    s_setprio 2
    ds_write_b128 v216, v[236:239]
    ds_write_b128 v217, v[236:239]
    ds_write_b128 v218, v[160:163] offset:2096
    v_add_u32 v1, 6580, v218
    ds_write2_b32 v1, v160, v161 offset0:0 offset1:1
    ds_write2_b32 v1, v162, v163 offset0:2 offset1:3
    ds_write_b128 v218, v[164:167] offset:4336
    v_add_u32 v1, 8820, v218
    ds_write2_b32 v1, v164, v165 offset0:0 offset1:1
    ds_write2_b32 v1, v166, v167 offset0:2 offset1:3
    ds_write_b128 v218, v[168:171] offset:1072
    v_add_u32 v1, 5556, v218
    ds_write2_b32 v1, v168, v169 offset0:0 offset1:1
    ds_write2_b32 v1, v170, v171 offset0:2 offset1:3
    ds_write_b128 v218, v[172:175] offset:3312
    v_add_u32 v1, 7796, v218
    ds_write2_b32 v1, v172, v173 offset0:0 offset1:1
    ds_write2_b32 v1, v174, v175 offset0:2 offset1:3
    ds_write_b16 v219, v178 offset:32
    ds_write_b16 v219, v178 offset:226
    ds_write_b16 v219, v179
    ds_write_b16 v219, v179 offset:194
    s_mov_b64 exec, 0xfff
    ds_write_b32 v227, v176
    s_mov_b64 exec, -1
    s_mul_i32 s64, s3, 1536
    s_add_u32 s64, s64, 4294872064
    v_add_u32 v204, s64, v224
    ds_read_b128 v[32:35], v221 offset:448
    ds_read_b64 v[0:1], v220 offset:2048
    ds_read_b64 v[2:3], v220 offset:2056
    ds_read_b128 v[36:39], v221 offset:960
    ds_read_b64 v[4:5], v220 offset:1536
    ds_read_b64 v[6:7], v220 offset:1544
    ds_read_b128 v[40:43], v221 offset:1472
    ds_read_b64 v[8:9], v220 offset:1024
    ds_read_b64 v[10:11], v220 offset:1032
    ds_read_b128 v[44:47], v221 offset:1984
    ds_read_b64 v[12:13], v220 offset:512
    ds_read_b64 v[14:15], v220 offset:520
    ds_read_b128 v[48:51], v221 offset:384
    ds_read_b64 v[16:17], v220 offset:1984
    ds_read_b64 v[18:19], v220 offset:1992
    ds_read_b128 v[52:55], v221 offset:896
    ds_read_b64 v[20:21], v220 offset:1472
    ds_read_b64 v[22:23], v220 offset:1480
    ds_read_b128 v[56:59], v221 offset:1408
    ds_read_b64 v[24:25], v220 offset:960
    ds_read_b64 v[26:27], v220 offset:968
    ds_read_b128 v[60:63], v221 offset:1920
    ds_read_b64 v[28:29], v220 offset:448
    ds_read_b64 v[30:31], v220 offset:456
    s_waitcnt lgkmcnt(14)
    v_mfma_f32_16x16x32_bf16 v[128:131], v[0:3], v[32:35], 0
    ds_read_b128 v[96:99], v221 offset:320
    ds_read_b64 v[64:65], v220 offset:1920
    v_mfma_f32_16x16x32_bf16 v[132:135], v[0:3], v[36:39], 0
    ds_read_b64 v[66:67], v220 offset:1928
    ds_read_b128 v[100:103], v221 offset:832
    v_mfma_f32_16x16x32_bf16 v[136:139], v[4:7], v[36:39], 0
    ds_read_b64 v[68:69], v220 offset:1408
    ds_read_b64 v[70:71], v220 offset:1416
    v_mfma_f32_16x16x32_bf16 v[132:135], v[4:7], v[32:35], v[132:135]
    ds_read_b128 v[104:107], v221 offset:1344
    ds_read_b64 v[72:73], v220 offset:896
    v_mfma_f32_16x16x32_bf16 v[136:139], v[0:3], v[40:43], v[136:139]
    ds_read_b64 v[74:75], v220 offset:904
    ds_read_b128 v[108:111], v221 offset:1856
    v_mfma_f32_16x16x32_bf16 v[140:143], v[4:7], v[40:43], 0
    ds_read_b64 v[76:77], v220 offset:384
    v_mfma_f32_16x16x32_bf16 v[136:139], v[8:11], v[32:35], v[136:139]
    ds_read_b64 v[78:79], v220 offset:392
    v_mfma_f32_16x16x32_bf16 v[140:143], v[8:11], v[36:39], v[140:143]
    ds_read_b128 v[112:115], v221 offset:256
    s_waitcnt lgkmcnt(14)
    v_mfma_f32_16x16x32_bf16 v[128:131], v[16:19], v[48:51], v[128:131]
    ds_read_b64 v[80:81], v220 offset:1856
    v_mfma_f32_16x16x32_bf16 v[140:143], v[12:15], v[32:35], v[140:143]
    ds_read_b64 v[82:83], v220 offset:1864
    v_mfma_f32_16x16x32_bf16 v[140:143], v[0:3], v[44:47], v[140:143]
    ds_read_b128 v[116:119], v221 offset:768
    v_mfma_f32_16x16x32_bf16 v[132:135], v[16:19], v[52:55], v[132:135]
    ds_read_b64 v[84:85], v220 offset:1344
    v_mfma_f32_16x16x32_bf16 v[136:139], v[20:23], v[52:55], v[136:139]
    ds_read_b64 v[86:87], v220 offset:1352
    v_mfma_f32_16x16x32_bf16 v[132:135], v[20:23], v[48:51], v[132:135]
    ds_read_b128 v[120:123], v221 offset:1280
    v_mfma_f32_16x16x32_bf16 v[136:139], v[16:19], v[56:59], v[136:139]
    ds_read_b64 v[88:89], v220 offset:832
    v_mfma_f32_16x16x32_bf16 v[140:143], v[20:23], v[56:59], v[140:143]
    ds_read_b64 v[90:91], v220 offset:840
    v_mfma_f32_16x16x32_bf16 v[136:139], v[24:27], v[48:51], v[136:139]
    ds_read_b128 v[124:127], v221 offset:1792
    v_mfma_f32_16x16x32_bf16 v[140:143], v[24:27], v[52:55], v[140:143]
    ds_read_b64 v[92:93], v220 offset:320
    v_mfma_f32_16x16x32_bf16 v[140:143], v[16:19], v[60:63], v[140:143]
    ds_read_b64 v[94:95], v220 offset:328
    s_waitcnt lgkmcnt(14)
    v_mfma_f32_16x16x32_bf16 v[140:143], v[28:31], v[48:51], v[140:143]
    v_mfma_f32_16x16x32_bf16 v[128:131], v[64:67], v[96:99], v[128:131]
    ds_read_b128 v[32:35], v221 offset:192
    ds_read_b64 v[0:1], v220 offset:1792
    v_mfma_f32_16x16x32_bf16 v[132:135], v[64:67], v[100:103], v[132:135]
    ds_read_b64 v[2:3], v220 offset:1800
    ds_read_b128 v[36:39], v221 offset:704
    v_mfma_f32_16x16x32_bf16 v[136:139], v[68:71], v[100:103], v[136:139]
    ds_read_b64 v[4:5], v220 offset:1280
    ds_read_b64 v[6:7], v220 offset:1288
    v_mfma_f32_16x16x32_bf16 v[132:135], v[68:71], v[96:99], v[132:135]
    ds_read_b128 v[40:43], v221 offset:1216
    ds_read_b64 v[8:9], v220 offset:768
    v_mfma_f32_16x16x32_bf16 v[136:139], v[64:67], v[104:107], v[136:139]
    ds_read_b64 v[10:11], v220 offset:776
    ds_read_b128 v[44:47], v221 offset:1728
    v_mfma_f32_16x16x32_bf16 v[140:143], v[68:71], v[104:107], v[140:143]
    ds_read_b64 v[12:13], v220 offset:256
    v_mfma_f32_16x16x32_bf16 v[136:139], v[72:75], v[96:99], v[136:139]
    ds_read_b64 v[14:15], v220 offset:264
    v_mfma_f32_16x16x32_bf16 v[140:143], v[72:75], v[100:103], v[140:143]
    ds_read_b128 v[48:51], v221 offset:128
    s_waitcnt lgkmcnt(14)
    v_mfma_f32_16x16x32_bf16 v[128:131], v[80:83], v[112:115], v[128:131]
    ds_read_b64 v[16:17], v220 offset:1728
    v_mfma_f32_16x16x32_bf16 v[140:143], v[76:79], v[96:99], v[140:143]
    ds_read_b64 v[18:19], v220 offset:1736
    v_mfma_f32_16x16x32_bf16 v[140:143], v[64:67], v[108:111], v[140:143]
    ds_read_b128 v[52:55], v221 offset:640
    v_mfma_f32_16x16x32_bf16 v[132:135], v[80:83], v[116:119], v[132:135]
    ds_read_b64 v[20:21], v220 offset:1216
    v_mfma_f32_16x16x32_bf16 v[136:139], v[84:87], v[116:119], v[136:139]
    ds_read_b64 v[22:23], v220 offset:1224
    v_mfma_f32_16x16x32_bf16 v[132:135], v[84:87], v[112:115], v[132:135]
    ds_read_b128 v[56:59], v221 offset:1152
    v_mfma_f32_16x16x32_bf16 v[136:139], v[80:83], v[120:123], v[136:139]
    ds_read_b64 v[24:25], v220 offset:704
    v_mfma_f32_16x16x32_bf16 v[140:143], v[84:87], v[120:123], v[140:143]
    ds_read_b64 v[26:27], v220 offset:712
    v_mfma_f32_16x16x32_bf16 v[136:139], v[88:91], v[112:115], v[136:139]
    ds_read_b128 v[60:63], v221 offset:1664
    v_mfma_f32_16x16x32_bf16 v[140:143], v[88:91], v[116:119], v[140:143]
    ds_read_b64 v[28:29], v220 offset:192
    v_mfma_f32_16x16x32_bf16 v[140:143], v[80:83], v[124:127], v[140:143]
    ds_read_b64 v[30:31], v220 offset:200
    s_waitcnt lgkmcnt(14)
    v_mfma_f32_16x16x32_bf16 v[140:143], v[92:95], v[112:115], v[140:143]
    v_mfma_f32_16x16x32_bf16 v[128:131], v[0:3], v[32:35], v[128:131]
    ds_read_b128 v[96:99], v221 offset:64
    ds_read_b64 v[64:65], v220 offset:1664
    v_mfma_f32_16x16x32_bf16 v[132:135], v[0:3], v[36:39], v[132:135]
    ds_read_b64 v[66:67], v220 offset:1672
    ds_read_b128 v[100:103], v221 offset:576
    v_mfma_f32_16x16x32_bf16 v[136:139], v[4:7], v[36:39], v[136:139]
    ds_read_b64 v[68:69], v220 offset:1152
    ds_read_b64 v[70:71], v220 offset:1160
    v_mfma_f32_16x16x32_bf16 v[132:135], v[4:7], v[32:35], v[132:135]
    ds_read_b128 v[104:107], v221 offset:1088
    ds_read_b64 v[72:73], v220 offset:640
    v_mfma_f32_16x16x32_bf16 v[136:139], v[0:3], v[40:43], v[136:139]
    ds_read_b64 v[74:75], v220 offset:648
    ds_read_b128 v[108:111], v221 offset:1600
    v_mfma_f32_16x16x32_bf16 v[140:143], v[4:7], v[40:43], v[140:143]
    ds_read_b64 v[76:77], v220 offset:128
    v_mfma_f32_16x16x32_bf16 v[136:139], v[8:11], v[32:35], v[136:139]
    ds_read_b64 v[78:79], v220 offset:136
    v_mfma_f32_16x16x32_bf16 v[140:143], v[8:11], v[36:39], v[140:143]
    ds_read_b128 v[112:115], v221 offset:0
    s_waitcnt lgkmcnt(14)
    v_mfma_f32_16x16x32_bf16 v[128:131], v[16:19], v[48:51], v[128:131]
    ds_read_b64 v[80:81], v220 offset:1600
    v_mfma_f32_16x16x32_bf16 v[140:143], v[12:15], v[32:35], v[140:143]
    ds_read_b64 v[82:83], v220 offset:1608
    v_mfma_f32_16x16x32_bf16 v[140:143], v[0:3], v[44:47], v[140:143]
    ds_read_b128 v[116:119], v221 offset:512
    v_mfma_f32_16x16x32_bf16 v[132:135], v[16:19], v[52:55], v[132:135]
    ds_read_b64 v[84:85], v220 offset:1088
    v_mfma_f32_16x16x32_bf16 v[136:139], v[20:23], v[52:55], v[136:139]
    ds_read_b64 v[86:87], v220 offset:1096
    v_mfma_f32_16x16x32_bf16 v[132:135], v[20:23], v[48:51], v[132:135]
    ds_read_b128 v[120:123], v221 offset:1024
    v_mfma_f32_16x16x32_bf16 v[136:139], v[16:19], v[56:59], v[136:139]
    ds_read_b64 v[88:89], v220 offset:576
    v_mfma_f32_16x16x32_bf16 v[140:143], v[20:23], v[56:59], v[140:143]
    ds_read_b64 v[90:91], v220 offset:584
    v_mfma_f32_16x16x32_bf16 v[136:139], v[24:27], v[48:51], v[136:139]
    ds_read_b128 v[124:127], v221 offset:1536
    v_mfma_f32_16x16x32_bf16 v[140:143], v[24:27], v[52:55], v[140:143]
    ds_read_b64 v[92:93], v220 offset:64
    v_mfma_f32_16x16x32_bf16 v[140:143], v[16:19], v[60:63], v[140:143]
    ds_read_b64 v[94:95], v220 offset:72
    s_waitcnt lgkmcnt(14)
    v_mfma_f32_16x16x32_bf16 v[140:143], v[28:31], v[48:51], v[140:143]
    v_mfma_f32_16x16x32_bf16 v[128:131], v[64:67], v[96:99], v[128:131]
    ds_read_b64 v[0:1], v220 offset:2048
    v_mfma_f32_16x16x32_bf16 v[132:135], v[64:67], v[100:103], v[132:135]
    ds_read_b64 v[2:3], v220 offset:2056
    v_mfma_f32_16x16x32_bf16 v[136:139], v[68:71], v[100:103], v[136:139]
    ds_read_b128 v[48:51], v221 offset:2496
    v_mfma_f32_16x16x32_bf16 v[132:135], v[68:71], v[96:99], v[132:135]
    ds_read_b64 v[4:5], v220 offset:1536
    v_mfma_f32_16x16x32_bf16 v[136:139], v[64:67], v[104:107], v[136:139]
    ds_read_b64 v[6:7], v220 offset:1544
    v_mfma_f32_16x16x32_bf16 v[140:143], v[68:71], v[104:107], v[140:143]
    ds_read_b128 v[44:47], v221 offset:1984
    v_mfma_f32_16x16x32_bf16 v[136:139], v[72:75], v[96:99], v[136:139]
    ds_read_b64 v[8:9], v220 offset:1024
    v_mfma_f32_16x16x32_bf16 v[140:143], v[72:75], v[100:103], v[140:143]
    ds_read_b64 v[10:11], v220 offset:1032
    s_waitcnt lgkmcnt(14)
    v_mfma_f32_16x16x32_bf16 v[128:131], v[80:83], v[112:115], v[128:131]
    ds_read_b128 v[52:55], v221 offset:3008
    v_mfma_f32_16x16x32_bf16 v[140:143], v[76:79], v[96:99], v[140:143]
    ds_read_b64 v[12:13], v220 offset:512
    v_mfma_f32_16x16x32_bf16 v[140:143], v[64:67], v[108:111], v[140:143]
    ds_read_b64 v[14:15], v220 offset:520
    v_mfma_f32_16x16x32_bf16 v[132:135], v[80:83], v[116:119], v[132:135]
    ds_read_b128 v[40:43], v221 offset:1472
    v_mfma_f32_16x16x32_bf16 v[136:139], v[84:87], v[116:119], v[136:139]
    ds_read_b64 v[16:17], v220 offset:0
    v_mfma_f32_16x16x32_bf16 v[132:135], v[84:87], v[112:115], v[132:135]
    ds_read_b64 v[18:19], v220 offset:8
    s_waitcnt lgkmcnt(14)
    v_mfma_f32_16x16x32_bf16 v[136:139], v[80:83], v[120:123], v[136:139]
    ds_read_b128 v[56:59], v221 offset:3520
    v_mfma_f32_16x16x32_bf16 v[140:143], v[84:87], v[120:123], v[140:143]
    ds_read_b128 v[36:39], v221 offset:960
    v_mfma_f32_16x16x32_bf16 v[136:139], v[88:91], v[112:115], v[136:139]
    ds_read_b128 v[60:63], v221 offset:4032
    v_mfma_f32_16x16x32_bf16 v[140:143], v[88:91], v[116:119], v[140:143]
    ds_read_b128 v[32:35], v221 offset:448
    v_mfma_f32_16x16x32_bf16 v[140:143], v[80:83], v[124:127], v[140:143]
    ds_read_b32 v251, v250
    v_mfma_f32_16x16x32_bf16 v[140:143], v[92:95], v[112:115], v[140:143]
    s_waitcnt lgkmcnt(14)
    v_mfma_f32_16x16x32_bf16 v[144:147], v[0:3], v[48:51], 0
    ds_read_b64 v[64:65], v220 offset:1984
    v_mfma_f32_16x16x32_bf16 v[148:151], v[4:7], v[48:51], 0
    ds_read_b64 v[66:67], v220 offset:1992
    s_waitcnt lgkmcnt(14)
    v_mfma_f32_16x16x32_bf16 v[144:147], v[4:7], v[44:47], v[144:147]
    ds_read_b128 v[112:115], v221 offset:2432
    s_waitcnt lgkmcnt(13)
    v_mfma_f32_16x16x32_bf16 v[148:151], v[0:3], v[52:55], v[148:151]
    ds_read_b64 v[68:69], v220 offset:1472
    v_mfma_f32_16x16x32_bf16 v[152:155], v[4:7], v[52:55], 0
    ds_read_b64 v[70:71], v220 offset:1480
    s_waitcnt lgkmcnt(5)
    v_cmp_gt_u32 vcc, 4, v251
    s_nop 0
    s_cbranch_vccz L_xc_ok
    s_mov_b32 s61, 3200000
L_spin_xc:
    ds_read_b32 v251, v250
    s_sub_u32 s61, s61, 1
    s_cmp_eq_u32 s61, 0
    s_cbranch_scc1 L_spun_xc
    s_waitcnt lgkmcnt(0)
    v_cmp_gt_u32 vcc, 4, v251
    s_nop 0
    s_cbranch_vccnz L_spin_xc
L_spun_xc:
    s_waitcnt lgkmcnt(0)
L_xc_ok:
    v_mfma_f32_16x16x32_bf16 v[148:151], v[8:11], v[44:47], v[148:151]
    ds_read_b128 v[108:111], v221 offset:1920
    v_cvt_pk_bf16_f32 v184, v128, v129
    v_mfma_f32_16x16x32_bf16 v[152:155], v[8:11], v[48:51], v[152:155]
    ds_read_b64 v[72:73], v220 offset:960
    v_cvt_pk_bf16_f32 v185, v130, v131
    v_mfma_f32_16x16x32_bf16 v[156:159], v[8:11], v[52:55], 0
    ds_read_b64 v[74:75], v220 offset:968
    ds_write_b64 v204, v[184:185] offset:0
    v_mfma_f32_16x16x32_bf16 v[144:147], v[8:11], v[40:43], v[144:147]
    ds_read_b128 v[116:119], v221 offset:2944
    v_cvt_pk_bf16_f32 v186, v132, v133
    v_mfma_f32_16x16x32_bf16 v[148:151], v[12:15], v[40:43], v[148:151]
    ds_read_b64 v[76:77], v220 offset:448
    v_cvt_pk_bf16_f32 v187, v134, v135
    v_mfma_f32_16x16x32_bf16 v[152:155], v[12:15], v[44:47], v[152:155]
    ds_read_b64 v[78:79], v220 offset:456
    ds_write_b64 v204, v[186:187] offset:512
    v_mfma_f32_16x16x32_bf16 v[156:159], v[12:15], v[48:51], v[156:159]
    ds_read_b128 v[104:107], v221 offset:1408
    v_cvt_pk_bf16_f32 v188, v136, v137
    v_mfma_f32_16x16x32_bf16 v[152:155], v[0:3], v[56:59], v[152:155]
    ds_read_b128 v[120:123], v221 offset:3456
    v_cvt_pk_bf16_f32 v189, v138, v139
    v_mfma_f32_16x16x32_bf16 v[156:159], v[4:7], v[56:59], v[156:159]
    ds_read_b128 v[100:103], v221 offset:896
    ds_write_b64 v204, v[188:189] offset:1024
    v_mfma_f32_16x16x32_bf16 v[152:155], v[16:19], v[40:43], v[152:155]
    ds_read_b128 v[124:127], v221 offset:3968
    v_cvt_pk_bf16_f32 v190, v140, v141
    v_mfma_f32_16x16x32_bf16 v[156:159], v[16:19], v[44:47], v[156:159]
    v_cvt_pk_bf16_f32 v191, v142, v143
    v_mfma_f32_16x16x32_bf16 v[144:147], v[12:15], v[36:39], v[144:147]
    ds_write_b64 v204, v[190:191] offset:1536
    v_mfma_f32_16x16x32_bf16 v[148:151], v[16:19], v[36:39], v[148:151]
    v_mov_b32 v192, 163768
    v_mov_b32 v193, 1
    s_mov_b64 exec, 1
    ds_add_u32 v192, v193
    s_mov_b64 exec, -1
    v_mfma_f32_16x16x32_bf16 v[156:159], v[0:3], v[60:63], v[156:159]
    v_mfma_f32_16x16x32_bf16 v[144:147], v[16:19], v[32:35], v[144:147]
    s_waitcnt lgkmcnt(14)
    v_mfma_f32_16x16x32_bf16 v[144:147], v[64:67], v[112:115], v[144:147]
    ds_read_b64 v[0:1], v220 offset:1920
    v_mfma_f32_16x16x32_bf16 v[148:151], v[68:71], v[112:115], v[148:151]
    ds_read_b64 v[2:3], v220 offset:1928
    v_mfma_f32_16x16x32_bf16 v[144:147], v[68:71], v[108:111], v[144:147]
    ds_read_b128 v[48:51], v221 offset:2368
    s_waitcnt lgkmcnt(13)
    v_mfma_f32_16x16x32_bf16 v[148:151], v[64:67], v[116:119], v[148:151]
    ds_read_b64 v[4:5], v220 offset:1408
    v_mfma_f32_16x16x32_bf16 v[152:155], v[68:71], v[116:119], v[152:155]
    ds_read_b64 v[6:7], v220 offset:1416
    v_mfma_f32_16x16x32_bf16 v[148:151], v[72:75], v[108:111], v[148:151]
    ds_read_b128 v[44:47], v221 offset:1856
    v_mfma_f32_16x16x32_bf16 v[152:155], v[72:75], v[112:115], v[152:155]
    ds_read_b64 v[8:9], v220 offset:896
    v_mfma_f32_16x16x32_bf16 v[156:159], v[72:75], v[116:119], v[156:159]
    ds_read_b64 v[10:11], v220 offset:904
    s_waitcnt lgkmcnt(14)
    v_mfma_f32_16x16x32_bf16 v[144:147], v[72:75], v[104:107], v[144:147]
    ds_read_b128 v[52:55], v221 offset:2880
    v_mfma_f32_16x16x32_bf16 v[148:151], v[76:79], v[104:107], v[148:151]
    ds_read_b64 v[12:13], v220 offset:384
    v_mfma_f32_16x16x32_bf16 v[152:155], v[76:79], v[108:111], v[152:155]
    ds_read_b64 v[14:15], v220 offset:392
    v_mfma_f32_16x16x32_bf16 v[156:159], v[76:79], v[112:115], v[156:159]
    ds_read_b128 v[40:43], v221 offset:1344
    s_waitcnt lgkmcnt(14)
    v_mfma_f32_16x16x32_bf16 v[152:155], v[64:67], v[120:123], v[152:155]
    ds_read_b128 v[56:59], v221 offset:3392
    v_mfma_f32_16x16x32_bf16 v[156:159], v[68:71], v[120:123], v[156:159]
    ds_read_b128 v[36:39], v221 offset:832
    v_mfma_f32_16x16x32_bf16 v[144:147], v[76:79], v[100:103], v[144:147]
    ds_read_b128 v[60:63], v221 offset:3904
    v_mfma_f32_16x16x32_bf16 v[156:159], v[64:67], v[124:127], v[156:159]
    s_waitcnt lgkmcnt(12)
    v_mfma_f32_16x16x32_bf16 v[144:147], v[0:3], v[48:51], v[144:147]
    ds_read_b64 v[64:65], v220 offset:1856
    s_waitcnt lgkmcnt(11)
    v_mfma_f32_16x16x32_bf16 v[148:151], v[4:7], v[48:51], v[148:151]
    ds_read_b64 v[66:67], v220 offset:1864
    s_waitcnt lgkmcnt(11)
    v_mfma_f32_16x16x32_bf16 v[144:147], v[4:7], v[44:47], v[144:147]
    ds_read_b128 v[112:115], v221 offset:2304
    s_waitcnt lgkmcnt(9)
    v_mfma_f32_16x16x32_bf16 v[148:151], v[0:3], v[52:55], v[148:151]
    ds_read_b64 v[68:69], v220 offset:1344
    v_mfma_f32_16x16x32_bf16 v[152:155], v[4:7], v[52:55], v[152:155]
    ds_read_b64 v[70:71], v220 offset:1352
    v_mfma_f32_16x16x32_bf16 v[148:151], v[8:11], v[44:47], v[148:151]
    ds_read_b128 v[108:111], v221 offset:1792
    v_mfma_f32_16x16x32_bf16 v[152:155], v[8:11], v[48:51], v[152:155]
    ds_read_b64 v[72:73], v220 offset:832
    v_mfma_f32_16x16x32_bf16 v[156:159], v[8:11], v[52:55], v[156:159]
    ds_read_b64 v[74:75], v220 offset:840
    s_waitcnt lgkmcnt(11)
    v_mfma_f32_16x16x32_bf16 v[144:147], v[8:11], v[40:43], v[144:147]
    ds_read_b128 v[116:119], v221 offset:2816
    v_mfma_f32_16x16x32_bf16 v[148:151], v[12:15], v[40:43], v[148:151]
    ds_read_b64 v[76:77], v220 offset:320
    v_mfma_f32_16x16x32_bf16 v[152:155], v[12:15], v[44:47], v[152:155]
    ds_read_b64 v[78:79], v220 offset:328
    v_mfma_f32_16x16x32_bf16 v[156:159], v[12:15], v[48:51], v[156:159]
    ds_read_b128 v[104:107], v221 offset:1280
    s_waitcnt lgkmcnt(14)
    v_mfma_f32_16x16x32_bf16 v[152:155], v[0:3], v[56:59], v[152:155]
    ds_read_b128 v[120:123], v221 offset:3328
    v_mfma_f32_16x16x32_bf16 v[156:159], v[4:7], v[56:59], v[156:159]
    ds_read_b128 v[100:103], v221 offset:768
    s_waitcnt lgkmcnt(14)
    v_mfma_f32_16x16x32_bf16 v[144:147], v[12:15], v[36:39], v[144:147]
    ds_read_b128 v[124:127], v221 offset:3840
    v_mfma_f32_16x16x32_bf16 v[156:159], v[0:3], v[60:63], v[156:159]
    s_waitcnt lgkmcnt(12)
    v_mfma_f32_16x16x32_bf16 v[144:147], v[64:67], v[112:115], v[144:147]
    ds_read_b64 v[0:1], v220 offset:1792
    s_waitcnt lgkmcnt(11)
    v_mfma_f32_16x16x32_bf16 v[148:151], v[68:71], v[112:115], v[148:151]
    ds_read_b64 v[2:3], v220 offset:1800
    s_waitcnt lgkmcnt(11)
    v_mfma_f32_16x16x32_bf16 v[144:147], v[68:71], v[108:111], v[144:147]
    ds_read_b128 v[48:51], v221 offset:2240
    s_waitcnt lgkmcnt(9)
    v_mfma_f32_16x16x32_bf16 v[148:151], v[64:67], v[116:119], v[148:151]
    ds_read_b64 v[4:5], v220 offset:1280
    v_mfma_f32_16x16x32_bf16 v[152:155], v[68:71], v[116:119], v[152:155]
    ds_read_b64 v[6:7], v220 offset:1288
    v_mfma_f32_16x16x32_bf16 v[148:151], v[72:75], v[108:111], v[148:151]
    ds_read_b128 v[44:47], v221 offset:1728
    v_mfma_f32_16x16x32_bf16 v[152:155], v[72:75], v[112:115], v[152:155]
    ds_read_b64 v[8:9], v220 offset:768
    v_mfma_f32_16x16x32_bf16 v[156:159], v[72:75], v[116:119], v[156:159]
    ds_read_b64 v[10:11], v220 offset:776
    s_waitcnt lgkmcnt(11)
    v_mfma_f32_16x16x32_bf16 v[144:147], v[72:75], v[104:107], v[144:147]
    ds_read_b128 v[52:55], v221 offset:2752
    v_mfma_f32_16x16x32_bf16 v[148:151], v[76:79], v[104:107], v[148:151]
    ds_read_b64 v[12:13], v220 offset:256
    v_mfma_f32_16x16x32_bf16 v[152:155], v[76:79], v[108:111], v[152:155]
    ds_read_b64 v[14:15], v220 offset:264
    v_mfma_f32_16x16x32_bf16 v[156:159], v[76:79], v[112:115], v[156:159]
    ds_read_b128 v[40:43], v221 offset:1216
    s_waitcnt lgkmcnt(14)
    v_mfma_f32_16x16x32_bf16 v[152:155], v[64:67], v[120:123], v[152:155]
    ds_read_b128 v[56:59], v221 offset:3264
    v_mfma_f32_16x16x32_bf16 v[156:159], v[68:71], v[120:123], v[156:159]
    ds_read_b128 v[36:39], v221 offset:704
    s_waitcnt lgkmcnt(14)
    v_mfma_f32_16x16x32_bf16 v[144:147], v[76:79], v[100:103], v[144:147]
    ds_read_b128 v[60:63], v221 offset:3776
    v_mfma_f32_16x16x32_bf16 v[156:159], v[64:67], v[124:127], v[156:159]
    s_waitcnt lgkmcnt(12)
    v_mfma_f32_16x16x32_bf16 v[144:147], v[0:3], v[48:51], v[144:147]
    ds_read_b64 v[64:65], v220 offset:1728
    s_waitcnt lgkmcnt(11)
    v_mfma_f32_16x16x32_bf16 v[148:151], v[4:7], v[48:51], v[148:151]
    ds_read_b64 v[66:67], v220 offset:1736
    s_waitcnt lgkmcnt(11)
    v_mfma_f32_16x16x32_bf16 v[144:147], v[4:7], v[44:47], v[144:147]
    ds_read_b128 v[112:115], v221 offset:2176
    s_waitcnt lgkmcnt(9)
    v_mfma_f32_16x16x32_bf16 v[148:151], v[0:3], v[52:55], v[148:151]
    ds_read_b64 v[68:69], v220 offset:1216
    v_mfma_f32_16x16x32_bf16 v[152:155], v[4:7], v[52:55], v[152:155]
    ds_read_b64 v[70:71], v220 offset:1224
    v_mfma_f32_16x16x32_bf16 v[148:151], v[8:11], v[44:47], v[148:151]
    ds_read_b128 v[108:111], v221 offset:1664
    v_mfma_f32_16x16x32_bf16 v[152:155], v[8:11], v[48:51], v[152:155]
    ds_read_b64 v[72:73], v220 offset:704
    v_mfma_f32_16x16x32_bf16 v[156:159], v[8:11], v[52:55], v[156:159]
    ds_read_b64 v[74:75], v220 offset:712
    s_waitcnt lgkmcnt(11)
    v_mfma_f32_16x16x32_bf16 v[144:147], v[8:11], v[40:43], v[144:147]
    ds_read_b128 v[116:119], v221 offset:2688
    v_mfma_f32_16x16x32_bf16 v[148:151], v[12:15], v[40:43], v[148:151]
    ds_read_b64 v[76:77], v220 offset:192
    v_mfma_f32_16x16x32_bf16 v[152:155], v[12:15], v[44:47], v[152:155]
    ds_read_b64 v[78:79], v220 offset:200
    v_mfma_f32_16x16x32_bf16 v[156:159], v[12:15], v[48:51], v[156:159]
    ds_read_b128 v[104:107], v221 offset:1152
    s_waitcnt lgkmcnt(14)
    v_mfma_f32_16x16x32_bf16 v[152:155], v[0:3], v[56:59], v[152:155]
    ds_read_b128 v[120:123], v221 offset:3200
    v_mfma_f32_16x16x32_bf16 v[156:159], v[4:7], v[56:59], v[156:159]
    ds_read_b128 v[100:103], v221 offset:640
    s_waitcnt lgkmcnt(14)
    v_mfma_f32_16x16x32_bf16 v[144:147], v[12:15], v[36:39], v[144:147]
    ds_read_b128 v[124:127], v221 offset:3712
    v_mfma_f32_16x16x32_bf16 v[156:159], v[0:3], v[60:63], v[156:159]
    s_waitcnt lgkmcnt(12)
    v_mfma_f32_16x16x32_bf16 v[144:147], v[64:67], v[112:115], v[144:147]
    ds_read_b64 v[0:1], v220 offset:1664
    s_waitcnt lgkmcnt(11)
    v_mfma_f32_16x16x32_bf16 v[148:151], v[68:71], v[112:115], v[148:151]
    ds_read_b64 v[2:3], v220 offset:1672
    s_waitcnt lgkmcnt(11)
    v_mfma_f32_16x16x32_bf16 v[144:147], v[68:71], v[108:111], v[144:147]
    ds_read_b128 v[48:51], v221 offset:2112
    s_waitcnt lgkmcnt(9)
    v_mfma_f32_16x16x32_bf16 v[148:151], v[64:67], v[116:119], v[148:151]
    ds_read_b64 v[4:5], v220 offset:1152
    v_mfma_f32_16x16x32_bf16 v[152:155], v[68:71], v[116:119], v[152:155]
    ds_read_b64 v[6:7], v220 offset:1160
    v_mfma_f32_16x16x32_bf16 v[148:151], v[72:75], v[108:111], v[148:151]
    ds_read_b128 v[44:47], v221 offset:1600
    v_mfma_f32_16x16x32_bf16 v[152:155], v[72:75], v[112:115], v[152:155]
    ds_read_b64 v[8:9], v220 offset:640
    v_mfma_f32_16x16x32_bf16 v[156:159], v[72:75], v[116:119], v[156:159]
    ds_read_b64 v[10:11], v220 offset:648
    s_waitcnt lgkmcnt(11)
    v_mfma_f32_16x16x32_bf16 v[144:147], v[72:75], v[104:107], v[144:147]
    ds_read_b128 v[52:55], v221 offset:2624
    v_mfma_f32_16x16x32_bf16 v[148:151], v[76:79], v[104:107], v[148:151]
    ds_read_b64 v[12:13], v220 offset:128
    v_mfma_f32_16x16x32_bf16 v[152:155], v[76:79], v[108:111], v[152:155]
    ds_read_b64 v[14:15], v220 offset:136
    v_mfma_f32_16x16x32_bf16 v[156:159], v[76:79], v[112:115], v[156:159]
    ds_read_b128 v[40:43], v221 offset:1088
    s_waitcnt lgkmcnt(14)
    v_mfma_f32_16x16x32_bf16 v[152:155], v[64:67], v[120:123], v[152:155]
    ds_read_b128 v[56:59], v221 offset:3136
    v_mfma_f32_16x16x32_bf16 v[156:159], v[68:71], v[120:123], v[156:159]
    ds_read_b128 v[36:39], v221 offset:576
    s_waitcnt lgkmcnt(14)
    v_mfma_f32_16x16x32_bf16 v[144:147], v[76:79], v[100:103], v[144:147]
    ds_read_b128 v[60:63], v221 offset:3648
    v_mfma_f32_16x16x32_bf16 v[156:159], v[64:67], v[124:127], v[156:159]
    s_waitcnt lgkmcnt(12)
    v_mfma_f32_16x16x32_bf16 v[144:147], v[0:3], v[48:51], v[144:147]
    ds_read_b64 v[64:65], v220 offset:1600
    s_waitcnt lgkmcnt(11)
    v_mfma_f32_16x16x32_bf16 v[148:151], v[4:7], v[48:51], v[148:151]
    ds_read_b64 v[66:67], v220 offset:1608
    s_waitcnt lgkmcnt(11)
    v_mfma_f32_16x16x32_bf16 v[144:147], v[4:7], v[44:47], v[144:147]
    ds_read_b128 v[112:115], v221 offset:2048
    s_waitcnt lgkmcnt(9)
    v_mfma_f32_16x16x32_bf16 v[148:151], v[0:3], v[52:55], v[148:151]
    ds_read_b64 v[68:69], v220 offset:1088
    v_mfma_f32_16x16x32_bf16 v[152:155], v[4:7], v[52:55], v[152:155]
    ds_read_b64 v[70:71], v220 offset:1096
    v_mfma_f32_16x16x32_bf16 v[148:151], v[8:11], v[44:47], v[148:151]
    ds_read_b128 v[108:111], v221 offset:1536
    v_mfma_f32_16x16x32_bf16 v[152:155], v[8:11], v[48:51], v[152:155]
    ds_read_b64 v[72:73], v220 offset:576
    v_mfma_f32_16x16x32_bf16 v[156:159], v[8:11], v[52:55], v[156:159]
    ds_read_b64 v[74:75], v220 offset:584
    s_waitcnt lgkmcnt(11)
    v_mfma_f32_16x16x32_bf16 v[144:147], v[8:11], v[40:43], v[144:147]
    ds_read_b128 v[116:119], v221 offset:2560
    v_mfma_f32_16x16x32_bf16 v[148:151], v[12:15], v[40:43], v[148:151]
    ds_read_b64 v[76:77], v220 offset:64
    v_mfma_f32_16x16x32_bf16 v[152:155], v[12:15], v[44:47], v[152:155]
    ds_read_b64 v[78:79], v220 offset:72
    v_mfma_f32_16x16x32_bf16 v[156:159], v[12:15], v[48:51], v[156:159]
    ds_read_b128 v[104:107], v221 offset:1024
    s_waitcnt lgkmcnt(14)
    v_mfma_f32_16x16x32_bf16 v[152:155], v[0:3], v[56:59], v[152:155]
    ds_read_b128 v[120:123], v221 offset:3072
    v_mfma_f32_16x16x32_bf16 v[156:159], v[4:7], v[56:59], v[156:159]
    ds_read_b128 v[100:103], v221 offset:512
    s_waitcnt lgkmcnt(14)
    v_mfma_f32_16x16x32_bf16 v[144:147], v[12:15], v[36:39], v[144:147]
    ds_read_b128 v[124:127], v221 offset:3584
    v_mfma_f32_16x16x32_bf16 v[156:159], v[0:3], v[60:63], v[156:159]
    s_waitcnt lgkmcnt(12)
    v_mfma_f32_16x16x32_bf16 v[144:147], v[64:67], v[112:115], v[144:147]
    ds_read_b128 v[0:3], v222 offset:0
    ds_read_b128 v[4:7], v222 offset:128
    s_waitcnt lgkmcnt(12)
    v_mfma_f32_16x16x32_bf16 v[148:151], v[68:71], v[112:115], v[148:151]
    ds_read_b128 v[8:11], v222 offset:1024
    ds_read_b128 v[12:15], v222 offset:1152
    s_waitcnt lgkmcnt(13)
    v_mfma_f32_16x16x32_bf16 v[144:147], v[68:71], v[108:111], v[144:147]
    ds_read_b128 v[16:19], v222 offset:16
    ds_read_b128 v[20:23], v222 offset:144
    s_waitcnt lgkmcnt(12)
    v_mfma_f32_16x16x32_bf16 v[148:151], v[64:67], v[116:119], v[148:151]
    ds_read_b128 v[24:27], v222 offset:1040
    ds_read_b128 v[28:31], v222 offset:1168
    v_mfma_f32_16x16x32_bf16 v[152:155], v[68:71], v[116:119], v[152:155]
    ds_read2_b32 v[32:33], v223 offset0:24 offset1:25
    ds_read2_b32 v[34:35], v223 offset0:26 offset1:27
    v_mfma_f32_16x16x32_bf16 v[148:151], v[72:75], v[108:111], v[148:151]
    ds_read2_b32 v[36:37], v223 offset0:16 offset1:17
    ds_read2_b32 v[38:39], v223 offset0:18 offset1:19
    v_mfma_f32_16x16x32_bf16 v[152:155], v[72:75], v[112:115], v[152:155]
    ds_read2_b32 v[40:41], v223 offset0:8 offset1:9
    ds_read2_b32 v[42:43], v223 offset0:10 offset1:11
    v_mfma_f32_16x16x32_bf16 v[156:159], v[72:75], v[116:119], v[156:159]
    ds_read2_b32 v[44:45], v223 offset0:0 offset1:1
    ds_read2_b32 v[46:47], v223 offset0:2 offset1:3
    s_waitcnt lgkmcnt(14)
    v_mfma_f32_16x16x32_bf16 v[144:147], v[72:75], v[104:107], v[144:147]
    ds_read2_b32 v[48:49], v223 offset0:120 offset1:121
    ds_read2_b32 v[50:51], v223 offset0:122 offset1:123
    v_mfma_f32_16x16x32_bf16 v[148:151], v[76:79], v[104:107], v[148:151]
    ds_read2_b32 v[52:53], v223 offset0:112 offset1:113
    v_mfma_f32_16x16x32_bf16 v[152:155], v[76:79], v[108:111], v[152:155]
    ds_read2_b32 v[54:55], v223 offset0:114 offset1:115
    v_mfma_f32_16x16x32_bf16 v[156:159], v[76:79], v[112:115], v[156:159]
    ds_read2_b32 v[56:57], v223 offset0:104 offset1:105
    v_mfma_f32_16x16x32_bf16 v[152:155], v[64:67], v[120:123], v[152:155]
    ds_read2_b32 v[58:59], v223 offset0:106 offset1:107
    v_mfma_f32_16x16x32_bf16 v[156:159], v[68:71], v[120:123], v[156:159]
    ds_read2_b32 v[60:61], v223 offset0:96 offset1:97
    v_mfma_f32_16x16x32_bf16 v[144:147], v[76:79], v[100:103], v[144:147]
    ds_read2_b32 v[62:63], v223 offset0:98 offset1:99
    v_mfma_f32_16x16x32_bf16 v[156:159], v[64:67], v[124:127], v[156:159]
    v_mfma_f32_16x16x32_bf16 v[64:67], v[0:3], v[228:231], 0
    v_mfma_f32_16x16x32_bf16 v[68:71], v[4:7], v[228:231], 0
    s_waitcnt lgkmcnt(14)
    v_mfma_f32_16x16x32_bf16 v[72:75], v[8:11], v[228:231], 0
    v_mfma_f32_16x16x32_bf16 v[76:79], v[12:15], v[228:231], 0
    v_mfma_f32_16x16x32_bf16 v[80:83], v[16:19], v[232:235], 0
    v_mfma_f32_16x16x32_bf16 v[84:87], v[20:23], v[232:235], 0
    v_mfma_f32_16x16x32_bf16 v[88:91], v[24:27], v[232:235], 0
    v_mfma_f32_16x16x32_bf16 v[92:95], v[28:31], v[232:235], 0
    v_mov_b32 v194, 163772
    v_mov_b32 v195, 1
    s_mov_b64 exec, 1
    ds_add_u32 v194, v195
    s_mov_b64 exec, -1
    v_cvt_pk_bf16_f32 v96, v64, v65
    v_cvt_pk_bf16_f32 v97, v66, v67
    v_cvt_pk_bf16_f32 v98, v68, v69
    v_cvt_pk_bf16_f32 v99, v70, v71
    v_cvt_pk_bf16_f32 v100, v72, v73
    v_cvt_pk_bf16_f32 v101, v74, v75
    v_cvt_pk_bf16_f32 v102, v76, v77
    v_cvt_pk_bf16_f32 v103, v78, v79
    v_cvt_pk_bf16_f32 v104, v80, v81
    v_cvt_pk_bf16_f32 v105, v82, v83
    v_cvt_pk_bf16_f32 v106, v84, v85
    v_cvt_pk_bf16_f32 v107, v86, v87
    v_cvt_pk_bf16_f32 v108, v88, v89
    v_cvt_pk_bf16_f32 v109, v90, v91
    v_cvt_pk_bf16_f32 v110, v92, v93
    v_cvt_pk_bf16_f32 v111, v94, v95
    v_mfma_f32_16x16x32_bf16 v[144:147], v[96:99], v[32:35], v[144:147]
    s_waitcnt lgkmcnt(13)
    v_mfma_f32_16x16x32_bf16 v[148:151], v[96:99], v[36:39], v[148:151]
    s_waitcnt lgkmcnt(11)
    v_mfma_f32_16x16x32_bf16 v[152:155], v[96:99], v[40:43], v[152:155]
    s_waitcnt lgkmcnt(9)
    v_mfma_f32_16x16x32_bf16 v[156:159], v[96:99], v[44:47], v[156:159]
    v_mfma_f32_16x16x32_bf16 v[152:155], v[100:103], v[32:35], v[152:155]
    v_mfma_f32_16x16x32_bf16 v[156:159], v[100:103], v[36:39], v[156:159]
    s_waitcnt lgkmcnt(7)
    v_mfma_f32_16x16x32_bf16 v[144:147], v[104:107], v[48:51], v[144:147]
    s_waitcnt lgkmcnt(5)
    v_mfma_f32_16x16x32_bf16 v[148:151], v[104:107], v[52:55], v[148:151]
    s_waitcnt lgkmcnt(3)
    v_mfma_f32_16x16x32_bf16 v[152:155], v[104:107], v[56:59], v[152:155]
    s_waitcnt lgkmcnt(1)
    v_mfma_f32_16x16x32_bf16 v[156:159], v[104:107], v[60:63], v[156:159]
    v_mfma_f32_16x16x32_bf16 v[152:155], v[108:111], v[48:51], v[152:155]
    v_mfma_f32_16x16x32_bf16 v[156:159], v[108:111], v[52:55], v[156:159]
    v_cvt_pk_bf16_f32 v184, v144, v145
    v_cvt_pk_bf16_f32 v185, v146, v147
    ds_write_b64 v224, v[184:185] offset:0
    v_cvt_pk_bf16_f32 v186, v148, v149
    v_cvt_pk_bf16_f32 v187, v150, v151
    ds_write_b64 v224, v[186:187] offset:512
    s_nop 0
    v_cvt_pk_bf16_f32 v188, v152, v153
    v_cvt_pk_bf16_f32 v189, v154, v155
    ds_write_b64 v224, v[188:189] offset:1024
    v_cvt_pk_bf16_f32 v190, v156, v157
    v_cvt_pk_bf16_f32 v191, v158, v159
    ds_write_b64 v224, v[190:191] offset:1536
    v_mov_b32 v192, 163764
    v_mov_b32 v193, 1
    s_mov_b64 exec, 1
    ds_add_u32 v192, v193
    s_mov_b64 exec, -1
    s_setprio 0
    s_mov_b32 s61, 3200000
L_spin_y:
    ds_read_b32 v193, v192
    s_sub_u32 s61, s61, 1
    s_cmp_eq_u32 s61, 0
    s_cbranch_scc1 L_spun_y
    s_waitcnt lgkmcnt(0)
    v_cmp_gt_u32 vcc, 4, v193
    s_nop 0
    s_cbranch_vccnz L_spin_y
L_spun_y:
    s_waitcnt lgkmcnt(0)
    v_mov_b32 v192, 163796
    s_mov_b32 s61, 3200000
L_spin_ol:
    ds_read_b32 v193, v192
    s_sub_u32 s61, s61, 1
    s_cmp_eq_u32 s61, 0
    s_cbranch_scc1 L_spun_ol
    s_waitcnt lgkmcnt(0)
    v_cmp_gt_u32 vcc, 4, v193
    s_nop 0
    s_cbranch_vccnz L_spin_ol
L_spun_ol:
    s_waitcnt lgkmcnt(0)
    ds_read_b64 v[16:17], v225 offset:0
    ds_read_b64 v[18:19], v225 offset:4608
    ds_read_b64 v[20:21], v225 offset:9216
    ds_read_b64 v[22:23], v225 offset:13824
    s_mov_b32 s72, 0x05040100
    s_mov_b32 s73, 0x07060302
    v_add_u32 v32, 4608, v226
    s_waitcnt lgkmcnt(0)
    v_perm_b32 v24, v18, v16, s72
    v_perm_b32 v25, v22, v20, s72
    v_perm_b32 v26, v18, v16, s73
    v_perm_b32 v27, v22, v20, s73
    v_perm_b32 v28, v19, v17, s72
    v_perm_b32 v29, v23, v21, s72
    v_perm_b32 v30, v19, v17, s73
    v_perm_b32 v31, v23, v21, s73
    global_store_dwordx2 v226, v[24:25], s[32:33] offset:0
    global_store_dwordx2 v226, v[26:27], s[32:33] offset:2304
    global_store_dwordx2 v32, v[28:29], s[32:33] offset:0
    global_store_dwordx2 v32, v[30:31], s[32:33] offset:2304
    s_branch L_end_tail
L_t_pub:
    s_setprio 3
    s_lshl_b32 s62, s57, 4
    s_add_u32 s62, s62, s56
    s_lshl_b32 s62, s62, 5
    s_add_u32 s62, s62, 425984
    s_waitcnt vmcnt(0)
    v_mov_b32 v250, 0
    v_mov_b32 v251, 1
    s_mov_b64 exec, 1
    buffer_store_dword v251, v250, s[52:55], s62 offen sc1
    s_mov_b64 exec, -1
L_t_p3:
    ds_read_b64_tr_b16 v[120:121], v160 offset:0
    ds_read_b64_tr_b16 v[122:123], v160 offset:512
    ds_read_b64_tr_b16 v[124:125], v161 offset:0
    ds_read_b64_tr_b16 v[126:127], v161 offset:512
    ds_read_b64_tr_b16 v[128:129], v160 offset:2048
    ds_read_b64_tr_b16 v[130:131], v160 offset:2560
    ds_read_b64_tr_b16 v[132:133], v161 offset:2048
    ds_read_b64_tr_b16 v[134:135], v161 offset:2560
    ds_read_b64_tr_b16 v[136:137], v160 offset:4096
    ds_read_b64_tr_b16 v[138:139], v160 offset:4608
    ds_read_b64_tr_b16 v[140:141], v161 offset:4096
    ds_read_b64_tr_b16 v[142:143], v161 offset:4608
    s_mov_b32 s63, s41
    v_mov_b32 v18, 163768
    s_mov_b32 s60, 400000
L_t_loop:
    buffer_load_dword v15, v177, s[52:55], s12 offen sc1
    ds_read_b32 v19, v18
    s_sub_u32 s60, s60, 1
    s_cmp_eq_u32 s60, 0
    s_cbranch_scc1 L_t_ready
    s_waitcnt vmcnt(0) lgkmcnt(0)
    v_cmp_ne_u32 vcc, 1, v15
    s_nop 0
    s_cbranch_vccz L_t_ready
    s_cmp_eq_u32 s63, 0
    s_cbranch_scc1 L_t_loop
    v_cmp_gt_u32 vcc, 4, v19
    s_nop 0
    s_cbranch_vccnz L_t_loop
    s_mov_b32 s63, 0
    ds_read_b64 v[20:21], v178 offset:0
    ds_read_b64 v[22:23], v178 offset:6144
    ds_read_b64 v[24:25], v178 offset:12288
    ds_read_b64 v[26:27], v178 offset:18432
    s_mov_b32 s72, 0x05040100
    s_mov_b32 s73, 0x07060302
    v_add_u32 v36, 4608, v179
    s_waitcnt lgkmcnt(0)
    v_perm_b32 v28, v22, v20, s72
    v_perm_b32 v29, v26, v24, s72
    v_perm_b32 v30, v22, v20, s73
    v_perm_b32 v31, v26, v24, s73
    v_perm_b32 v32, v23, v21, s72
    v_perm_b32 v33, v27, v25, s72
    v_perm_b32 v34, v23, v21, s73
    v_perm_b32 v35, v27, v25, s73
    global_store_dwordx2 v179, v[28:29], s[32:33] offset:0
    s_mov_b32 s63, 2
    buffer_load_dword v15, v177, s[52:55], s12 offen sc1
    s_waitcnt vmcnt(0)
    v_cmp_ne_u32 vcc, 1, v15
    s_nop 0
    s_cbranch_vccz L_t_ready
    global_store_dwordx2 v179, v[30:31], s[32:33] offset:2304
    s_mov_b32 s63, 3
    buffer_load_dword v15, v177, s[52:55], s12 offen sc1
    s_waitcnt vmcnt(0)
    v_cmp_ne_u32 vcc, 1, v15
    s_nop 0
    s_cbranch_vccz L_t_ready
    global_store_dwordx2 v36, v[32:33], s[32:33] offset:0
    s_mov_b32 s63, 4
    buffer_load_dword v15, v177, s[52:55], s12 offen sc1
    s_waitcnt vmcnt(0)
    v_cmp_ne_u32 vcc, 1, v15
    s_nop 0
    s_cbranch_vccz L_t_ready
    global_store_dwordx2 v36, v[34:35], s[32:33] offset:2304
    s_mov_b32 s63, 0
    buffer_load_dword v15, v177, s[52:55], s12 offen sc1
    s_waitcnt vmcnt(0)
    v_cmp_ne_u32 vcc, 1, v15
    s_nop 0
    s_cbranch_vccz L_t_ready
    s_branch L_t_loop
L_t_ready:
    s_mov_b32 s64, s10
    buffer_load_dwordx4 v[48:51], v164, s[52:55], s64 offen offset:0 sc1
    buffer_load_dwordx4 v[52:55], v164, s[52:55], s64 offen offset:1024 sc1
    buffer_load_dwordx4 v[56:59], v164, s[52:55], s64 offen offset:2048 sc1
    buffer_load_dwordx4 v[60:63], v164, s[52:55], s64 offen offset:3072 sc1
    s_add_u32 s64, s64, 4096
    buffer_load_dwordx4 v[64:67], v164, s[52:55], s64 offen offset:0 sc1
    buffer_load_dwordx4 v[68:71], v164, s[52:55], s64 offen offset:1024 sc1
    buffer_load_dwordx4 v[72:75], v164, s[52:55], s64 offen offset:2048 sc1
    buffer_load_dwordx4 v[76:79], v164, s[52:55], s64 offen offset:3072 sc1
    s_add_u32 s64, s64, 4096
    buffer_load_dwordx4 v[80:83], v164, s[52:55], s64 offen offset:0 sc1
    buffer_load_dwordx4 v[84:87], v164, s[52:55], s64 offen offset:1024 sc1
    buffer_load_dwordx4 v[88:91], v164, s[52:55], s64 offen offset:2048 sc1
    buffer_load_dwordx4 v[92:95], v164, s[52:55], s64 offen offset:3072 sc1
    s_add_u32 s64, s64, 4096
    buffer_load_dwordx4 v[96:99], v164, s[52:55], s64 offen offset:0 sc1
    buffer_load_dwordx4 v[100:103], v164, s[52:55], s64 offen offset:1024 sc1
    buffer_load_dwordx4 v[104:107], v164, s[52:55], s64 offen offset:2048 sc1
    buffer_load_dwordx4 v[108:111], v164, s[52:55], s64 offen offset:3072 sc1
    buffer_load_dword v112, v174, s[52:55], s11 offen offset:0 sc1
    buffer_load_dword v113, v174, s[52:55], s11 offen offset:128 sc1
    buffer_load_dword v114, v174, s[52:55], s11 offen offset:256 sc1
    buffer_load_dword v115, v174, s[52:55], s11 offen offset:384 sc1
    buffer_load_dword v116, v174, s[52:55], s11 offen offset:1024 sc1
    buffer_load_dword v117, v174, s[52:55], s11 offen offset:1152 sc1
    buffer_load_dword v118, v174, s[52:55], s11 offen offset:1280 sc1
    buffer_load_dword v119, v174, s[52:55], s11 offen offset:1408 sc1
    v_mov_b32 v11, 1
    s_cmp_eq_u32 s41, 0
    s_cbranch_scc1 L_t_plain
    s_waitcnt vmcnt(0)
    v_mov_b32 v12, 163796
    v_mov_b32 v13, 1
    s_mov_b64 exec, 1
    ds_add_u32 v12, v13
    s_mov_b64 exec, -1
    s_cmp_eq_u32 s63, 0
    s_cbranch_scc1 L_t_odone
    s_cmp_eq_u32 s63, 2
    s_cbranch_scc1 L_t_yp1
    s_cmp_eq_u32 s63, 3
    s_cbranch_scc1 L_t_yp2
    s_cmp_eq_u32 s63, 4
    s_cbranch_scc1 L_t_yp3
    s_mov_b32 s61, 3200000
L_spin_y1b:
    ds_read_b32 v19, v18
    s_sub_u32 s61, s61, 1
    s_cmp_eq_u32 s61, 0
    s_cbranch_scc1 L_spun_y1b
    s_waitcnt lgkmcnt(0)
    v_cmp_gt_u32 vcc, 4, v19
    s_nop 0
    s_cbranch_vccnz L_spin_y1b
L_spun_y1b:
    s_waitcnt lgkmcnt(0)
    ds_read_b64 v[20:21], v178 offset:0
    ds_read_b64 v[22:23], v178 offset:6144
    ds_read_b64 v[24:25], v178 offset:12288
    ds_read_b64 v[26:27], v178 offset:18432
    s_mov_b32 s72, 0x05040100
    s_mov_b32 s73, 0x07060302
    v_add_u32 v36, 4608, v179
    s_waitcnt lgkmcnt(0)
    v_perm_b32 v28, v22, v20, s72
    v_perm_b32 v29, v26, v24, s72
    v_perm_b32 v30, v22, v20, s73
    v_perm_b32 v31, v26, v24, s73
    v_perm_b32 v32, v23, v21, s72
    v_perm_b32 v33, v27, v25, s72
    v_perm_b32 v34, v23, v21, s73
    v_perm_b32 v35, v27, v25, s73
    global_store_dwordx2 v179, v[28:29], s[32:33] offset:0
L_t_yp1:
    global_store_dwordx2 v179, v[30:31], s[32:33] offset:2304
L_t_yp2:
    global_store_dwordx2 v36, v[32:33], s[32:33] offset:0
L_t_yp3:
    global_store_dwordx2 v36, v[34:35], s[32:33] offset:2304
L_t_odone:
    s_setprio 1
    v_mov_b32 v18, 163772
    s_mov_b32 s61, 3200000
L_spin_cv:
    ds_read_b32 v19, v18
    s_sub_u32 s61, s61, 1
    s_cmp_eq_u32 s61, 0
    s_cbranch_scc1 L_spun_cv
    s_waitcnt lgkmcnt(0)
    v_cmp_gt_u32 vcc, 4, v19
    s_nop 0
    s_cbranch_vccnz L_spin_cv
L_spun_cv:
    s_waitcnt lgkmcnt(0)
    s_waitcnt lgkmcnt(8)
    v_mfma_f32_32x32x16_bf16 v[32:47], v[124:127], v[48:51], 0
    v_mfma_f32_32x32x16_bf16 v[16:31], v[120:123], v[48:51], 0
    ds_read_b64_tr_b16 v[120:121], v160 offset:6144
    ds_read_b64_tr_b16 v[122:123], v160 offset:6656
    ds_read_b64_tr_b16 v[124:125], v161 offset:6144
    ds_read_b64_tr_b16 v[126:127], v161 offset:6656
    s_waitcnt lgkmcnt(8)
    v_mfma_f32_32x32x16_bf16 v[32:47], v[132:135], v[52:55], v[32:47]
    v_mfma_f32_32x32x16_bf16 v[16:31], v[128:131], v[52:55], v[16:31]
    ds_read_b64_tr_b16 v[128:129], v160 offset:8192
    ds_read_b64_tr_b16 v[130:131], v160 offset:8704
    ds_read_b64_tr_b16 v[132:133], v161 offset:8192
    ds_read_b64_tr_b16 v[134:135], v161 offset:8704
    s_waitcnt lgkmcnt(8)
    v_mfma_f32_32x32x16_bf16 v[32:47], v[140:143], v[56:59], v[32:47]
    v_mfma_f32_32x32x16_bf16 v[16:31], v[136:139], v[56:59], v[16:31]
    ds_read_b64_tr_b16 v[136:137], v160 offset:10240
    ds_read_b64_tr_b16 v[138:139], v160 offset:10752
    ds_read_b64_tr_b16 v[140:141], v161 offset:10240
    ds_read_b64_tr_b16 v[142:143], v161 offset:10752
    s_waitcnt lgkmcnt(8)
    v_mfma_f32_32x32x16_bf16 v[32:47], v[124:127], v[60:63], v[32:47]
    v_mfma_f32_32x32x16_bf16 v[16:31], v[120:123], v[60:63], v[16:31]
    ds_read_b64_tr_b16 v[120:121], v160 offset:12288
    ds_read_b64_tr_b16 v[122:123], v160 offset:12800
    ds_read_b64_tr_b16 v[124:125], v161 offset:12288
    ds_read_b64_tr_b16 v[126:127], v161 offset:12800
    s_waitcnt lgkmcnt(8)
    v_mfma_f32_32x32x16_bf16 v[32:47], v[132:135], v[64:67], v[32:47]
    v_mfma_f32_32x32x16_bf16 v[16:31], v[128:131], v[64:67], v[16:31]
    ds_read_b64_tr_b16 v[128:129], v160 offset:14336
    ds_read_b64_tr_b16 v[130:131], v160 offset:14848
    ds_read_b64_tr_b16 v[132:133], v161 offset:14336
    ds_read_b64_tr_b16 v[134:135], v161 offset:14848
    s_waitcnt lgkmcnt(8)
    v_mfma_f32_32x32x16_bf16 v[32:47], v[140:143], v[68:71], v[32:47]
    v_mfma_f32_32x32x16_bf16 v[16:31], v[136:139], v[68:71], v[16:31]
    ds_read_b64_tr_b16 v[136:137], v160 offset:16384
    ds_read_b64_tr_b16 v[138:139], v160 offset:16896
    ds_read_b64_tr_b16 v[140:141], v161 offset:16384
    ds_read_b64_tr_b16 v[142:143], v161 offset:16896
    s_waitcnt lgkmcnt(8)
    v_mfma_f32_32x32x16_bf16 v[32:47], v[124:127], v[72:75], v[32:47]
    v_mfma_f32_32x32x16_bf16 v[16:31], v[120:123], v[72:75], v[16:31]
    ds_read_b64_tr_b16 v[120:121], v160 offset:18432
    ds_read_b64_tr_b16 v[122:123], v160 offset:18944
    ds_read_b64_tr_b16 v[124:125], v161 offset:18432
    ds_read_b64_tr_b16 v[126:127], v161 offset:18944
    s_waitcnt lgkmcnt(8)
    v_mfma_f32_32x32x16_bf16 v[32:47], v[132:135], v[76:79], v[32:47]
    v_mfma_f32_32x32x16_bf16 v[16:31], v[128:131], v[76:79], v[16:31]
    ds_read_b64_tr_b16 v[128:129], v160 offset:20480
    ds_read_b64_tr_b16 v[130:131], v160 offset:20992
    ds_read_b64_tr_b16 v[132:133], v161 offset:20480
    ds_read_b64_tr_b16 v[134:135], v161 offset:20992
    s_waitcnt lgkmcnt(8)
    v_mfma_f32_32x32x16_bf16 v[32:47], v[140:143], v[80:83], v[32:47]
    v_mfma_f32_32x32x16_bf16 v[16:31], v[136:139], v[80:83], v[16:31]
    ds_read_b64_tr_b16 v[136:137], v160 offset:22528
    ds_read_b64_tr_b16 v[138:139], v160 offset:23040
    ds_read_b64_tr_b16 v[140:141], v161 offset:22528
    ds_read_b64_tr_b16 v[142:143], v161 offset:23040
    s_waitcnt lgkmcnt(8)
    v_mfma_f32_32x32x16_bf16 v[32:47], v[124:127], v[84:87], v[32:47]
    v_mfma_f32_32x32x16_bf16 v[16:31], v[120:123], v[84:87], v[16:31]
    ds_read_b64_tr_b16 v[120:121], v160 offset:24576
    ds_read_b64_tr_b16 v[122:123], v160 offset:25088
    ds_read_b64_tr_b16 v[124:125], v161 offset:24576
    ds_read_b64_tr_b16 v[126:127], v161 offset:25088
    s_waitcnt lgkmcnt(8)
    v_mfma_f32_32x32x16_bf16 v[32:47], v[132:135], v[88:91], v[32:47]
    v_mfma_f32_32x32x16_bf16 v[16:31], v[128:131], v[88:91], v[16:31]
    ds_read_b64_tr_b16 v[128:129], v160 offset:26624
    ds_read_b64_tr_b16 v[130:131], v160 offset:27136
    ds_read_b64_tr_b16 v[132:133], v161 offset:26624
    ds_read_b64_tr_b16 v[134:135], v161 offset:27136
    s_waitcnt lgkmcnt(8)
    v_mfma_f32_32x32x16_bf16 v[32:47], v[140:143], v[92:95], v[32:47]
    v_mfma_f32_32x32x16_bf16 v[16:31], v[136:139], v[92:95], v[16:31]
    ds_read_b64_tr_b16 v[136:137], v160 offset:28672
    ds_read_b64_tr_b16 v[138:139], v160 offset:29184
    ds_read_b64_tr_b16 v[140:141], v161 offset:28672
    ds_read_b64_tr_b16 v[142:143], v161 offset:29184
    s_waitcnt lgkmcnt(8)
    v_mfma_f32_32x32x16_bf16 v[32:47], v[124:127], v[96:99], v[32:47]
    v_mfma_f32_32x32x16_bf16 v[16:31], v[120:123], v[96:99], v[16:31]
    ds_read_b64_tr_b16 v[120:121], v160 offset:30720
    ds_read_b64_tr_b16 v[122:123], v160 offset:31232
    ds_read_b64_tr_b16 v[124:125], v161 offset:30720
    ds_read_b64_tr_b16 v[126:127], v161 offset:31232
    s_waitcnt lgkmcnt(8)
    v_mfma_f32_32x32x16_bf16 v[32:47], v[132:135], v[100:103], v[32:47]
    v_mfma_f32_32x32x16_bf16 v[16:31], v[128:131], v[100:103], v[16:31]
    ds_read_b64_tr_b16 v[128:129], v162 offset:0
    ds_read_b64_tr_b16 v[130:131], v162 offset:512
    ds_read_b64_tr_b16 v[132:133], v163 offset:0
    ds_read_b64_tr_b16 v[134:135], v163 offset:512
    s_waitcnt lgkmcnt(8)
    v_mfma_f32_32x32x16_bf16 v[32:47], v[140:143], v[104:107], v[32:47]
    v_mfma_f32_32x32x16_bf16 v[16:31], v[136:139], v[104:107], v[16:31]
    ds_read_b64_tr_b16 v[136:137], v162 offset:2048
    ds_read_b64_tr_b16 v[138:139], v162 offset:2560
    ds_read_b64_tr_b16 v[140:141], v163 offset:2048
    ds_read_b64_tr_b16 v[142:143], v163 offset:2560
    s_waitcnt lgkmcnt(8)
    v_mfma_f32_32x32x16_bf16 v[32:47], v[124:127], v[108:111], v[32:47]
    v_mfma_f32_32x32x16_bf16 v[16:31], v[120:123], v[108:111], v[16:31]
    s_waitcnt lgkmcnt(4)
    v_mfma_f32_32x32x16_bf16 v[32:47], v[132:135], v[112:115], v[32:47]
    v_mfma_f32_32x32x16_bf16 v[16:31], v[128:131], v[112:115], v[16:31]
    s_waitcnt lgkmcnt(0)
    v_mfma_f32_32x32x16_bf16 v[32:47], v[140:143], v[116:119], v[32:47]
    v_mfma_f32_32x32x16_bf16 v[16:31], v[136:139], v[116:119], v[16:31]
    s_branch L_t_red
L_t_plain:
    s_waitcnt vmcnt(23) lgkmcnt(8)
    v_mfma_f32_32x32x16_bf16 v[32:47], v[124:127], v[48:51], 0
    v_mfma_f32_32x32x16_bf16 v[16:31], v[120:123], v[48:51], 0
    ds_read_b64_tr_b16 v[120:121], v160 offset:6144
    ds_read_b64_tr_b16 v[122:123], v160 offset:6656
    ds_read_b64_tr_b16 v[124:125], v161 offset:6144
    ds_read_b64_tr_b16 v[126:127], v161 offset:6656
    s_waitcnt vmcnt(22) lgkmcnt(8)
    v_mfma_f32_32x32x16_bf16 v[32:47], v[132:135], v[52:55], v[32:47]
    v_mfma_f32_32x32x16_bf16 v[16:31], v[128:131], v[52:55], v[16:31]
    ds_read_b64_tr_b16 v[128:129], v160 offset:8192
    ds_read_b64_tr_b16 v[130:131], v160 offset:8704
    ds_read_b64_tr_b16 v[132:133], v161 offset:8192
    ds_read_b64_tr_b16 v[134:135], v161 offset:8704
    s_waitcnt vmcnt(21) lgkmcnt(8)
    v_mfma_f32_32x32x16_bf16 v[32:47], v[140:143], v[56:59], v[32:47]
    v_mfma_f32_32x32x16_bf16 v[16:31], v[136:139], v[56:59], v[16:31]
    ds_read_b64_tr_b16 v[136:137], v160 offset:10240
    ds_read_b64_tr_b16 v[138:139], v160 offset:10752
    ds_read_b64_tr_b16 v[140:141], v161 offset:10240
    ds_read_b64_tr_b16 v[142:143], v161 offset:10752
    s_waitcnt vmcnt(20) lgkmcnt(8)
    v_mfma_f32_32x32x16_bf16 v[32:47], v[124:127], v[60:63], v[32:47]
    v_mfma_f32_32x32x16_bf16 v[16:31], v[120:123], v[60:63], v[16:31]
    ds_read_b64_tr_b16 v[120:121], v160 offset:12288
    ds_read_b64_tr_b16 v[122:123], v160 offset:12800
    ds_read_b64_tr_b16 v[124:125], v161 offset:12288
    ds_read_b64_tr_b16 v[126:127], v161 offset:12800
    s_waitcnt vmcnt(19) lgkmcnt(8)
    v_mfma_f32_32x32x16_bf16 v[32:47], v[132:135], v[64:67], v[32:47]
    v_mfma_f32_32x32x16_bf16 v[16:31], v[128:131], v[64:67], v[16:31]
    ds_read_b64_tr_b16 v[128:129], v160 offset:14336
    ds_read_b64_tr_b16 v[130:131], v160 offset:14848
    ds_read_b64_tr_b16 v[132:133], v161 offset:14336
    ds_read_b64_tr_b16 v[134:135], v161 offset:14848
    s_waitcnt vmcnt(18) lgkmcnt(8)
    v_mfma_f32_32x32x16_bf16 v[32:47], v[140:143], v[68:71], v[32:47]
    v_mfma_f32_32x32x16_bf16 v[16:31], v[136:139], v[68:71], v[16:31]
    ds_read_b64_tr_b16 v[136:137], v160 offset:16384
    ds_read_b64_tr_b16 v[138:139], v160 offset:16896
    ds_read_b64_tr_b16 v[140:141], v161 offset:16384
    ds_read_b64_tr_b16 v[142:143], v161 offset:16896
    s_waitcnt vmcnt(17) lgkmcnt(8)
    v_mfma_f32_32x32x16_bf16 v[32:47], v[124:127], v[72:75], v[32:47]
    v_mfma_f32_32x32x16_bf16 v[16:31], v[120:123], v[72:75], v[16:31]
    ds_read_b64_tr_b16 v[120:121], v160 offset:18432
    ds_read_b64_tr_b16 v[122:123], v160 offset:18944
    ds_read_b64_tr_b16 v[124:125], v161 offset:18432
    ds_read_b64_tr_b16 v[126:127], v161 offset:18944
    s_waitcnt vmcnt(16) lgkmcnt(8)
    v_mfma_f32_32x32x16_bf16 v[32:47], v[132:135], v[76:79], v[32:47]
    v_mfma_f32_32x32x16_bf16 v[16:31], v[128:131], v[76:79], v[16:31]
    ds_read_b64_tr_b16 v[128:129], v160 offset:20480
    ds_read_b64_tr_b16 v[130:131], v160 offset:20992
    ds_read_b64_tr_b16 v[132:133], v161 offset:20480
    ds_read_b64_tr_b16 v[134:135], v161 offset:20992
    s_waitcnt vmcnt(15) lgkmcnt(8)
    v_mfma_f32_32x32x16_bf16 v[32:47], v[140:143], v[80:83], v[32:47]
    v_mfma_f32_32x32x16_bf16 v[16:31], v[136:139], v[80:83], v[16:31]
    ds_read_b64_tr_b16 v[136:137], v160 offset:22528
    ds_read_b64_tr_b16 v[138:139], v160 offset:23040
    ds_read_b64_tr_b16 v[140:141], v161 offset:22528
    ds_read_b64_tr_b16 v[142:143], v161 offset:23040
    s_waitcnt vmcnt(14) lgkmcnt(8)
    v_mfma_f32_32x32x16_bf16 v[32:47], v[124:127], v[84:87], v[32:47]
    v_mfma_f32_32x32x16_bf16 v[16:31], v[120:123], v[84:87], v[16:31]
    ds_read_b64_tr_b16 v[120:121], v160 offset:24576
    ds_read_b64_tr_b16 v[122:123], v160 offset:25088
    ds_read_b64_tr_b16 v[124:125], v161 offset:24576
    ds_read_b64_tr_b16 v[126:127], v161 offset:25088
    s_waitcnt vmcnt(13) lgkmcnt(8)
    v_mfma_f32_32x32x16_bf16 v[32:47], v[132:135], v[88:91], v[32:47]
    v_mfma_f32_32x32x16_bf16 v[16:31], v[128:131], v[88:91], v[16:31]
    ds_read_b64_tr_b16 v[128:129], v160 offset:26624
    ds_read_b64_tr_b16 v[130:131], v160 offset:27136
    ds_read_b64_tr_b16 v[132:133], v161 offset:26624
    ds_read_b64_tr_b16 v[134:135], v161 offset:27136
    s_waitcnt vmcnt(12) lgkmcnt(8)
    v_mfma_f32_32x32x16_bf16 v[32:47], v[140:143], v[92:95], v[32:47]
    v_mfma_f32_32x32x16_bf16 v[16:31], v[136:139], v[92:95], v[16:31]
    ds_read_b64_tr_b16 v[136:137], v160 offset:28672
    ds_read_b64_tr_b16 v[138:139], v160 offset:29184
    ds_read_b64_tr_b16 v[140:141], v161 offset:28672
    ds_read_b64_tr_b16 v[142:143], v161 offset:29184
    s_waitcnt vmcnt(11) lgkmcnt(8)
    v_mfma_f32_32x32x16_bf16 v[32:47], v[124:127], v[96:99], v[32:47]
    v_mfma_f32_32x32x16_bf16 v[16:31], v[120:123], v[96:99], v[16:31]
    ds_read_b64_tr_b16 v[120:121], v160 offset:30720
    ds_read_b64_tr_b16 v[122:123], v160 offset:31232
    ds_read_b64_tr_b16 v[124:125], v161 offset:30720
    ds_read_b64_tr_b16 v[126:127], v161 offset:31232
    s_waitcnt vmcnt(10) lgkmcnt(8)
    v_mfma_f32_32x32x16_bf16 v[32:47], v[132:135], v[100:103], v[32:47]
    v_mfma_f32_32x32x16_bf16 v[16:31], v[128:131], v[100:103], v[16:31]
    ds_read_b64_tr_b16 v[128:129], v162 offset:0
    ds_read_b64_tr_b16 v[130:131], v162 offset:512
    ds_read_b64_tr_b16 v[132:133], v163 offset:0
    ds_read_b64_tr_b16 v[134:135], v163 offset:512
    s_waitcnt vmcnt(9) lgkmcnt(8)
    v_mfma_f32_32x32x16_bf16 v[32:47], v[140:143], v[104:107], v[32:47]
    v_mfma_f32_32x32x16_bf16 v[16:31], v[136:139], v[104:107], v[16:31]
    ds_read_b64_tr_b16 v[136:137], v162 offset:2048
    ds_read_b64_tr_b16 v[138:139], v162 offset:2560
    ds_read_b64_tr_b16 v[140:141], v163 offset:2048
    ds_read_b64_tr_b16 v[142:143], v163 offset:2560
    s_waitcnt vmcnt(8) lgkmcnt(8)
    v_mfma_f32_32x32x16_bf16 v[32:47], v[124:127], v[108:111], v[32:47]
    v_mfma_f32_32x32x16_bf16 v[16:31], v[120:123], v[108:111], v[16:31]
    s_waitcnt vmcnt(4) lgkmcnt(4)
    v_mfma_f32_32x32x16_bf16 v[32:47], v[132:135], v[112:115], v[32:47]
    v_mfma_f32_32x32x16_bf16 v[16:31], v[128:131], v[112:115], v[16:31]
    s_waitcnt vmcnt(0) lgkmcnt(0)
    v_mfma_f32_32x32x16_bf16 v[32:47], v[140:143], v[116:119], v[32:47]
    v_mfma_f32_32x32x16_bf16 v[16:31], v[136:139], v[116:119], v[16:31]
L_t_red:
    s_nop 10
    ds_write_b128 v165, v[32:35] offset:0
    ds_write_b128 v165, v[36:39] offset:1024
    ds_write_b128 v165, v[40:43] offset:2048
    ds_write_b128 v167, v[44:47]
    ds_write_b32 v175, v11
L_t_sent:
    s_mov_b32 s61, 3200000
L_spin_red:
    ds_read_b32 v11, v176
    s_sub_u32 s61, s61, 1
    s_cmp_eq_u32 s61, 0
    s_cbranch_scc1 L_spun_red
    s_waitcnt lgkmcnt(0)
    v_cmp_gt_u32 vcc, 1, v11
    s_nop 0
    s_cbranch_vccnz L_spin_red
L_spun_red:
    s_waitcnt lgkmcnt(0)
    ds_read_b128 v[48:51], v166 offset:0
    ds_read_b128 v[52:55], v166 offset:1024
    ds_read_b128 v[56:59], v166 offset:2048
    ds_read_b128 v[60:63], v168
    s_waitcnt lgkmcnt(3)
    v_add_f32 v16, v16, v48
    v_add_f32 v17, v17, v49
    v_add_f32 v18, v18, v50
    v_add_f32 v19, v19, v51
    v_cvt_pk_bf16_f32 v64, v16, v17
    v_cvt_pk_bf16_f32 v65, v18, v19
    s_waitcnt lgkmcnt(2)
    v_add_f32 v20, v20, v52
    v_add_f32 v21, v21, v53
    v_add_f32 v22, v22, v54
    v_add_f32 v23, v23, v55
    v_cvt_pk_bf16_f32 v66, v20, v21
    v_cvt_pk_bf16_f32 v67, v22, v23
    s_waitcnt lgkmcnt(1)
    v_add_f32 v24, v24, v56
    v_add_f32 v25, v25, v57
    v_add_f32 v26, v26, v58
    v_add_f32 v27, v27, v59
    v_cvt_pk_bf16_f32 v68, v24, v25
    v_cvt_pk_bf16_f32 v69, v26, v27
    s_waitcnt lgkmcnt(0)
    v_add_f32 v28, v28, v60
    v_add_f32 v29, v29, v61
    v_add_f32 v30, v30, v62
    v_add_f32 v31, v31, v63
    v_cvt_pk_bf16_f32 v70, v28, v29
    v_cvt_pk_bf16_f32 v71, v30, v31
    ds_write_b128 v169, v[64:67]
    ds_write_b128 v170, v[68:71]
    ds_read_b128 v[64:67], v171
    ds_read_b128 v[68:71], v171 offset:1024
    s_waitcnt lgkmcnt(1)
    global_store_dwordx4 v172, v[64:67], s[32:33] nt
    s_waitcnt lgkmcnt(0)
    global_store_dwordx4 v173, v[68:71], s[32:33] nt
L_end_tail:
L_end:
    s_endpgm
L_ck16:
    s_mov_b32 s61, 3200000
L_ckl16:
    ds_read_b32 v154, v152 offset:64
    s_sub_u32 s61, s61, 1
    s_cmp_eq_u32 s61, 0
    s_cbranch_scc1 L_ckb16
    s_waitcnt lgkmcnt(0)
    v_cmp_gt_u32 vcc, 8, v154
    s_nop 0
    s_cbranch_vccnz L_ckl16
    s_branch L_ckb16
L_ck17:
    s_mov_b32 s61, 3200000
L_ckl17:
    ds_read_b32 v154, v152 offset:68
    s_sub_u32 s61, s61, 1
    s_cmp_eq_u32 s61, 0
    s_cbranch_scc1 L_ckb17
    s_waitcnt lgkmcnt(0)
    v_cmp_gt_u32 vcc, 8, v154
    s_nop 0
    s_cbranch_vccnz L_ckl17
    s_branch L_ckb17
L_ck18:
    s_mov_b32 s61, 3200000
L_ckl18:
    ds_read_b32 v154, v152 offset:72
    s_sub_u32 s61, s61, 1
    s_cmp_eq_u32 s61, 0
    s_cbranch_scc1 L_ckb18
    s_waitcnt lgkmcnt(0)
    v_cmp_gt_u32 vcc, 8, v154
    s_nop 0
    s_cbranch_vccnz L_ckl18
    s_branch L_ckb18
L_ck19:
    s_mov_b32 s61, 3200000
L_ckl19:
    ds_read_b32 v154, v152 offset:76
    s_sub_u32 s61, s61, 1
    s_cmp_eq_u32 s61, 0
    s_cbranch_scc1 L_ckb19
    s_waitcnt lgkmcnt(0)
    v_cmp_gt_u32 vcc, 8, v154
    s_nop 0
    s_cbranch_vccnz L_ckl19
    s_branch L_ckb19
L_ck20:
    s_mov_b32 s61, 3200000
L_ckl20:
    ds_read_b32 v154, v152 offset:80
    s_sub_u32 s61, s61, 1
    s_cmp_eq_u32 s61, 0
    s_cbranch_scc1 L_ckb20
    s_waitcnt lgkmcnt(0)
    v_cmp_gt_u32 vcc, 8, v154
    s_nop 0
    s_cbranch_vccnz L_ckl20
    s_branch L_ckb20
L_att_slow:
    s_waitcnt lgkmcnt(0)
    s_barrier
    s_add_u32 m0, s83, 0
    s_add_u32 s69, s82, 0
    buffer_load_dwordx4 v6, s[52:55], s69 offen sc1 lds
    s_add_u32 m0, s83, 8192
    s_add_u32 s69, s82, 0
    buffer_load_dwordx4 v7, s[52:55], s69 offen sc1 lds
    s_add_u32 m0, s92, 16384
    s_add_u32 s69, s82, 0
    s_mov_b64 exec, 0xffffff
    buffer_load_dwordx4 v14, s[52:55], s69 offen sc1 lds
    s_mov_b64 exec, -1
    s_add_u32 m0, s83, 19456
    s_add_u32 s69, s82, 19456
    buffer_load_dwordx4 v6, s[52:55], s69 offen sc1 lds
    s_add_u32 m0, s83, 27648
    s_add_u32 s69, s82, 19456
    buffer_load_dwordx4 v7, s[52:55], s69 offen sc1 lds
    s_add_u32 m0, s92, 35840
    s_add_u32 s69, s82, 19456
    s_mov_b64 exec, 0xffffff
    buffer_load_dwordx4 v14, s[52:55], s69 offen sc1 lds
    s_mov_b64 exec, -1
    s_add_u32 m0, s83, 38912
    s_add_u32 s69, s82, 38912
    buffer_load_dwordx4 v6, s[52:55], s69 offen sc1 lds
    s_add_u32 m0, s83, 47104
    s_add_u32 s69, s82, 38912
    buffer_load_dwordx4 v7, s[52:55], s69 offen sc1 lds
    s_add_u32 m0, s92, 55296
    s_add_u32 s69, s82, 38912
    s_mov_b64 exec, 0xffffff
    buffer_load_dwordx4 v14, s[52:55], s69 offen sc1 lds
    s_mov_b64 exec, -1
    s_add_u32 m0, s83, 58368
    s_add_u32 s69, s82, 58368
    buffer_load_dwordx4 v6, s[52:55], s69 offen sc1 lds
    s_add_u32 m0, s83, 66560
    s_add_u32 s69, s82, 58368
    buffer_load_dwordx4 v7, s[52:55], s69 offen sc1 lds
    s_add_u32 m0, s92, 74752
    s_add_u32 s69, s82, 58368
    s_mov_b64 exec, 0xffffff
    buffer_load_dwordx4 v14, s[52:55], s69 offen sc1 lds
    s_mov_b64 exec, -1
    s_add_u32 m0, s83, 77824
    s_add_u32 s69, s82, 77824
    buffer_load_dwordx4 v6, s[52:55], s69 offen sc1 lds
    s_add_u32 m0, s83, 86016
    s_add_u32 s69, s82, 77824
    buffer_load_dwordx4 v7, s[52:55], s69 offen sc1 lds
    s_add_u32 m0, s92, 94208
    s_add_u32 s69, s82, 77824
    s_mov_b64 exec, 0xffffff
    buffer_load_dwordx4 v14, s[52:55], s69 offen sc1 lds
    s_mov_b64 exec, -1
    s_add_u32 m0, s83, 97280
    s_add_u32 s69, s82, 97280
    buffer_load_dwordx4 v6, s[52:55], s69 offen sc1 lds
    s_add_u32 m0, s83, 105472
    s_add_u32 s69, s82, 97280
    buffer_load_dwordx4 v7, s[52:55], s69 offen sc1 lds
    s_add_u32 m0, s92, 113664
    s_add_u32 s69, s82, 97280
    s_mov_b64 exec, 0xffffff
    buffer_load_dwordx4 v14, s[52:55], s69 offen sc1 lds
    s_mov_b64 exec, -1
    s_cmp_lt_u32 s38, 4
    s_cbranch_scc1 L_slow_q0
    v_mov_b32 v8, v124
    v_mov_b32 v9, v125
    v_mov_b32 v10, v126
    v_mov_b32 v11, v127
    v_mov_b32 v100, v12
    s_nop 1
    v_permlane32_swap_b32 v12, v100
    v_mov_b32 v12, v100
L_slow_q0:
    v_mov_b32 v13, 0
    v_mov_b32 v15, 0xff800000
    s_mov_b32 s63, 0
    v_subrev_u32 v1, s71, v1
    v_subrev_u32 v2, s72, v2
    v_subrev_u32 v3, s73, v3
    v_subrev_u32 v4, s73, v4
    v_add_u32 v1, 38912, v1
    v_add_u32 v2, 38912, v2
    v_add_u32 v3, 38912, v3
    v_add_u32 v4, 38912, v4
    s_waitcnt vmcnt(0)
    s_barrier
L_slow_pass:
    v_subrev_u32 v1, 155648, v1
    v_subrev_u32 v2, 155648, v2
    v_subrev_u32 v3, 155648, v3
    v_subrev_u32 v4, 155648, v4
    s_mov_b32 s62, 0
L_slow_loop:
    ds_read_b32 v104, v2 offset:18432
    ds_read_b128 v[96:99], v1 offset:0
    ds_read_b64_tr_b16 v[108:109], v3 offset:8192
    ds_read_b64_tr_b16 v[110:111], v4 offset:8192
    ds_read_b64_tr_b16 v[112:113], v3 offset:8832
    ds_read_b64_tr_b16 v[114:115], v4 offset:8832
    s_waitcnt lgkmcnt(0)
    v_mfma_f32_32x32x4_2b_bf16 v[32:63], v[104:105], v[12:13], 0
    s_nop 15
    s_nop 1
    v_mfma_f32_32x32x16_bf16 v[32:47], v[96:99], v[8:11], v[32:47]
    s_cmp_eq_u32 s63, 0
    s_cbranch_scc0 L_slow_p2
    s_nop 9
    v_max3_f32 v15, v15, v32, v33
    v_max3_f32 v15, v15, v34, v35
    v_max3_f32 v15, v15, v36, v37
    v_max3_f32 v15, v15, v38, v39
    v_max3_f32 v15, v15, v40, v41
    v_max3_f32 v15, v15, v42, v43
    v_max3_f32 v15, v15, v44, v45
    v_max3_f32 v15, v15, v46, v47
    s_branch L_slow_next
L_slow_p2:
    s_nop 9
    v_sub_f32 v32, v32, v15
    v_sub_f32 v33, v33, v15
    v_sub_f32 v34, v34, v15
    v_sub_f32 v35, v35, v15
    v_sub_f32 v36, v36, v15
    v_sub_f32 v37, v37, v15
    v_sub_f32 v38, v38, v15
    v_sub_f32 v39, v39, v15
    v_sub_f32 v40, v40, v15
    v_sub_f32 v41, v41, v15
    v_sub_f32 v42, v42, v15
    v_sub_f32 v43, v43, v15
    v_sub_f32 v44, v44, v15
    v_sub_f32 v45, v45, v15
    v_sub_f32 v46, v46, v15
    v_sub_f32 v47, v47, v15
    v_exp_f32 v32, v32
    v_exp_f32 v33, v33
    v_exp_f32 v34, v34
    v_exp_f32 v35, v35
    v_exp_f32 v36, v36
    v_exp_f32 v37, v37
    v_exp_f32 v38, v38
    v_exp_f32 v39, v39
    v_exp_f32 v40, v40
    v_exp_f32 v41, v41
    v_exp_f32 v42, v42
    v_exp_f32 v43, v43
    v_exp_f32 v44, v44
    v_exp_f32 v45, v45
    v_exp_f32 v46, v46
    v_exp_f32 v47, v47
    v_smfmac_f32_32x32x32_bf16 v[16:31], v[108:111], v[32:39], v5
    s_nop 0
    v_smfmac_f32_32x32x32_bf16 v[16:31], v[112:115], v[40:47], v5
L_slow_next:
    s_add_u32 s62, s62, 1
    s_and_b32 s60, s62, 7
    s_cmp_eq_u32 s60, 0
    s_mov_b32 s60, 1024
    s_mov_b32 s61, 128
    s_mov_b32 s69, 1280
    s_cmov_b32 s60, 12288
    s_cmov_b32 s61, 18560
    s_cmov_b32 s69, 10496
    v_add_u32 v1, s60, v1
    v_add_u32 v2, s61, v2
    v_add_u32 v3, s69, v3
    v_add_u32 v4, s69, v4
    s_cmp_lt_u32 s62, 64
    s_cbranch_scc1 L_slow_loop
    s_cmp_eq_u32 s63, 0
    s_cbranch_scc0 L_slow_done
    v_mov_b32 v100, v15
    s_nop 1
    v_permlane32_swap_b32 v15, v100
    v_max_f32 v15, v15, v100
    v_mov_b32 v16, 0
    v_mov_b32 v17, 0
    v_mov_b32 v18, 0
    v_mov_b32 v19, 0
    v_mov_b32 v20, 0
    v_mov_b32 v21, 0
    v_mov_b32 v22, 0
    v_mov_b32 v23, 0
    v_mov_b32 v24, 0
    v_mov_b32 v25, 0
    v_mov_b32 v26, 0
    v_mov_b32 v27, 0
    v_mov_b32 v28, 0
    v_mov_b32 v29, 0
    v_mov_b32 v30, 0
    v_mov_b32 v31, 0
    s_mov_b32 s63, 1
    s_branch L_slow_pass
L_slow_done:
    v_mov_b32 v15, v26
    s_nop 1
    v_permlane32_swap_b32 v15, v26
    v_rcp_f32 v15, v15
    v_lshlrev_b32 v38, 4, v0
    v_and_b32 v39, 31, v0
    v_lshlrev_b32 v39, 2, v39
    v_mul_f32 v16, v15, v16
    v_mul_f32 v17, v15, v17
    v_mul_f32 v18, v15, v18
    v_mul_f32 v19, v15, v19
    v_mul_f32 v20, v15, v20
    v_mul_f32 v21, v15, v21
    v_mul_f32 v22, v15, v22
    v_mul_f32 v23, v15, v23
    v_mul_f32 v24, v15, v24
    v_mul_f32 v25, v15, v25
    v_cvt_pk_bf16_f32 v32, v16, v17
    v_cvt_pk_bf16_f32 v33, v18, v19
    v_cvt_pk_bf16_f32 v34, v20, v21
    v_cvt_pk_bf16_f32 v35, v22, v23
    v_cvt_pk_bf16_f32 v36, v24, v25
    buffer_store_dwordx4 v[32:35], v38, s[52:55], s65 offen sc1
    s_mov_b32 exec_hi, 0
    buffer_store_dword v36, v39, s[52:55], s64 offen sc1
    s_mov_b32 exec_hi, -1
    s_barrier
    s_lshl_b32 s60, s38, 13
    s_add_u32 m0, s60, 24576
    s_mov_b32 s61, 0
    buffer_load_dwordx4 v240, s[48:51], s61 offen lds
    s_lshl_b32 s60, s38, 13
    s_add_u32 m0, s60, 25600
    s_mov_b32 s61, 9216
    buffer_load_dwordx4 v240, s[48:51], s61 offen lds
    s_lshl_b32 s60, s38, 13
    s_add_u32 m0, s60, 26624
    s_mov_b32 s61, 23040
    buffer_load_dwordx4 v240, s[48:51], s61 offen lds
    s_lshl_b32 s60, s38, 13
    s_add_u32 m0, s60, 27648
    s_mov_b32 s61, 32256
    buffer_load_dwordx4 v240, s[48:51], s61 offen lds
    s_lshl_b32 s60, s38, 13
    s_add_u32 m0, s60, 28672
    s_mov_b32 s61, 41472
    buffer_load_dwordx4 v240, s[48:51], s61 offen lds
    s_lshl_b32 s60, s38, 13
    s_add_u32 m0, s60, 29696
    s_mov_b32 s61, 50688
    buffer_load_dwordx4 v240, s[48:51], s61 offen lds
    s_lshl_b32 s60, s38, 13
    s_add_u32 m0, s60, 30720
    s_mov_b32 s61, 64512
    buffer_load_dwordx4 v240, s[48:51], s61 offen lds
    s_lshl_b32 s60, s38, 13
    s_add_u32 m0, s60, 31744
    s_mov_b32 s61, 73728
    buffer_load_dwordx4 v240, s[48:51], s61 offen lds
    s_add_u32 m0, s83, 90112
    s_nop 0
    buffer_load_dwordx4 v241, s[48:51], 0 offen lds
    s_cmp_eq_u32 s41, 0
    s_cbranch_scc1 L_nou_slow
    s_lshl_b32 s60, s38, 9
    s_add_u32 s60, s60, 98784
    v_lshl_add_u32 v103, v0, 3, s60
    s_mov_b32 s60, 0x05040100
    s_mov_b32 s61, 0x07060302
    v_perm_b32 v144, v244, v242, s60
    v_perm_b32 v145, v248, v246, s60
    ds_write_b64 v103, v[144:145] offset:0
    v_perm_b32 v146, v244, v242, s61
    v_perm_b32 v147, v248, v246, s61
    ds_write_b64 v103, v[146:147] offset:4608
    v_perm_b32 v148, v245, v243, s60
    v_perm_b32 v149, v249, v247, s60
    ds_write_b64 v103, v[148:149] offset:9216
    v_perm_b32 v150, v245, v243, s61
    v_perm_b32 v151, v249, v247, s61
    ds_write_b64 v103, v[150:151] offset:13824
L_nou_slow:
    s_waitcnt vmcnt(0) lgkmcnt(0)
    s_barrier
    s_branch L_att_fin
L_code_end:

.section .rodata,"a"
.p2align 6
.amdhsa_kernel concat_heads__ssm_conv_s4__mha_block__prompt_kernel
  .amdhsa_next_free_vgpr 256
  .amdhsa_next_free_sgpr 96
  .amdhsa_accum_offset 256
  .amdhsa_group_segment_fixed_size 0
  .amdhsa_kernarg_size 120
  .amdhsa_user_sgpr_count 2
  .amdhsa_user_sgpr_kernarg_segment_ptr 1
  .amdhsa_system_sgpr_workgroup_id_x 1
.end_amdhsa_kernel
```
